```python
import torch

def _softmax(x, axis=-1):
    return torch.softmax(x, dim=axis)
def _gelu(x):
    return torch.nn.functional.gelu(x, approximate="tanh")
def _silu(x):
    return torch.nn.functional.silu(x)
def _sigmoid(x):
    return torch.sigmoid(x)
def _layernorm(x, axis=-1, eps=1e-5):
    m = x.mean(dim=axis, keepdim=True)
    v = x.var(dim=axis, keepdim=True, unbiased=False)
    return (x - m) / torch.sqrt(v + eps)
def _scatter_add(tgt, idx, src, axis=0):
    return tgt.clone().index_add_(axis, idx, src)
def _segment_sum(src, seg, n):
    out = torch.zeros((n,) + src.shape[1:], dtype=src.dtype)
    return out.index_add_(0, seg, src)
def _pad(x, pw):
    flat = tuple(v for pair in reversed(pw) for v in pair)
    return torch.nn.functional.pad(x, flat)

kernel_name = 'sequential_preLN__softmax_full_mha__swiglu_ffn__prompt'

def setup_inputs():

    _w = (lambda a: (lambda t: t.to(torch.bfloat16) if t.is_floating_point() else t)(torch.as_tensor(a)))
    def _A_setup():
        B, S, D = 1, 2048, 576
        return {
            "x": _w((lambda *s: torch.randn(*s, dtype=torch.bfloat16) * 0.05)(B, S, D)),
            "wqkv": _w((lambda *s: torch.randn(*s, dtype=torch.bfloat16) * 0.05)(D, 3 * D)),
            "wo": _w((lambda *s: torch.randn(*s, dtype=torch.bfloat16) * 0.05)(D, D)),
        }
    _A_in = _A_setup()

    def _B_setup():
        B, S, D, F = 1, 2048, 576, 4608
        return {
            "x": _w((lambda *s: torch.randn(*s, dtype=torch.bfloat16) * 0.05)(B, S, D)),
            "w_gate": _w((lambda *s: torch.randn(*s, dtype=torch.bfloat16) * 0.05)(D, F)),
            "w_up": _w((lambda *s: torch.randn(*s, dtype=torch.bfloat16) * 0.05)(D, F)),
            "w_down": _w((lambda *s: torch.randn(*s, dtype=torch.bfloat16) * 0.05)(F, D)),
        }
    _B_in = _B_setup()

    return {
        "A_x": _A_in["x"],
        "A_wqkv": _A_in["wqkv"],
        "A_wo": _A_in["wo"],
        "B_x": _B_in["x"],
        "B_w_gate": _B_in["w_gate"],
        "B_w_up": _B_in["w_up"],
        "B_w_down": _B_in["w_down"],
    }

def reference(A_x, A_wqkv, A_wo, B_x, B_w_gate, B_w_up, B_w_down):
    def _A_ref(x, wqkv, wo):
        B, S, D = x.shape
        H = 32; Dh = D // H
        qkv = (lambda x, *d: x.permute(*d))((x @ wqkv).reshape(B, S, 3, H, Dh), 2, 0, 3, 1, 4)
        q, k, v = qkv[0], qkv[1], qkv[2]
        scale = Dh ** -0.5
        scores = torch.einsum("bhqd,bhkd->bhqk", q, k) * scale
        p = _softmax(scores, axis=-1)
        o = torch.einsum("bhqk,bhkd->bhqd", p, v)
        return (lambda x, *d: x.permute(*d))(o, 0, 2, 1, 3).reshape(B, S, D) @ wo

    def _B_ref(x, w_gate, w_up, w_down):
        g = _silu(x @ w_gate)
        u = x @ w_up
        return (g * u) @ w_down

    x = A_x
    h = x + _A_ref(_layernorm(x, axis=-1), A_wqkv, A_wo)
    h2 = h + _B_ref(_layernorm(h, axis=-1), B_w_gate, B_w_up, B_w_down)
    return h2
```

```asm
; @launch grid=(256,1,1) block=(512,1,1) lds=163840
.amdgcn_target "amdgcn-amd-amdhsa--gfx950"
.text
.globl sequential_preLN__softmax_full_mha__swiglu_ffn__prompt_kernel
.p2align 8
.type sequential_preLN__softmax_full_mha__swiglu_ffn__prompt_kernel,@function
sequential_preLN__softmax_full_mha__swiglu_ffn__prompt_kernel:
    s_cmp_ge_u32 s2, 256
    s_cbranch_scc1 Lsequ_1
    s_load_dwordx4 s[4:7], s[0:1], 0
    s_load_dwordx4 s[8:11], s[0:1], 64
    v_and_b32 v1, 63, v0
    v_lshrrev_b32 v2, 6, v0
    v_lshrrev_b32 v5, 3, v1
    v_readfirstlane_b32 s24, v2
    v_and_b32 v6, 7, v1
    s_cmp_ge_u32 s2, 64
    s_cbranch_scc1 Lsequ_4
    s_getpc_b64 s[26:27]
Lsequential_preLN__softmax_full_mha__swiglu_ffn__prompt_pc:
    s_sub_u32 s26, s26, Lsequential_preLN__softmax_full_mha__swiglu_ffn__prompt_pc-sequential_preLN__softmax_full_mha__swiglu_ffn__prompt_kernel
    s_subb_u32 s27, s27, 0
    v_lshlrev_b32 v3, 7, v0
    v_min_u32 v4, ALL_CODE_END-sequential_preLN__softmax_full_mha__swiglu_ffn__prompt_kernel-4, v3
    s_cmp_lt_u32 s2, 56
    s_cbranch_scc1 Lsequ_8_n
    global_load_dword v63, v4, s[26:27]
Lsequ_8_n:
    s_mov_b32 s44, 0x3f803f80
    s_mov_b32 s45, 0xffff0000
    v_mov_b32 v2, 1073741824
    s_cmp_ge_u32 s2, 32
    s_cbranch_scc1 Lsequ_8
    s_lshl_b32 s30, s2, 3
    s_add_u32 s30, s30, s24
    s_mul_i32 s31, s30, 9216
    v_mul_u32_u24 v7, 1152, v5
    v_lshl_add_u32 v7, v6, 4, v7
    v_mov_b32 v4, 0
    v_mov_b32 v3, 0
    s_waitcnt lgkmcnt(0)
    s_mov_b32 s12, s4
    s_and_b32 s13, s5, 0xffff
    s_mov_b32 s14, 2359296
    s_mov_b32 s15, 0x00020000
    buffer_load_dwordx4 v[16:19], v7, s[12:15], s31 offen offset:0
    buffer_load_dwordx4 v[20:23], v7, s[12:15], s31 offen offset:128
    buffer_load_dwordx4 v[24:27], v7, s[12:15], s31 offen offset:256
    buffer_load_dwordx4 v[28:31], v7, s[12:15], s31 offen offset:384
    buffer_load_dwordx4 v[32:35], v7, s[12:15], s31 offen offset:512
    buffer_load_dwordx4 v[36:39], v7, s[12:15], s31 offen offset:640
    buffer_load_dwordx4 v[40:43], v7, s[12:15], s31 offen offset:768
    buffer_load_dwordx4 v[44:47], v7, s[12:15], s31 offen offset:896
    buffer_load_dwordx4 v[48:51], v7, s[12:15], s31 offen offset:1024
    s_mov_b32 s20, s10
    s_and_b32 s21, s11, 0xffff
    s_mov_b32 s22, 268435456
    s_mov_b32 s23, 0x00020000
    s_waitcnt vmcnt(8)
    v_dot2_f32_bf16 v4, v16, s44, v4
    v_dot2_f32_bf16 v3, v16, v16, v3
    v_dot2_f32_bf16 v4, v17, s44, v4
    v_dot2_f32_bf16 v3, v17, v17, v3
    v_dot2_f32_bf16 v4, v18, s44, v4
    v_dot2_f32_bf16 v3, v18, v18, v3
    v_dot2_f32_bf16 v4, v19, s44, v4
    v_dot2_f32_bf16 v3, v19, v19, v3
    s_waitcnt vmcnt(7)
    v_dot2_f32_bf16 v4, v20, s44, v4
    v_dot2_f32_bf16 v3, v20, v20, v3
    v_dot2_f32_bf16 v4, v21, s44, v4
    v_dot2_f32_bf16 v3, v21, v21, v3
    v_dot2_f32_bf16 v4, v22, s44, v4
    v_dot2_f32_bf16 v3, v22, v22, v3
    v_dot2_f32_bf16 v4, v23, s44, v4
    v_dot2_f32_bf16 v3, v23, v23, v3
    s_waitcnt vmcnt(6)
    v_dot2_f32_bf16 v4, v24, s44, v4
    v_dot2_f32_bf16 v3, v24, v24, v3
    v_dot2_f32_bf16 v4, v25, s44, v4
    v_dot2_f32_bf16 v3, v25, v25, v3
    v_dot2_f32_bf16 v4, v26, s44, v4
    v_dot2_f32_bf16 v3, v26, v26, v3
    v_dot2_f32_bf16 v4, v27, s44, v4
    v_dot2_f32_bf16 v3, v27, v27, v3
    s_waitcnt vmcnt(5)
    v_dot2_f32_bf16 v4, v28, s44, v4
    v_dot2_f32_bf16 v3, v28, v28, v3
    v_dot2_f32_bf16 v4, v29, s44, v4
    v_dot2_f32_bf16 v3, v29, v29, v3
    v_dot2_f32_bf16 v4, v30, s44, v4
    v_dot2_f32_bf16 v3, v30, v30, v3
    v_dot2_f32_bf16 v4, v31, s44, v4
    v_dot2_f32_bf16 v3, v31, v31, v3
    s_waitcnt vmcnt(4)
    v_dot2_f32_bf16 v4, v32, s44, v4
    v_dot2_f32_bf16 v3, v32, v32, v3
    v_dot2_f32_bf16 v4, v33, s44, v4
    v_dot2_f32_bf16 v3, v33, v33, v3
    v_dot2_f32_bf16 v4, v34, s44, v4
    v_dot2_f32_bf16 v3, v34, v34, v3
    v_dot2_f32_bf16 v4, v35, s44, v4
    v_dot2_f32_bf16 v3, v35, v35, v3
    s_waitcnt vmcnt(3)
    v_dot2_f32_bf16 v4, v36, s44, v4
    v_dot2_f32_bf16 v3, v36, v36, v3
    v_dot2_f32_bf16 v4, v37, s44, v4
    v_dot2_f32_bf16 v3, v37, v37, v3
    v_dot2_f32_bf16 v4, v38, s44, v4
    v_dot2_f32_bf16 v3, v38, v38, v3
    v_dot2_f32_bf16 v4, v39, s44, v4
    v_dot2_f32_bf16 v3, v39, v39, v3
    s_waitcnt vmcnt(2)
    v_dot2_f32_bf16 v4, v40, s44, v4
    v_dot2_f32_bf16 v3, v40, v40, v3
    v_dot2_f32_bf16 v4, v41, s44, v4
    v_dot2_f32_bf16 v3, v41, v41, v3
    v_dot2_f32_bf16 v4, v42, s44, v4
    v_dot2_f32_bf16 v3, v42, v42, v3
    v_dot2_f32_bf16 v4, v43, s44, v4
    v_dot2_f32_bf16 v3, v43, v43, v3
    s_waitcnt vmcnt(1)
    v_dot2_f32_bf16 v4, v44, s44, v4
    v_dot2_f32_bf16 v3, v44, v44, v3
    v_dot2_f32_bf16 v4, v45, s44, v4
    v_dot2_f32_bf16 v3, v45, v45, v3
    v_dot2_f32_bf16 v4, v46, s44, v4
    v_dot2_f32_bf16 v3, v46, v46, v3
    v_dot2_f32_bf16 v4, v47, s44, v4
    v_dot2_f32_bf16 v3, v47, v47, v3
    s_waitcnt vmcnt(0)
    v_dot2_f32_bf16 v4, v48, s44, v4
    v_dot2_f32_bf16 v3, v48, v48, v3
    v_dot2_f32_bf16 v4, v49, s44, v4
    v_dot2_f32_bf16 v3, v49, v49, v3
    v_dot2_f32_bf16 v4, v50, s44, v4
    v_dot2_f32_bf16 v3, v50, v50, v3
    v_dot2_f32_bf16 v4, v51, s44, v4
    v_dot2_f32_bf16 v3, v51, v51, v3
    s_nop 1
    v_add_f32_dpp v4, v4, v4 quad_perm:[1,0,3,2] row_mask:0xf bank_mask:0xf
    v_add_f32_dpp v3, v3, v3 quad_perm:[1,0,3,2] row_mask:0xf bank_mask:0xf
    s_nop 0
    v_add_f32_dpp v4, v4, v4 quad_perm:[2,3,0,1] row_mask:0xf bank_mask:0xf
    v_add_f32_dpp v3, v3, v3 quad_perm:[2,3,0,1] row_mask:0xf bank_mask:0xf
    s_nop 0
    v_add_f32_dpp v4, v4, v4 row_half_mirror row_mask:0xf bank_mask:0xf
    v_add_f32_dpp v3, v3, v3 row_half_mirror row_mask:0xf bank_mask:0xf
    v_mul_f32 v19, 0x3ae38e39, v4
    v_mul_f32 v3, 0x3ae38e39, v3
    v_fma_f32 v3, -v19, v19, v3
    v_max_f32 v3, 0, v3
    v_add_f32 v3, 0x3727c5ac, v3
    v_rsq_f32 v16, v3
    v_cvt_pk_bf16_f32 v17, -v19, -v19
    v_lshlrev_b32 v4, 16, v17
    v_add_f32 v4, v19, v4
    v_cvt_pk_bf16_f32 v18, -v4, 0
    v_lshlrev_b32 v8, 4, v5
    v_cmp_eq_u32 vcc, 0, v6
    s_nop 1
    v_cndmask_b32 v8, v2, v8, vcc
    s_lshl_b32 s31, s30, 7
    s_add_u32 s31, s31, 7479296
    buffer_store_dwordx4 v[16:19], v8, s[20:23], s31 offen sc1
    v_lshrrev_b32 v8, 2, v8
    s_lshl_b32 s31, s30, 5
    s_add_u32 s31, s31, 7340032
    buffer_store_dword v16, v8, s[20:23], s31 offen sc1
    s_branch Lsequ_11
Lsequ_8:
    s_cmp_ge_u32 s2, 59
    s_cbranch_scc1 Lsequ_9
    s_sub_u32 s30, s2, 32
    s_lshl_b32 s31, s30, 7
    s_mul_i32 s32, s24, 248832
    s_add_u32 s31, s31, s32
    v_mul_u32_u24 v7, 3456, v5
    v_lshl_add_u32 v7, v6, 4, v7
    s_waitcnt lgkmcnt(0)
    s_mov_b32 s16, s6
    s_and_b32 s17, s7, 0xffff
    s_mov_b32 s18, 1990656
    s_mov_b32 s19, 0x00020000
    buffer_load_dwordx4 v[16:19], v7, s[16:19], s31 offen
    s_add_u32 s31, s31, 27648
    buffer_load_dwordx4 v[20:23], v7, s[16:19], s31 offen
    s_add_u32 s31, s31, 27648
    buffer_load_dwordx4 v[24:27], v7, s[16:19], s31 offen
    s_add_u32 s31, s31, 27648
    buffer_load_dwordx4 v[28:31], v7, s[16:19], s31 offen
    s_add_u32 s31, s31, 27648
    buffer_load_dwordx4 v[32:35], v7, s[16:19], s31 offen
    s_add_u32 s31, s31, 27648
    buffer_load_dwordx4 v[36:39], v7, s[16:19], s31 offen
    s_add_u32 s31, s31, 27648
    buffer_load_dwordx4 v[40:43], v7, s[16:19], s31 offen
    s_add_u32 s31, s31, 27648
    buffer_load_dwordx4 v[44:47], v7, s[16:19], s31 offen
    s_add_u32 s31, s31, 27648
    buffer_load_dwordx4 v[48:51], v7, s[16:19], s31 offen
    s_add_u32 s31, s31, 27648
    s_mov_b32 s20, s10
    s_and_b32 s21, s11, 0xffff
    s_mov_b32 s22, 268435456
    s_mov_b32 s23, 0x00020000
    s_waitcnt vmcnt(8)
    v_lshlrev_b32 v64, 16, v16
    v_and_b32 v65, s45, v16
    v_lshlrev_b32 v66, 16, v17
    v_and_b32 v67, s45, v17
    v_lshlrev_b32 v68, 16, v18
    v_and_b32 v69, s45, v18
    v_lshlrev_b32 v70, 16, v19
    v_and_b32 v71, s45, v19
    s_waitcnt vmcnt(7)
    v_lshlrev_b32 v4, 16, v20
    v_and_b32 v3, s45, v20
    v_add_f32 v64, v64, v4
    v_add_f32 v65, v65, v3
    v_lshlrev_b32 v4, 16, v21
    v_and_b32 v3, s45, v21
    v_add_f32 v66, v66, v4
    v_add_f32 v67, v67, v3
    v_lshlrev_b32 v4, 16, v22
    v_and_b32 v3, s45, v22
    v_add_f32 v68, v68, v4
    v_add_f32 v69, v69, v3
    v_lshlrev_b32 v4, 16, v23
    v_and_b32 v3, s45, v23
    v_add_f32 v70, v70, v4
    v_add_f32 v71, v71, v3
    s_waitcnt vmcnt(6)
    v_lshlrev_b32 v4, 16, v24
    v_and_b32 v3, s45, v24
    v_add_f32 v64, v64, v4
    v_add_f32 v65, v65, v3
    v_lshlrev_b32 v4, 16, v25
    v_and_b32 v3, s45, v25
    v_add_f32 v66, v66, v4
    v_add_f32 v67, v67, v3
    v_lshlrev_b32 v4, 16, v26
    v_and_b32 v3, s45, v26
    v_add_f32 v68, v68, v4
    v_add_f32 v69, v69, v3
    v_lshlrev_b32 v4, 16, v27
    v_and_b32 v3, s45, v27
    v_add_f32 v70, v70, v4
    v_add_f32 v71, v71, v3
    s_waitcnt vmcnt(5)
    v_lshlrev_b32 v4, 16, v28
    v_and_b32 v3, s45, v28
    v_add_f32 v64, v64, v4
    v_add_f32 v65, v65, v3
    v_lshlrev_b32 v4, 16, v29
    v_and_b32 v3, s45, v29
    v_add_f32 v66, v66, v4
    v_add_f32 v67, v67, v3
    v_lshlrev_b32 v4, 16, v30
    v_and_b32 v3, s45, v30
    v_add_f32 v68, v68, v4
    v_add_f32 v69, v69, v3
    v_lshlrev_b32 v4, 16, v31
    v_and_b32 v3, s45, v31
    v_add_f32 v70, v70, v4
    v_add_f32 v71, v71, v3
    s_waitcnt vmcnt(4)
    v_lshlrev_b32 v4, 16, v32
    v_and_b32 v3, s45, v32
    v_add_f32 v64, v64, v4
    v_add_f32 v65, v65, v3
    v_lshlrev_b32 v4, 16, v33
    v_and_b32 v3, s45, v33
    v_add_f32 v66, v66, v4
    v_add_f32 v67, v67, v3
    v_lshlrev_b32 v4, 16, v34
    v_and_b32 v3, s45, v34
    v_add_f32 v68, v68, v4
    v_add_f32 v69, v69, v3
    v_lshlrev_b32 v4, 16, v35
    v_and_b32 v3, s45, v35
    v_add_f32 v70, v70, v4
    v_add_f32 v71, v71, v3
    s_waitcnt vmcnt(3)
    v_lshlrev_b32 v4, 16, v36
    v_and_b32 v3, s45, v36
    v_add_f32 v64, v64, v4
    v_add_f32 v65, v65, v3
    v_lshlrev_b32 v4, 16, v37
    v_and_b32 v3, s45, v37
    v_add_f32 v66, v66, v4
    v_add_f32 v67, v67, v3
    v_lshlrev_b32 v4, 16, v38
    v_and_b32 v3, s45, v38
    v_add_f32 v68, v68, v4
    v_add_f32 v69, v69, v3
    v_lshlrev_b32 v4, 16, v39
    v_and_b32 v3, s45, v39
    v_add_f32 v70, v70, v4
    v_add_f32 v71, v71, v3
    s_waitcnt vmcnt(2)
    v_lshlrev_b32 v4, 16, v40
    v_and_b32 v3, s45, v40
    v_add_f32 v64, v64, v4
    v_add_f32 v65, v65, v3
    v_lshlrev_b32 v4, 16, v41
    v_and_b32 v3, s45, v41
    v_add_f32 v66, v66, v4
    v_add_f32 v67, v67, v3
    v_lshlrev_b32 v4, 16, v42
    v_and_b32 v3, s45, v42
    v_add_f32 v68, v68, v4
    v_add_f32 v69, v69, v3
    v_lshlrev_b32 v4, 16, v43
    v_and_b32 v3, s45, v43
    v_add_f32 v70, v70, v4
    v_add_f32 v71, v71, v3
    s_waitcnt vmcnt(1)
    v_lshlrev_b32 v4, 16, v44
    v_and_b32 v3, s45, v44
    v_add_f32 v64, v64, v4
    v_add_f32 v65, v65, v3
    v_lshlrev_b32 v4, 16, v45
    v_and_b32 v3, s45, v45
    v_add_f32 v66, v66, v4
    v_add_f32 v67, v67, v3
    v_lshlrev_b32 v4, 16, v46
    v_and_b32 v3, s45, v46
    v_add_f32 v68, v68, v4
    v_add_f32 v69, v69, v3
    v_lshlrev_b32 v4, 16, v47
    v_and_b32 v3, s45, v47
    v_add_f32 v70, v70, v4
    v_add_f32 v71, v71, v3
    s_waitcnt vmcnt(0)
    v_lshlrev_b32 v4, 16, v48
    v_and_b32 v3, s45, v48
    v_add_f32 v64, v64, v4
    v_add_f32 v65, v65, v3
    v_lshlrev_b32 v4, 16, v49
    v_and_b32 v3, s45, v49
    v_add_f32 v66, v66, v4
    v_add_f32 v67, v67, v3
    v_lshlrev_b32 v4, 16, v50
    v_and_b32 v3, s45, v50
    v_add_f32 v68, v68, v4
    v_add_f32 v69, v69, v3
    v_lshlrev_b32 v4, 16, v51
    v_and_b32 v3, s45, v51
    v_add_f32 v70, v70, v4
    v_add_f32 v71, v71, v3
    s_lshl_b32 s32, s24, 11
    v_lshlrev_b32 v8, 5, v1
    v_add_u32 v8, s32, v8
    ds_write_b128 v8, v[64:67]
    ds_write_b128 v8, v[68:71] offset:16
    v_lshlrev_b32 v8, 2, v1
    v_add_u32 v8, s32, v8
    ds_read_b32 v16, v8 offset:0
    ds_read_b32 v17, v8 offset:256
    ds_read_b32 v18, v8 offset:512
    ds_read_b32 v19, v8 offset:768
    ds_read_b32 v20, v8 offset:1024
    ds_read_b32 v21, v8 offset:1280
    ds_read_b32 v22, v8 offset:1536
    ds_read_b32 v23, v8 offset:1792
    s_waitcnt lgkmcnt(0)
    v_add_f32 v16, v16, v17
    v_add_f32 v16, v16, v18
    v_add_f32 v16, v16, v19
    v_add_f32 v16, v16, v20
    v_add_f32 v16, v16, v21
    v_add_f32 v16, v16, v22
    v_add_f32 v16, v16, v23
    s_lshl_b32 s32, s24, 8
    v_lshlrev_b32 v8, 2, v1
    v_add_u32 v10, s32, v8
    ds_write_b32 v10, v16 offset:16384
    s_waitcnt lgkmcnt(0)
    s_barrier
    s_cmp_lg_u32 s24, 4
    s_cbranch_scc1 Lsequ_2
    ds_read_b32 v16, v8 offset:16384
    ds_read_b32 v17, v8 offset:16640
    ds_read_b32 v18, v8 offset:16896
    ds_read_b32 v19, v8 offset:17152
    ds_read_b32 v20, v8 offset:17408
    ds_read_b32 v21, v8 offset:17664
    ds_read_b32 v22, v8 offset:17920
    ds_read_b32 v23, v8 offset:18176
    s_waitcnt lgkmcnt(0)
    v_add_f32 v16, v16, v17
    v_add_f32 v16, v16, v18
    v_add_f32 v16, v16, v19
    v_add_f32 v16, v16, v20
    v_add_f32 v16, v16, v21
    v_add_f32 v16, v16, v22
    v_add_f32 v16, v16, v23
    v_cvt_pk_bf16_f32 v19, v16, 0
    v_lshlrev_b32 v17, 16, v19
    v_sub_f32 v16, v16, v17
    v_cvt_pk_bf16_f32 v18, v17, v16
    v_lshlrev_b32 v8, 3, v1
    s_lshl_b32 s31, s30, 9
    s_add_u32 s31, s31, 7512064
    buffer_store_dwordx2 v[18:19], v8, s[20:23], s31 offen sc1
    s_waitcnt vmcnt(0)
    s_branch Lsequ_10
Lsequ_9:
    s_waitcnt lgkmcnt(0)
    s_mov_b32 s20, s10
    s_and_b32 s21, s11, 0xffff
    s_mov_b32 s22, 268435456
    s_mov_b32 s23, 0x00020000
    s_cmp_lg_u32 s2, 63
    s_cbranch_scc1 Lsequ_11
    v_mov_b32 v3, 0
    v_lshlrev_b32 v4, 7, v0
    s_mov_b32 s30, 7348224
    buffer_store_dword v3, v4, s[20:23], s30 offen sc1
    s_mov_b32 s30, 7413760
    buffer_store_dword v3, v4, s[20:23], s30 offen sc1
Lsequ_11:
    s_waitcnt vmcnt(0)
    s_barrier
    s_cmp_lg_u32 s24, 4
    s_cbranch_scc1 Lsequ_2
Lsequ_10:
    s_mov_b32 s40, s8
    s_and_b32 s41, s9, 0xffff
    s_mov_b32 s42, 256
    s_mov_b32 s43, 0x00020000
    v_cmp_eq_u32 vcc, 0, v1
    s_nop 1
    v_cndmask_b32 v14, v2, v1, vcc
    v_mov_b32 v3, 1
    buffer_atomic_add v3, v14, s[40:43], 0 offen offset:0 sc0 sc1
    s_waitcnt vmcnt(0)
    v_readfirstlane_b32 s50, v3
    s_nop 1
    s_cmp_lg_u32 s50, 63
    s_cbranch_scc1 Lsequ_12
    v_mov_b32 v3, 1
    buffer_store_dword v3, v14, s[40:43], 0 offen offset:128 sc1
Lsequ_12:
    s_branch Lsequ_2
Lsequ_4:
    s_and_b32 s25, s2, 7
    s_lshr_b32 s28, s2, 3
    s_sub_u32 s28, s28, 8
    s_lshr_b32 s29, s25, 1
    s_lshl_b32 s29, s29, 2
    s_and_b32 s30, s28, 3
    s_add_u32 s29, s29, s30
    s_and_b32 s30, s25, 1
    s_mul_i32 s30, s30, 6
    s_lshr_b32 s31, s28, 2
    s_add_u32 s30, s30, s31
    s_cmp_lt_u32 s24, 4
    s_cbranch_scc1 Lsequ_3
    s_setprio 3
    s_sub_u32 s63, s24, 4
    v_lshrrev_b32 v7, 4, v1
    v_xor_b32 v8, v6, v7
    v_mul_u32_u24 v9, 1152, v5
    v_lshl_add_u32 v40, v8, 4, v9
    v_xor_b32 v41, 64, v40
    v_add_u32 v41, 9216, v41
    v_add_u32 v42, 18432, v40
    v_add_u32 v43, 18432, v41
    s_lshl_b32 s31, s29, 2
    s_add_u32 s31, s31, s63
    s_mul_i32 s56, s31, 36864
    s_lshl_b32 s33, s63, 12
    s_mul_i32 s57, s63, 55296
    s_mul_i32 s42, s30, 288
    s_add_u32 s57, s57, s42
    s_mul_i32 s43, s63, 5120
    s_add_u32 s43, s43, 16384
    v_add_u32 v10, 0, v1
    v_mul_u32_u24 v11, 3277, v10
    v_lshrrev_b32 v11, 16, v11
    v_mul_u32_u24 v12, 20, v11
    v_sub_u32 v10, v10, v12
    v_mul_u32_u24 v11, 3456, v11
    v_lshrrev_b32 v12, 1, v10
    v_mul_u32_u24 v13, 36, v12
    v_and_b32 v12, 1, v12
    v_lshl_add_u32 v13, v12, 2, v13
    v_and_b32 v12, 1, v10
    v_lshl_add_u32 v13, v12, 4, v13
    v_cmp_gt_u32 vcc, 16, v10
    v_mul_u32_u24 v12, 72, v10
    v_subrev_u32 v12, 1120, v12
    v_cndmask_b32 v12, v12, v13, vcc
    v_add_u32 v44, v11, v12
    v_add_u32 v10, 64, v1
    v_mul_u32_u24 v11, 3277, v10
    v_lshrrev_b32 v11, 16, v11
    v_mul_u32_u24 v12, 20, v11
    v_sub_u32 v10, v10, v12
    v_mul_u32_u24 v11, 3456, v11
    v_lshrrev_b32 v12, 1, v10
    v_mul_u32_u24 v13, 36, v12
    v_and_b32 v12, 1, v12
    v_lshl_add_u32 v13, v12, 2, v13
    v_and_b32 v12, 1, v10
    v_lshl_add_u32 v13, v12, 4, v13
    v_cmp_gt_u32 vcc, 16, v10
    v_mul_u32_u24 v12, 72, v10
    v_subrev_u32 v12, 1120, v12
    v_cndmask_b32 v12, v12, v13, vcc
    v_add_u32 v45, v11, v12
    v_add_u32 v10, 128, v1
    v_mul_u32_u24 v11, 3277, v10
    v_lshrrev_b32 v11, 16, v11
    v_mul_u32_u24 v12, 20, v11
    v_sub_u32 v10, v10, v12
    v_mul_u32_u24 v11, 3456, v11
    v_lshrrev_b32 v12, 1, v10
    v_mul_u32_u24 v13, 36, v12
    v_and_b32 v12, 1, v12
    v_lshl_add_u32 v13, v12, 2, v13
    v_and_b32 v12, 1, v10
    v_lshl_add_u32 v13, v12, 4, v13
    v_cmp_gt_u32 vcc, 16, v10
    v_mul_u32_u24 v12, 72, v10
    v_subrev_u32 v12, 1120, v12
    v_cndmask_b32 v12, v12, v13, vcc
    v_add_u32 v46, v11, v12
    v_add_u32 v10, 192, v1
    v_mul_u32_u24 v11, 3277, v10
    v_lshrrev_b32 v11, 16, v11
    v_mul_u32_u24 v12, 20, v11
    v_sub_u32 v10, v10, v12
    v_mul_u32_u24 v11, 3456, v11
    v_lshrrev_b32 v12, 1, v10
    v_mul_u32_u24 v13, 36, v12
    v_and_b32 v12, 1, v12
    v_lshl_add_u32 v13, v12, 2, v13
    v_and_b32 v12, 1, v10
    v_lshl_add_u32 v13, v12, 4, v13
    v_cmp_gt_u32 vcc, 16, v10
    v_mul_u32_u24 v12, 72, v10
    v_subrev_u32 v12, 1120, v12
    v_cndmask_b32 v12, v12, v13, vcc
    v_add_u32 v47, v11, v12
    v_add_u32 v10, 256, v1
    v_mul_u32_u24 v11, 3277, v10
    v_lshrrev_b32 v11, 16, v11
    v_mul_u32_u24 v12, 20, v11
    v_sub_u32 v10, v10, v12
    v_mul_u32_u24 v11, 3456, v11
    v_lshrrev_b32 v12, 1, v10
    v_mul_u32_u24 v13, 36, v12
    v_and_b32 v12, 1, v12
    v_lshl_add_u32 v13, v12, 2, v13
    v_and_b32 v12, 1, v10
    v_lshl_add_u32 v13, v12, 4, v13
    v_cmp_gt_u32 vcc, 16, v10
    v_mul_u32_u24 v12, 72, v10
    v_subrev_u32 v12, 1120, v12
    v_cndmask_b32 v12, v12, v13, vcc
    v_add_u32 v48, v11, v12
    s_waitcnt lgkmcnt(0)
    s_mov_b32 s12, s4
    s_and_b32 s13, s5, 0xffff
    s_mov_b32 s14, 2359296
    s_mov_b32 s15, 0x00020000
    s_mov_b32 s16, s6
    s_and_b32 s17, s7, 0xffff
    s_mov_b32 s18, 1990656
    s_mov_b32 s19, 0x00020000
    s_mov_b32 s54, 0
    s_mov_b32 s55, 0
Lsequ_13:
    s_add_u32 s58, s54, s33
    s_add_u32 s59, s54, s43
    s_add_u32 m0, s58, 0
    s_nop 0
    buffer_load_dwordx4 v40, s[12:15], s56 offen lds
    s_add_u32 m0, s58, 1024
    s_nop 0
    buffer_load_dwordx4 v41, s[12:15], s56 offen lds
    s_add_u32 m0, s58, 2048
    s_nop 0
    buffer_load_dwordx4 v42, s[12:15], s56 offen lds
    s_add_u32 m0, s58, 3072
    s_nop 0
    buffer_load_dwordx4 v43, s[12:15], s56 offen lds
    s_add_u32 m0, s59, 0
    s_nop 0
    buffer_load_dwordx4 v44, s[16:19], s57 offen lds
    s_add_u32 m0, s59, 1024
    s_nop 0
    buffer_load_dwordx4 v45, s[16:19], s57 offen lds
    s_add_u32 m0, s59, 2048
    s_nop 0
    buffer_load_dwordx4 v46, s[16:19], s57 offen lds
    s_add_u32 m0, s59, 3072
    s_nop 0
    buffer_load_dwordx4 v47, s[16:19], s57 offen lds
    s_add_u32 m0, s59, 4096
    s_nop 0
    buffer_load_dwordx4 v48, s[16:19], s57 offen lds
    s_add_u32 s56, s56, 128
    s_add_u32 s57, s57, 221184
    s_add_u32 s54, s54, 36864
    s_cmp_eq_u32 s54, 147456
    s_cselect_b32 s54, 0, s54
    s_bitcmp1_b32 5, s55
    s_cbranch_scc1 Lsequ_14
    s_cmp_eq_u32 s55, 1
    s_cbranch_scc0 Lsequ_14_a
    s_waitcnt vmcnt(9)
Lsequ_14_a:
    s_waitcnt vmcnt(18)
    s_barrier
Lsequ_14:
    s_add_u32 s55, s55, 1
    s_cmp_lt_u32 s55, 9
    s_cbranch_scc1 Lsequ_13
    s_waitcnt vmcnt(9)
    s_barrier
    s_waitcnt vmcnt(0)
    s_barrier
    s_mov_b32 s20, s10
    s_and_b32 s21, s11, 0xffff
    s_mov_b32 s22, 268435456
    s_mov_b32 s23, 0x00020000
    s_branch Lsequ_6
Lsequ_3:
    v_and_b32 v11, 31, v1
    v_lshrrev_b32 v12, 5, v1
    v_bfe_u32 v13, v1, 1, 3
    v_xor_b32 v13, v13, v12
    v_lshlrev_b32 v13, 4, v13
    v_lshl_add_u32 v13, v11, 7, v13
    s_lshl_b32 s49, s24, 12
    v_add_u32 v16, s49, v13
    v_xor_b32 v17, 32, v16
    v_xor_b32 v18, 64, v16
    v_xor_b32 v19, 96, v16
    v_bfe_u32 v13, v1, 2, 2
    v_lshl_add_u32 v13, v12, 3, v13
    v_mul_u32_u24 v13, 320, v13
    v_and_b32 v14, 3, v1
    v_bfe_u32 v15, v1, 4, 1
    v_lshlrev_b32 v20, 5, v15
    v_lshl_add_u32 v20, v14, 3, v20
    v_add_u32 v20, v20, v13
    v_add_u32 v20, 16384, v20
    v_lshl_add_u32 v21, v14, 4, v13
    v_add_u32 v21, 16640, v21
    s_lshl_b32 s31, s29, 2
    s_add_u32 s31, s31, s24
    v_mul_u32_u24 v6, 20, v15
    v_and_b32 v7, 15, v11
    v_add_lshl_u32 v22, v6, v7, 3
    v_bfe_u32 v6, v11, 2, 2
    v_mul_u32_u24 v6, 36, v6
    v_add3_u32 v6, v6, v14, 16
    v_lshlrev_b32 v23, 3, v6
    v_lshlrev_b32 v24, 4, v11
    v_lshlrev_b32 v25, 4, v12
    v_cmp_gt_u32 s[52:53], 32, v1
    v_mov_b32 v29, 0
    s_lshl_b32 s32, s31, 9
    s_add_u32 s32, s32, 7479296
    s_mul_i32 s33, s30, 1152
    s_add_u32 s33, s33, 7512064
    s_lshl_b32 s34, s31, 7
    s_add_u32 s34, s34, 7340032
    s_and_b32 s49, s30, 3
    s_lshl_b32 s49, s49, 3
    s_mov_b32 s56, 155648
    s_mov_b32 s57, 2432
    s_mov_b32 s58, 0
    s_mov_b32 s54, 1.0
    s_cmp_lt_u32 s30, 4
    s_cmov_b32 s56, 73728
    s_cmov_b32 s57, 1152
    s_cmov_b32 s58, 4980736
    s_cmov_b32 s54, 0x3eae1a93
    s_mul_i32 s49, s49, s56
    s_mul_i32 s57, s57, s31
    s_add_u32 s49, s49, s57
    s_add_u32 s49, s49, s58
    s_mov_b32 s35, s49
    v_mov_b32 v48, 0
    v_mov_b32 v49, 0
    v_mov_b32 v50, 0
    v_mov_b32 v51, 0
    v_mov_b32 v52, 0
    v_mov_b32 v53, 0
    v_mov_b32 v54, 0
    v_mov_b32 v55, 0
    v_mov_b32 v56, 0
    v_mov_b32 v57, 0
    v_mov_b32 v58, 0
    v_mov_b32 v59, 0
    v_mov_b32 v60, 0
    v_mov_b32 v61, 0
    v_mov_b32 v62, 0
    v_mov_b32 v63, 0
    v_mov_b32 v64, 0
    v_mov_b32 v65, 0
    v_mov_b32 v66, 0
    v_mov_b32 v67, 0
    v_mov_b32 v68, 0
    v_mov_b32 v69, 0
    v_mov_b32 v70, 0
    v_mov_b32 v71, 0
    v_mov_b32 v72, 0
    v_mov_b32 v73, 0
    v_mov_b32 v74, 0
    v_mov_b32 v75, 0
    v_mov_b32 v76, 0
    v_mov_b32 v77, 0
    v_mov_b32 v78, 0
    v_mov_b32 v79, 0
    v_mov_b32 v80, 0
    v_mov_b32 v81, 0
    v_mov_b32 v82, 0
    v_mov_b32 v83, 0
    v_mov_b32 v84, 0
    v_mov_b32 v85, 0
    v_mov_b32 v86, 0
    v_mov_b32 v87, 0
    v_mov_b32 v88, 0
    v_mov_b32 v89, 0
    v_mov_b32 v90, 0
    v_mov_b32 v91, 0
    v_mov_b32 v92, 0
    v_mov_b32 v93, 0
    v_mov_b32 v94, 0
    v_mov_b32 v95, 0
    v_mov_b32 v96, 0
    v_mov_b32 v97, 0
    v_mov_b32 v98, 0
    v_mov_b32 v99, 0
    v_mov_b32 v100, 0
    v_mov_b32 v101, 0
    v_mov_b32 v102, 0
    v_mov_b32 v103, 0
    v_mov_b32 v104, 0
    v_mov_b32 v105, 0
    v_mov_b32 v106, 0
    v_mov_b32 v107, 0
    v_mov_b32 v108, 0
    v_mov_b32 v109, 0
    v_mov_b32 v110, 0
    v_mov_b32 v111, 0
    v_mov_b32 v112, 0
    v_mov_b32 v113, 0
    v_mov_b32 v114, 0
    v_mov_b32 v115, 0
    v_mov_b32 v116, 0
    v_mov_b32 v117, 0
    v_mov_b32 v118, 0
    v_mov_b32 v119, 0
    v_mov_b32 v120, 0
    v_mov_b32 v121, 0
    v_mov_b32 v122, 0
    v_mov_b32 v123, 0
    v_mov_b32 v124, 0
    v_mov_b32 v125, 0
    v_mov_b32 v126, 0
    v_mov_b32 v127, 0
    v_accvgpr_write_b32 a66, 0
    v_accvgpr_write_b32 a67, 0
    v_accvgpr_write_b32 a70, 0
    v_accvgpr_write_b32 a71, 0
    v_accvgpr_write_b32 a74, 0
    v_accvgpr_write_b32 a75, 0
    v_accvgpr_write_b32 a78, 0
    v_accvgpr_write_b32 a79, 0
    v_accvgpr_write_b32 a82, 0
    v_accvgpr_write_b32 a83, 0
    v_mov_b32 v38, 0
    v_mov_b32 v39, 0
    s_waitcnt lgkmcnt(0)
    s_mov_b32 s20, s10
    s_and_b32 s21, s11, 0xffff
    s_mov_b32 s22, 268435456
    s_mov_b32 s23, 0x00020000
    s_mov_b32 s40, s8
    s_and_b32 s41, s9, 0xffff
    s_mov_b32 s42, 256
    s_mov_b32 s43, 0x00020000
    s_cmp_ge_u32 s30, 8
    s_cbranch_scc1 Lsequ_15
    v_lshlrev_b32 v8, 4, v1
    v_mul_lo_u32 v9, v12, s56
    v_lshlrev_b32 v9, 1, v9
    v_lshl_add_u32 v9, v11, 2, v9
    s_barrier
    ds_read_b128 a[0:3], v16
    ds_read_b64_tr_b16 a[8:9], v20 offset:0
    ds_read_b64_tr_b16 a[10:11], v20 offset:1280
    ds_read_b64_tr_b16 a[12:13], v20 offset:64
    ds_read_b64_tr_b16 a[14:15], v20 offset:1344
    ds_read_b64_tr_b16 a[16:17], v20 offset:128
    ds_read_b64_tr_b16 a[18:19], v20 offset:1408
    ds_read_b64_tr_b16 a[20:21], v20 offset:192
    ds_read_b64_tr_b16 a[22:23], v20 offset:1472
    ds_read_b64_tr_b16 a[24:25], v21 offset:0
    ds_read_b64_tr_b16 a[26:27], v21 offset:1280
    s_mov_b32 s60, 0
    s_mov_b32 s61, 0
.p2align 6
Lsequ_17:
    s_add_u32 s61, s61, 1
    s_cmp_eq_u32 s61, 4
    s_cselect_b32 s61, 0, s61
    s_mov_b32 s59, 36864
    s_cselect_b32 s59, 4294856704, s59
    s_waitcnt lgkmcnt(8)
    v_mfma_f32_32x32x16_bf16 v[48:63], a[8:11], a[0:3], v[48:63]
    ds_read_b128 a[4:7], v17
    ds_read_b64_tr_b16 a[28:29], v20 offset:5120
    ds_read_b64_tr_b16 a[30:31], v20 offset:6400
    s_waitcnt lgkmcnt(9)
    v_mfma_f32_32x32x16_bf16 v[64:79], a[12:15], a[0:3], v[64:79]
    ds_read_b64_tr_b16 a[32:33], v20 offset:5184
    ds_read_b64_tr_b16 a[34:35], v20 offset:6464
    ds_read_b64_tr_b16 a[36:37], v20 offset:5248
    s_waitcnt lgkmcnt(10)
    v_mfma_f32_32x32x16_bf16 v[80:95], a[16:19], a[0:3], v[80:95]
    ds_read_b64_tr_b16 a[38:39], v20 offset:6528
    ds_read_b64_tr_b16 a[40:41], v20 offset:5312
    ds_read_b64_tr_b16 a[42:43], v20 offset:6592
    s_waitcnt lgkmcnt(11)
    v_mfma_f32_32x32x16_bf16 v[96:111], a[20:23], a[0:3], v[96:111]
    ds_read_b64_tr_b16 a[44:45], v21 offset:5120
    ds_read_b64_tr_b16 a[46:47], v21 offset:6400
    s_waitcnt lgkmcnt(11)
    v_mfma_f32_32x32x16_bf16 v[112:127], a[24:27], a[0:3], v[112:127]
    v_add_u32 v16, s59, v16
    s_waitcnt lgkmcnt(8)
    v_mfma_f32_32x32x16_bf16 v[48:63], a[28:31], a[4:7], v[48:63]
    ds_read_b128 a[0:3], v18
    ds_read_b64_tr_b16 a[8:9], v20 offset:10240
    ds_read_b64_tr_b16 a[10:11], v20 offset:11520
    s_waitcnt lgkmcnt(9)
    v_mfma_f32_32x32x16_bf16 v[64:79], a[32:35], a[4:7], v[64:79]
    ds_read_b64_tr_b16 a[12:13], v20 offset:10304
    ds_read_b64_tr_b16 a[14:15], v20 offset:11584
    ds_read_b64_tr_b16 a[16:17], v20 offset:10368
    s_waitcnt lgkmcnt(10)
    v_mfma_f32_32x32x16_bf16 v[80:95], a[36:39], a[4:7], v[80:95]
    ds_read_b64_tr_b16 a[18:19], v20 offset:11648
    ds_read_b64_tr_b16 a[20:21], v20 offset:10432
    ds_read_b64_tr_b16 a[22:23], v20 offset:11712
    s_waitcnt lgkmcnt(11)
    v_mfma_f32_32x32x16_bf16 v[96:111], a[40:43], a[4:7], v[96:111]
    ds_read_b64_tr_b16 a[24:25], v21 offset:10240
    ds_read_b64_tr_b16 a[26:27], v21 offset:11520
    s_waitcnt lgkmcnt(11)
    v_mfma_f32_32x32x16_bf16 v[112:127], a[44:47], a[4:7], v[112:127]
    v_add_u32 v17, s59, v17
    s_waitcnt lgkmcnt(8)
    v_mfma_f32_32x32x16_bf16 v[48:63], a[8:11], a[0:3], v[48:63]
    ds_read_b128 a[4:7], v19
    ds_read_b64_tr_b16 a[28:29], v20 offset:15360
    ds_read_b64_tr_b16 a[30:31], v20 offset:16640
    s_waitcnt lgkmcnt(9)
    v_mfma_f32_32x32x16_bf16 v[64:79], a[12:15], a[0:3], v[64:79]
    ds_read_b64_tr_b16 a[32:33], v20 offset:15424
    ds_read_b64_tr_b16 a[34:35], v20 offset:16704
    ds_read_b64_tr_b16 a[36:37], v20 offset:15488
    s_waitcnt lgkmcnt(10)
    v_mfma_f32_32x32x16_bf16 v[80:95], a[16:19], a[0:3], v[80:95]
    ds_read_b64_tr_b16 a[38:39], v20 offset:16768
    ds_read_b64_tr_b16 a[40:41], v20 offset:15552
    ds_read_b64_tr_b16 a[42:43], v20 offset:16832
    s_waitcnt lgkmcnt(11)
    v_mfma_f32_32x32x16_bf16 v[96:111], a[20:23], a[0:3], v[96:111]
    ds_read_b64_tr_b16 a[44:45], v21 offset:15360
    ds_read_b64_tr_b16 a[46:47], v21 offset:16640
    s_waitcnt lgkmcnt(11)
    v_mfma_f32_32x32x16_bf16 v[112:127], a[24:27], a[0:3], v[112:127]
    v_add_u32 v18, s59, v18
    v_add_u32 v20, s59, v20
    v_add_u32 v21, s59, v21
    s_waitcnt lgkmcnt(0)
    s_barrier
    v_mfma_f32_32x32x16_bf16 v[48:63], a[28:31], a[4:7], v[48:63]
    ds_read_b128 a[0:3], v16
    ds_read_b64_tr_b16 a[8:9], v20 offset:0
    ds_read_b64_tr_b16 a[10:11], v20 offset:1280
    v_mfma_f32_32x32x16_bf16 v[64:79], a[32:35], a[4:7], v[64:79]
    ds_read_b64_tr_b16 a[12:13], v20 offset:64
    ds_read_b64_tr_b16 a[14:15], v20 offset:1344
    ds_read_b64_tr_b16 a[16:17], v20 offset:128
    v_mfma_f32_32x32x16_bf16 v[80:95], a[36:39], a[4:7], v[80:95]
    ds_read_b64_tr_b16 a[18:19], v20 offset:1408
    ds_read_b64_tr_b16 a[20:21], v20 offset:192
    ds_read_b64_tr_b16 a[22:23], v20 offset:1472
    v_mfma_f32_32x32x16_bf16 v[96:111], a[40:43], a[4:7], v[96:111]
    ds_read_b64_tr_b16 a[24:25], v21 offset:0
    ds_read_b64_tr_b16 a[26:27], v21 offset:1280
    v_mfma_f32_32x32x16_bf16 v[112:127], a[44:47], a[4:7], v[112:127]
    v_add_u32 v19, s59, v19
    s_add_u32 s60, s60, 1
    s_cmp_lt_u32 s60, 6
    s_cbranch_scc1 Lsequ_17
    s_cmp_gt_u32 s60, 8
    s_cbranch_scc1 Lsequ_19
    s_cmp_eq_u32 s60, 8
    s_cbranch_scc1 Lsequ_18_go
    s_cmp_lg_u32 s24, 3
    s_cbranch_scc1 Lsequ_17
    s_cmp_eq_u32 s60, 7
    s_cbranch_scc1 Lsequ_18_chk
    buffer_load_dword v30, v29, s[40:43], 0 offen offset:128 sc1
    s_mov_b32 s55, 0
    s_branch Lsequ_17
Lsequ_18_again:
    s_sleep 1
    buffer_load_dword v30, v29, s[40:43], 0 offen offset:128 sc1
Lsequ_18_chk:
    s_waitcnt vmcnt(0)
    v_readfirstlane_b32 s50, v30
    s_add_u32 s55, s55, 1
    s_cmp_ge_u32 s55, 200000
    s_cbranch_scc1 Lsequ_17
    s_cmp_lt_u32 s50, 1
    s_cbranch_scc1 Lsequ_18_again
    s_branch Lsequ_17
Lsequ_18_go:
    buffer_load_dwordx4 v[32:35], v24, s[20:23], s32 offen sc1
    buffer_load_dwordx2 a[64:65], v22, s[20:23], s33 offen offset:0 sc1
    buffer_load_dwordx2 a[68:69], v22, s[20:23], s33 offen offset:288 sc1
    buffer_load_dwordx2 a[72:73], v22, s[20:23], s33 offen offset:576 sc1
    buffer_load_dwordx2 a[76:77], v22, s[20:23], s33 offen offset:864 sc1
    buffer_load_dwordx2 a[80:81], v23, s[20:23], s33 offen offset:0 sc1
    s_branch Lsequ_17
Lsequ_19:
    s_waitcnt vmcnt(0)
    v_cndmask_b32 v36, 0, v33, s[52:53]
    v_cndmask_b32 v37, 0, v34, s[52:53]
    v_mul_f32 v16, s54, v32
    s_nop 0
    v_mfma_f32_32x32x16_bf16 v[48:63], a[64:67], v[36:39], v[48:63]
    v_mfma_f32_32x32x16_bf16 v[64:79], a[68:71], v[36:39], v[64:79]
    v_mfma_f32_32x32x16_bf16 v[80:95], a[72:75], v[36:39], v[80:95]
    v_mfma_f32_32x32x16_bf16 v[96:111], a[76:79], v[36:39], v[96:111]
    v_mfma_f32_32x32x16_bf16 v[112:127], a[80:83], v[36:39], v[112:127]
    s_nop 7
    v_mul_f32 v48, v48, v16
    v_mul_f32 v49, v49, v16
    v_mul_f32 v50, v50, v16
    v_mul_f32 v51, v51, v16
    v_mul_f32 v52, v52, v16
    v_mul_f32 v53, v53, v16
    v_mul_f32 v54, v54, v16
    v_mul_f32 v55, v55, v16
    v_cvt_pk_bf16_f32 v48, v48, v49
    v_cvt_pk_bf16_f32 v49, v50, v51
    v_cvt_pk_bf16_f32 v50, v52, v53
    v_cvt_pk_bf16_f32 v51, v54, v55
    buffer_store_dwordx4 v[48:51], v8, s[20:23], s35 offen sc1
    s_add_u32 s35, s35, s56
    v_mul_f32 v56, v56, v16
    v_mul_f32 v57, v57, v16
    v_mul_f32 v58, v58, v16
    v_mul_f32 v59, v59, v16
    v_mul_f32 v60, v60, v16
    v_mul_f32 v61, v61, v16
    v_mul_f32 v62, v62, v16
    v_mul_f32 v63, v63, v16
    v_cvt_pk_bf16_f32 v56, v56, v57
    v_cvt_pk_bf16_f32 v57, v58, v59
    v_cvt_pk_bf16_f32 v58, v60, v61
    v_cvt_pk_bf16_f32 v59, v62, v63
    buffer_store_dwordx4 v[56:59], v8, s[20:23], s35 offen sc1
    s_add_u32 s35, s35, s56
    v_mul_f32 v64, v64, v16
    v_mul_f32 v65, v65, v16
    v_mul_f32 v66, v66, v16
    v_mul_f32 v67, v67, v16
    v_mul_f32 v68, v68, v16
    v_mul_f32 v69, v69, v16
    v_mul_f32 v70, v70, v16
    v_mul_f32 v71, v71, v16
    v_cvt_pk_bf16_f32 v64, v64, v65
    v_cvt_pk_bf16_f32 v65, v66, v67
    v_cvt_pk_bf16_f32 v66, v68, v69
    v_cvt_pk_bf16_f32 v67, v70, v71
    buffer_store_dwordx4 v[64:67], v8, s[20:23], s35 offen sc1
    s_add_u32 s35, s35, s56
    v_mul_f32 v72, v72, v16
    v_mul_f32 v73, v73, v16
    v_mul_f32 v74, v74, v16
    v_mul_f32 v75, v75, v16
    v_mul_f32 v76, v76, v16
    v_mul_f32 v77, v77, v16
    v_mul_f32 v78, v78, v16
    v_mul_f32 v79, v79, v16
    v_cvt_pk_bf16_f32 v72, v72, v73
    v_cvt_pk_bf16_f32 v73, v74, v75
    v_cvt_pk_bf16_f32 v74, v76, v77
    v_cvt_pk_bf16_f32 v75, v78, v79
    buffer_store_dwordx4 v[72:75], v8, s[20:23], s35 offen sc1
    s_add_u32 s35, s35, s56
    v_mul_f32 v80, v80, v16
    v_mul_f32 v81, v81, v16
    v_mul_f32 v82, v82, v16
    v_mul_f32 v83, v83, v16
    v_mul_f32 v84, v84, v16
    v_mul_f32 v85, v85, v16
    v_mul_f32 v86, v86, v16
    v_mul_f32 v87, v87, v16
    v_cvt_pk_bf16_f32 v80, v80, v81
    v_cvt_pk_bf16_f32 v81, v82, v83
    v_cvt_pk_bf16_f32 v82, v84, v85
    v_cvt_pk_bf16_f32 v83, v86, v87
    buffer_store_dwordx4 v[80:83], v8, s[20:23], s35 offen sc1
    s_add_u32 s35, s35, s56
    v_mul_f32 v88, v88, v16
    v_mul_f32 v89, v89, v16
    v_mul_f32 v90, v90, v16
    v_mul_f32 v91, v91, v16
    v_mul_f32 v92, v92, v16
    v_mul_f32 v93, v93, v16
    v_mul_f32 v94, v94, v16
    v_mul_f32 v95, v95, v16
    v_cvt_pk_bf16_f32 v88, v88, v89
    v_cvt_pk_bf16_f32 v89, v90, v91
    v_cvt_pk_bf16_f32 v90, v92, v93
    v_cvt_pk_bf16_f32 v91, v94, v95
    buffer_store_dwordx4 v[88:91], v8, s[20:23], s35 offen sc1
    s_add_u32 s35, s35, s56
    v_mul_f32 v96, v96, v16
    v_mul_f32 v97, v97, v16
    v_mul_f32 v98, v98, v16
    v_mul_f32 v99, v99, v16
    v_mul_f32 v100, v100, v16
    v_mul_f32 v101, v101, v16
    v_mul_f32 v102, v102, v16
    v_mul_f32 v103, v103, v16
    v_cvt_pk_bf16_f32 v96, v96, v97
    v_cvt_pk_bf16_f32 v97, v98, v99
    v_cvt_pk_bf16_f32 v98, v100, v101
    v_cvt_pk_bf16_f32 v99, v102, v103
    buffer_store_dwordx4 v[96:99], v8, s[20:23], s35 offen sc1
    s_add_u32 s35, s35, s56
    v_mul_f32 v104, v104, v16
    v_mul_f32 v105, v105, v16
    v_mul_f32 v106, v106, v16
    v_mul_f32 v107, v107, v16
    v_mul_f32 v108, v108, v16
    v_mul_f32 v109, v109, v16
    v_mul_f32 v110, v110, v16
    v_mul_f32 v111, v111, v16
    v_cvt_pk_bf16_f32 v104, v104, v105
    v_cvt_pk_bf16_f32 v105, v106, v107
    v_cvt_pk_bf16_f32 v106, v108, v109
    v_cvt_pk_bf16_f32 v107, v110, v111
    buffer_store_dwordx4 v[104:107], v8, s[20:23], s35 offen sc1
    v_mul_f32 v112, v112, v16
    v_mul_f32 v113, v113, v16
    v_mul_f32 v114, v114, v16
    v_mul_f32 v115, v115, v16
    v_mul_f32 v116, v116, v16
    v_mul_f32 v117, v117, v16
    v_mul_f32 v118, v118, v16
    v_mul_f32 v119, v119, v16
    v_cvt_pk_bf16_f32 v40, v112, v113
    s_mul_i32 s51, s56, 0
    s_add_u32 s51, s51, s49
    buffer_store_dword v40, v9, s[20:23], s51 offen offset:1024 sc1
    v_cvt_pk_bf16_f32 v41, v114, v115
    s_mul_i32 s51, s56, 1
    s_add_u32 s51, s51, s49
    buffer_store_dword v41, v9, s[20:23], s51 offen offset:1024 sc1
    v_cvt_pk_bf16_f32 v42, v116, v117
    s_mul_i32 s51, s56, 4
    s_add_u32 s51, s51, s49
    buffer_store_dword v42, v9, s[20:23], s51 offen offset:1024 sc1
    v_cvt_pk_bf16_f32 v43, v118, v119
    s_mul_i32 s51, s56, 5
    s_add_u32 s51, s51, s49
    buffer_store_dword v43, v9, s[20:23], s51 offen offset:1024 sc1
    s_branch Lsequ_16
Lsequ_15:
    v_mul_lo_u32 v8, v15, s56
    v_lshl_add_u32 v8, v12, 8, v8
    v_lshl_add_u32 v8, v7, 4, v8
    v_bfe_u32 v6, v11, 1, 3
    v_mul_lo_u32 v9, v6, s56
    v_lshl_add_u32 v9, v12, 6, v9
    v_lshl_add_u32 v9, v15, 5, v9
    v_and_b32 v6, 1, v11
    v_lshl_add_u32 v9, v6, 4, v9
    v_mov_b32 v10, 0x3f803f80
    v_cmp_eq_u32 vcc, 0, v6
    v_cmp_gt_u32 s[44:45], 16, v11
    s_nop 0
    v_cndmask_b32 v10, 0, v10, vcc
    s_barrier
    ds_read_b128 a[0:3], v16
    ds_read_b64_tr_b16 a[8:9], v20 offset:0
    ds_read_b64_tr_b16 a[10:11], v20 offset:1280
    ds_read_b64_tr_b16 a[12:13], v20 offset:64
    ds_read_b64_tr_b16 a[14:15], v20 offset:1344
    ds_read_b64_tr_b16 a[16:17], v20 offset:128
    ds_read_b64_tr_b16 a[18:19], v20 offset:1408
    ds_read_b64_tr_b16 a[20:21], v20 offset:192
    ds_read_b64_tr_b16 a[22:23], v20 offset:1472
    ds_read_b64_tr_b16 a[24:25], v21 offset:0
    ds_read_b64_tr_b16 a[26:27], v21 offset:1280
    s_mov_b32 s60, 0
    s_mov_b32 s61, 0
.p2align 6
Lsequ_20:
    s_add_u32 s61, s61, 1
    s_cmp_eq_u32 s61, 4
    s_cselect_b32 s61, 0, s61
    s_mov_b32 s59, 36864
    s_cselect_b32 s59, 4294856704, s59
    s_waitcnt lgkmcnt(8)
    v_mfma_f32_32x32x16_bf16 v[48:63], a[0:3], a[8:11], v[48:63]
    ds_read_b128 a[4:7], v17
    ds_read_b64_tr_b16 a[28:29], v20 offset:5120
    ds_read_b64_tr_b16 a[30:31], v20 offset:6400
    s_waitcnt lgkmcnt(9)
    v_mfma_f32_32x32x16_bf16 v[64:79], a[0:3], a[12:15], v[64:79]
    ds_read_b64_tr_b16 a[32:33], v20 offset:5184
    ds_read_b64_tr_b16 a[34:35], v20 offset:6464
    ds_read_b64_tr_b16 a[36:37], v20 offset:5248
    s_waitcnt lgkmcnt(10)
    v_mfma_f32_32x32x16_bf16 v[80:95], a[0:3], a[16:19], v[80:95]
    ds_read_b64_tr_b16 a[38:39], v20 offset:6528
    ds_read_b64_tr_b16 a[40:41], v20 offset:5312
    ds_read_b64_tr_b16 a[42:43], v20 offset:6592
    s_waitcnt lgkmcnt(11)
    v_mfma_f32_32x32x16_bf16 v[96:111], a[0:3], a[20:23], v[96:111]
    ds_read_b64_tr_b16 a[44:45], v21 offset:5120
    ds_read_b64_tr_b16 a[46:47], v21 offset:6400
    s_waitcnt lgkmcnt(11)
    v_mfma_f32_32x32x16_bf16 v[112:127], a[0:3], a[24:27], v[112:127]
    v_add_u32 v16, s59, v16
    s_waitcnt lgkmcnt(8)
    v_mfma_f32_32x32x16_bf16 v[48:63], a[4:7], a[28:31], v[48:63]
    ds_read_b128 a[0:3], v18
    ds_read_b64_tr_b16 a[8:9], v20 offset:10240
    ds_read_b64_tr_b16 a[10:11], v20 offset:11520
    s_waitcnt lgkmcnt(9)
    v_mfma_f32_32x32x16_bf16 v[64:79], a[4:7], a[32:35], v[64:79]
    ds_read_b64_tr_b16 a[12:13], v20 offset:10304
    ds_read_b64_tr_b16 a[14:15], v20 offset:11584
    ds_read_b64_tr_b16 a[16:17], v20 offset:10368
    s_waitcnt lgkmcnt(10)
    v_mfma_f32_32x32x16_bf16 v[80:95], a[4:7], a[36:39], v[80:95]
    ds_read_b64_tr_b16 a[18:19], v20 offset:11648
    ds_read_b64_tr_b16 a[20:21], v20 offset:10432
    ds_read_b64_tr_b16 a[22:23], v20 offset:11712
    s_waitcnt lgkmcnt(11)
    v_mfma_f32_32x32x16_bf16 v[96:111], a[4:7], a[40:43], v[96:111]
    ds_read_b64_tr_b16 a[24:25], v21 offset:10240
    ds_read_b64_tr_b16 a[26:27], v21 offset:11520
    s_waitcnt lgkmcnt(11)
    v_mfma_f32_32x32x16_bf16 v[112:127], a[4:7], a[44:47], v[112:127]
    v_add_u32 v17, s59, v17
    s_waitcnt lgkmcnt(8)
    v_mfma_f32_32x32x16_bf16 v[48:63], a[0:3], a[8:11], v[48:63]
    ds_read_b128 a[4:7], v19
    ds_read_b64_tr_b16 a[28:29], v20 offset:15360
    ds_read_b64_tr_b16 a[30:31], v20 offset:16640
    s_waitcnt lgkmcnt(9)
    v_mfma_f32_32x32x16_bf16 v[64:79], a[0:3], a[12:15], v[64:79]
    ds_read_b64_tr_b16 a[32:33], v20 offset:15424
    ds_read_b64_tr_b16 a[34:35], v20 offset:16704
    ds_read_b64_tr_b16 a[36:37], v20 offset:15488
    s_waitcnt lgkmcnt(10)
    v_mfma_f32_32x32x16_bf16 v[80:95], a[0:3], a[16:19], v[80:95]
    ds_read_b64_tr_b16 a[38:39], v20 offset:16768
    ds_read_b64_tr_b16 a[40:41], v20 offset:15552
    ds_read_b64_tr_b16 a[42:43], v20 offset:16832
    s_waitcnt lgkmcnt(11)
    v_mfma_f32_32x32x16_bf16 v[96:111], a[0:3], a[20:23], v[96:111]
    ds_read_b64_tr_b16 a[44:45], v21 offset:15360
    ds_read_b64_tr_b16 a[46:47], v21 offset:16640
    s_waitcnt lgkmcnt(11)
    v_mfma_f32_32x32x16_bf16 v[112:127], a[0:3], a[24:27], v[112:127]
    v_add_u32 v18, s59, v18
    v_add_u32 v20, s59, v20
    v_add_u32 v21, s59, v21
    s_waitcnt lgkmcnt(0)
    s_barrier
    v_mfma_f32_32x32x16_bf16 v[48:63], a[4:7], a[28:31], v[48:63]
    ds_read_b128 a[0:3], v16
    ds_read_b64_tr_b16 a[8:9], v20 offset:0
    ds_read_b64_tr_b16 a[10:11], v20 offset:1280
    v_mfma_f32_32x32x16_bf16 v[64:79], a[4:7], a[32:35], v[64:79]
    ds_read_b64_tr_b16 a[12:13], v20 offset:64
    ds_read_b64_tr_b16 a[14:15], v20 offset:1344
    ds_read_b64_tr_b16 a[16:17], v20 offset:128
    v_mfma_f32_32x32x16_bf16 v[80:95], a[4:7], a[36:39], v[80:95]
    ds_read_b64_tr_b16 a[18:19], v20 offset:1408
    ds_read_b64_tr_b16 a[20:21], v20 offset:192
    ds_read_b64_tr_b16 a[22:23], v20 offset:1472
    v_mfma_f32_32x32x16_bf16 v[96:111], a[4:7], a[40:43], v[96:111]
    ds_read_b64_tr_b16 a[24:25], v21 offset:0
    ds_read_b64_tr_b16 a[26:27], v21 offset:1280
    v_mfma_f32_32x32x16_bf16 v[112:127], a[4:7], a[44:47], v[112:127]
    v_add_u32 v19, s59, v19
    s_add_u32 s60, s60, 1
    s_cmp_lt_u32 s60, 6
    s_cbranch_scc1 Lsequ_20
    s_cmp_gt_u32 s60, 8
    s_cbranch_scc1 Lsequ_22
    s_cmp_eq_u32 s60, 8
    s_cbranch_scc1 Lsequ_21_go
    s_cmp_lg_u32 s24, 3
    s_cbranch_scc1 Lsequ_20
    s_cmp_eq_u32 s60, 7
    s_cbranch_scc1 Lsequ_21_chk
    buffer_load_dword v30, v29, s[40:43], 0 offen offset:128 sc1
    s_mov_b32 s55, 0
    s_branch Lsequ_20
Lsequ_21_again:
    s_sleep 1
    buffer_load_dword v30, v29, s[40:43], 0 offen offset:128 sc1
Lsequ_21_chk:
    s_waitcnt vmcnt(0)
    v_readfirstlane_b32 s50, v30
    s_add_u32 s55, s55, 1
    s_cmp_ge_u32 s55, 200000
    s_cbranch_scc1 Lsequ_20
    s_cmp_lt_u32 s50, 1
    s_cbranch_scc1 Lsequ_21_again
    s_branch Lsequ_20
Lsequ_21_go:
    buffer_load_dwordx4 v[32:35], v24, s[20:23], s32 offen sc1
    buffer_load_dwordx2 a[64:65], v22, s[20:23], s33 offen offset:0 sc1
    buffer_load_dwordx2 a[68:69], v22, s[20:23], s33 offen offset:288 sc1
    buffer_load_dwordx2 a[72:73], v22, s[20:23], s33 offen offset:576 sc1
    buffer_load_dwordx2 a[76:77], v22, s[20:23], s33 offen offset:864 sc1
    buffer_load_dwordx2 a[80:81], v23, s[20:23], s33 offen offset:0 sc1
    buffer_load_dwordx4 a[96:99], v25, s[20:23], s34 offen offset:0 sc1
    buffer_load_dwordx4 a[100:103], v25, s[20:23], s34 offen offset:32 sc1
    buffer_load_dwordx4 a[104:107], v25, s[20:23], s34 offen offset:64 sc1
    buffer_load_dwordx4 a[108:111], v25, s[20:23], s34 offen offset:96 sc1
    s_branch Lsequ_20
Lsequ_22:
    s_waitcnt vmcnt(0)
    v_cndmask_b32 v36, 0, v33, s[52:53]
    v_cndmask_b32 v37, 0, v34, s[52:53]
    v_accvgpr_read_b32 v16, a96
    v_accvgpr_read_b32 v17, a97
    v_accvgpr_read_b32 v18, a98
    v_accvgpr_read_b32 v19, a99
    v_accvgpr_read_b32 v20, a100
    v_accvgpr_read_b32 v21, a101
    v_accvgpr_read_b32 v22, a102
    v_accvgpr_read_b32 v23, a103
    v_accvgpr_read_b32 v24, a104
    v_accvgpr_read_b32 v25, a105
    v_accvgpr_read_b32 v26, a106
    v_accvgpr_read_b32 v27, a107
    v_accvgpr_read_b32 v28, a108
    v_accvgpr_read_b32 v29, a109
    v_accvgpr_read_b32 v30, a110
    v_accvgpr_read_b32 v31, a111
    v_mfma_f32_32x32x16_bf16 v[48:63], v[36:39], a[64:67], v[48:63]
    v_mfma_f32_32x32x16_bf16 v[64:79], v[36:39], a[68:71], v[64:79]
    v_mfma_f32_32x32x16_bf16 v[80:95], v[36:39], a[72:75], v[80:95]
    v_mfma_f32_32x32x16_bf16 v[96:111], v[36:39], a[76:79], v[96:111]
    v_mfma_f32_32x32x16_bf16 v[112:127], v[36:39], a[80:83], v[112:127]
    s_nop 7
    v_mul_f32 v48, v48, v16
    v_mul_f32 v49, v49, v17
    v_mul_f32 v50, v50, v18
    v_mul_f32 v51, v51, v19
    v_mul_f32 v52, v52, v20
    v_mul_f32 v53, v53, v21
    v_mul_f32 v54, v54, v22
    v_mul_f32 v55, v55, v23
    v_cvt_pk_bf16_f32 v48, v48, v49
    v_cvt_pk_bf16_f32 v49, v50, v51
    v_cvt_pk_bf16_f32 v50, v52, v53
    v_cvt_pk_bf16_f32 v51, v54, v55
    buffer_store_dwordx4 v[48:51], v8, s[20:23], s35 offen offset:1152 sc1
    v_mul_f32 v56, v56, v24
    v_mul_f32 v57, v57, v25
    v_mul_f32 v58, v58, v26
    v_mul_f32 v59, v59, v27
    v_mul_f32 v60, v60, v28
    v_mul_f32 v61, v61, v29
    v_mul_f32 v62, v62, v30
    v_mul_f32 v63, v63, v31
    v_cvt_pk_bf16_f32 v56, v56, v57
    v_cvt_pk_bf16_f32 v57, v58, v59
    v_cvt_pk_bf16_f32 v58, v60, v61
    v_cvt_pk_bf16_f32 v59, v62, v63
    buffer_store_dwordx4 v[56:59], v8, s[20:23], s35 offen offset:1664 sc1
    s_add_u32 s35, s35, 311296
    v_mul_f32 v64, v64, v16
    v_mul_f32 v65, v65, v17
    v_mul_f32 v66, v66, v18
    v_mul_f32 v67, v67, v19
    v_mul_f32 v68, v68, v20
    v_mul_f32 v69, v69, v21
    v_mul_f32 v70, v70, v22
    v_mul_f32 v71, v71, v23
    v_cvt_pk_bf16_f32 v64, v64, v65
    v_cvt_pk_bf16_f32 v65, v66, v67
    v_cvt_pk_bf16_f32 v66, v68, v69
    v_cvt_pk_bf16_f32 v67, v70, v71
    buffer_store_dwordx4 v[64:67], v8, s[20:23], s35 offen offset:1152 sc1
    v_mul_f32 v72, v72, v24
    v_mul_f32 v73, v73, v25
    v_mul_f32 v74, v74, v26
    v_mul_f32 v75, v75, v27
    v_mul_f32 v76, v76, v28
    v_mul_f32 v77, v77, v29
    v_mul_f32 v78, v78, v30
    v_mul_f32 v79, v79, v31
    v_cvt_pk_bf16_f32 v72, v72, v73
    v_cvt_pk_bf16_f32 v73, v74, v75
    v_cvt_pk_bf16_f32 v74, v76, v77
    v_cvt_pk_bf16_f32 v75, v78, v79
    buffer_store_dwordx4 v[72:75], v8, s[20:23], s35 offen offset:1664 sc1
    s_add_u32 s35, s35, 311296
    v_mul_f32 v80, v80, v16
    v_mul_f32 v81, v81, v17
    v_mul_f32 v82, v82, v18
    v_mul_f32 v83, v83, v19
    v_mul_f32 v84, v84, v20
    v_mul_f32 v85, v85, v21
    v_mul_f32 v86, v86, v22
    v_mul_f32 v87, v87, v23
    v_cvt_pk_bf16_f32 v80, v80, v81
    v_cvt_pk_bf16_f32 v81, v82, v83
    v_cvt_pk_bf16_f32 v82, v84, v85
    v_cvt_pk_bf16_f32 v83, v86, v87
    buffer_store_dwordx4 v[80:83], v8, s[20:23], s35 offen offset:1152 sc1
    v_mul_f32 v88, v88, v24
    v_mul_f32 v89, v89, v25
    v_mul_f32 v90, v90, v26
    v_mul_f32 v91, v91, v27
    v_mul_f32 v92, v92, v28
    v_mul_f32 v93, v93, v29
    v_mul_f32 v94, v94, v30
    v_mul_f32 v95, v95, v31
    v_cvt_pk_bf16_f32 v88, v88, v89
    v_cvt_pk_bf16_f32 v89, v90, v91
    v_cvt_pk_bf16_f32 v90, v92, v93
    v_cvt_pk_bf16_f32 v91, v94, v95
    buffer_store_dwordx4 v[88:91], v8, s[20:23], s35 offen offset:1664 sc1
    s_add_u32 s35, s35, 311296
    v_mul_f32 v96, v96, v16
    v_mul_f32 v97, v97, v17
    v_mul_f32 v98, v98, v18
    v_mul_f32 v99, v99, v19
    v_mul_f32 v100, v100, v20
    v_mul_f32 v101, v101, v21
    v_mul_f32 v102, v102, v22
    v_mul_f32 v103, v103, v23
    v_cvt_pk_bf16_f32 v96, v96, v97
    v_cvt_pk_bf16_f32 v97, v98, v99
    v_cvt_pk_bf16_f32 v98, v100, v101
    v_cvt_pk_bf16_f32 v99, v102, v103
    buffer_store_dwordx4 v[96:99], v8, s[20:23], s35 offen offset:1152 sc1
    v_mul_f32 v104, v104, v24
    v_mul_f32 v105, v105, v25
    v_mul_f32 v106, v106, v26
    v_mul_f32 v107, v107, v27
    v_mul_f32 v108, v108, v28
    v_mul_f32 v109, v109, v29
    v_mul_f32 v110, v110, v30
    v_mul_f32 v111, v111, v31
    v_cvt_pk_bf16_f32 v104, v104, v105
    v_cvt_pk_bf16_f32 v105, v106, v107
    v_cvt_pk_bf16_f32 v106, v108, v109
    v_cvt_pk_bf16_f32 v107, v110, v111
    buffer_store_dwordx4 v[104:107], v8, s[20:23], s35 offen offset:1664 sc1
    v_mul_f32 v112, v112, v16
    v_mul_f32 v113, v113, v17
    v_mul_f32 v114, v114, v18
    v_mul_f32 v115, v115, v19
    v_mul_f32 v116, v116, v20
    v_mul_f32 v117, v117, v21
    v_mul_f32 v118, v118, v22
    v_mul_f32 v119, v119, v23
    v_cvt_pk_bf16_f32 v112, v112, v113
    v_cvt_pk_bf16_f32 v113, v114, v115
    v_cvt_pk_bf16_f32 v114, v116, v117
    v_cvt_pk_bf16_f32 v115, v118, v119
    v_cndmask_b32 v112, v10, v112, s[44:45]
    v_cndmask_b32 v113, v10, v113, s[44:45]
    v_cndmask_b32 v114, v10, v114, s[44:45]
    v_cndmask_b32 v115, v10, v115, s[44:45]
    buffer_store_dwordx4 v[112:115], v9, s[20:23], s49 offen offset:2176 sc1
    v_mul_f32 v120, v120, v24
    v_mul_f32 v121, v121, v25
    v_mul_f32 v122, v122, v26
    v_mul_f32 v123, v123, v27
    v_mul_f32 v124, v124, v28
    v_mul_f32 v125, v125, v29
    v_mul_f32 v126, v126, v30
    v_mul_f32 v127, v127, v31
    v_cvt_pk_bf16_f32 v120, v120, v121
    v_cvt_pk_bf16_f32 v121, v122, v123
    v_cvt_pk_bf16_f32 v122, v124, v125
    v_cvt_pk_bf16_f32 v123, v126, v127
    v_cndmask_b32 v120, v10, v120, s[44:45]
    v_cndmask_b32 v121, v10, v121, s[44:45]
    v_cndmask_b32 v122, v10, v122, s[44:45]
    v_cndmask_b32 v123, v10, v123, s[44:45]
    buffer_store_dwordx4 v[120:123], v9, s[20:23], s49 offen offset:2304 sc1
Lsequ_16:
    v_mov_b32 v2, 1073741824
    v_cmp_eq_u32 vcc, 0, v0
    v_mov_b32 v3, 1
    s_nop 0
    v_cndmask_b32 v2, v2, v0, vcc
    s_lshl_b32 s31, s30, 4
    s_add_u32 s31, s31, s29
    s_lshl_b32 s31, s31, 7
    s_add_u32 s31, s31, 7364608
    s_waitcnt vmcnt(0) lgkmcnt(0)
    s_barrier
    buffer_store_dword v3, v2, s[20:23], s31 offen sc1
Lsequ_6:
    v_lshlrev_b32 v4, 4, v1
    s_and_b32 s28, s2, 7
    s_lshl_b32 s28, s28, 2
    s_bfe_u32 s29, s2, 0x20003
    s_add_u32 s28, s28, s29
    s_cmp_ge_u32 s24, 4
    s_cbranch_scc1 Lsequ_23
    s_lshr_b32 s25, s2, 5
    s_lshl_b32 s25, s25, 3
    s_and_b32 s26, s2, 7
    s_add_u32 s25, s25, s26
    s_bfe_u32 s26, s2, 0x20003
    s_mov_b32 s45, 4
    s_mul_i32 s30, s26, 144
    s_lshl_b32 s31, s45, 5
    s_add_u32 s30, s30, s31
    v_and_b32 v2, 31, v1
    v_lshrrev_b32 v3, 5, v1
    v_and_b32 v120, 0x13, v2
    v_bfe_u32 v121, v2, 2, 1
    v_lshl_add_u32 v120, v121, 3, v120
    v_bfe_u32 v121, v2, 3, 1
    v_lshl_add_u32 v120, v121, 2, v120
    v_add_u32 v120, s30, v120
    v_and_b32 v121, 1, v2
    v_add_u32 v121, 576, v121
    s_cmp_eq_u32 s45, 4
    s_cselect_b32 s31, 15, 63
    v_cmp_lt_u32 vcc, s31, v2
    s_mul_i32 s33, s25, 36864
    s_lshl_b32 s34, s30, 1
    v_cndmask_b32 v120, v120, v121, vcc
    v_mul_u32_u24 v121, 9344, v3
    v_lshl_add_u32 v120, v120, 4, v121
    s_add_u32 s33, s33, s34
    s_lshl_b32 s35, s25, 9
    s_add_u32 s35, s35, 7479296
    v_mul_u32_u24 v121, 1152, v2
    v_lshl_add_u32 v121, v3, 4, v121
    v_lshlrev_b32 v122, 4, v2
    s_mov_b32 s12, s4
    s_and_b32 s13, s5, 0xffff
    s_mov_b32 s14, 2359296
    s_mov_b32 s15, 0x00020000
    s_lshr_b32 s29, s2, 5
    s_lshl_b32 s29, s29, 3
    s_lshl_b32 s27, s24, 1
    s_add_u32 s29, s29, s27
    v_lshlrev_b32 v10, 2, v2
    s_mul_i32 s27, s28, 73728
    s_mul_i32 s46, s29, 1152
    s_add_u32 s27, s27, s46
    s_add_u32 s27, s27, 4980736
    s_mul_i32 s32, s24, 168192
    s_add_u32 s32, s32, 9887744
    v_and_b32 v7, 3, v2
    v_bfe_u32 v8, v2, 2, 1
    v_lshl_add_u32 v7, v8, 3, v7
    v_bfe_u32 v8, v2, 3, 1
    v_lshl_add_u32 v7, v8, 2, v7
    v_lshlrev_b32 v7, 4, v7
    v_lshl_add_u32 v7, v3, 8, v7
    v_min_u32 v8, 19, v2
    v_lshlrev_b32 v8, 4, v8
    v_lshl_add_u32 v8, v3, 6, v8
    v_add_u32 v8, 768, v8
    v_cmp_lt_u32 vcc, 15, v2
    v_cmp_gt_u32 s[52:53], 32, v1
    v_add_u32 v5, 1024, v10
    v_cndmask_b32 v6, v7, v8, vcc
    v_add_u32 v6, 1152, v6
    v_mov_b32 v7, 512
    v_mov_b32 v8, 128
    v_cndmask_b32 v7, v7, v8, vcc
    v_add_u32 v9, v6, v7
    v_mov_b32 v8, 2224
    v_cndmask_b32 v5, v8, v5, s[52:53]
    v_mov_b32 v8, 0x3f803f80
    v_cndmask_b32 v113, 0, v8, s[52:53]
    v_cndmask_b32 v117, 0, v8, s[52:53]
    v_mov_b32 v101, 0
    v_mov_b32 v102, 0
    v_mov_b32 v103, 0
    v_mov_b32 v109, 0
    v_mov_b32 v110, 0
    v_mov_b32 v111, 0
    v_mov_b32 v114, 0
    v_mov_b32 v115, 0
    v_mov_b32 v118, 0
    v_mov_b32 v119, 0
    v_mov_b32 v64, 0
    v_mov_b32 v65, 0
    v_mov_b32 v66, 0
    v_mov_b32 v67, 0
    v_mov_b32 v68, 0
    v_mov_b32 v69, 0
    v_mov_b32 v70, 0
    v_mov_b32 v71, 0
    v_mov_b32 v72, 0
    v_mov_b32 v73, 0
    v_mov_b32 v74, 0
    v_mov_b32 v75, 0
    v_mov_b32 v76, 0
    v_mov_b32 v77, 0
    v_mov_b32 v78, 0
    v_mov_b32 v79, 0
    v_mov_b32 v80, 0
    v_mov_b32 v81, 0
    v_mov_b32 v82, 0
    v_mov_b32 v83, 0
    v_mov_b32 v84, 0
    v_mov_b32 v85, 0
    v_mov_b32 v86, 0
    v_mov_b32 v87, 0
    v_mov_b32 v88, 0
    v_mov_b32 v89, 0
    v_mov_b32 v90, 0
    v_mov_b32 v91, 0
    v_mov_b32 v92, 0
    v_mov_b32 v93, 0
    v_mov_b32 v94, 0
    v_mov_b32 v95, 0
    v_mov_b32 v56, 0
    v_accvgpr_write_b32 a16, 0
    v_mov_b32 v57, 0
    v_accvgpr_write_b32 a17, 0
    v_mov_b32 v58, 0
    v_accvgpr_write_b32 a18, 0
    v_mov_b32 v59, 0
    v_accvgpr_write_b32 a19, 0
    v_mov_b32 v60, 0
    v_accvgpr_write_b32 a20, 0
    v_mov_b32 v61, 0
    v_accvgpr_write_b32 a21, 0
    v_mov_b32 v62, 0
    v_accvgpr_write_b32 a22, 0
    v_mov_b32 v63, 0
    v_accvgpr_write_b32 a23, 0
    s_mov_b32 s59, 0
    s_mov_b32 s54, 2
    s_cmp_eq_u32 s24, 0
    s_cbranch_scc1 Lsequ_5
Lsequ_5_b:
    s_barrier
    buffer_load_dwordx4 v[96:99], v4, s[20:23], s27 offen sc1
    buffer_load_dword v100, v10, s[20:23], s27 offen offset:1024 sc1
    buffer_load_dwordx4 v[104:107], v4, s[20:23], s27 offen offset:1152 sc1
    buffer_load_dword v108, v10, s[20:23], s27 offen offset:2176 sc1
    s_waitcnt vmcnt(0)
    v_cndmask_b32 v100, 0, v100, s[52:53]
    v_cndmask_b32 v108, 0, v108, s[52:53]
    s_barrier
    ds_read_b128 a[0:3], v4
    ds_read_b32 v112, v5
    s_waitcnt lgkmcnt(0)
    v_mfma_f32_32x32x16_bf16 v[16:31], a[0:3], v[96:99], 0
    v_mfma_f32_32x32x16_bf16 v[16:31], v[112:115], v[100:103], v[16:31]
    v_mfma_f32_32x32x16_bf16 v[32:47], a[0:3], v[104:107], 0
    v_mfma_f32_32x32x16_bf16 v[32:47], v[112:115], v[108:111], v[32:47]
    s_nop 9
    v_max3_f32 v7, v16, v17, v18
    v_max3_f32 v7, v19, v20, v7
    v_max3_f32 v7, v21, v22, v7
    v_max3_f32 v7, v23, v24, v7
    v_max3_f32 v7, v25, v26, v7
    v_max3_f32 v7, v27, v28, v7
    v_max3_f32 v7, v29, v30, v7
    v_max_f32 v7, v31, v7
    v_max3_f32 v8, v32, v33, v34
    v_max3_f32 v8, v35, v36, v8
    v_max3_f32 v8, v37, v38, v8
    v_max3_f32 v8, v39, v40, v8
    v_max3_f32 v8, v41, v42, v8
    v_max3_f32 v8, v43, v44, v8
    v_max3_f32 v8, v45, v46, v8
    v_max_f32 v8, v47, v8
Lsequ_24:
    v_mov_b32 v11, v4
    v_mov_b32 v12, v5
    v_mov_b32 v13, v6
    v_mov_b32 v14, v9
    ds_read_b128 a[0:3], v11
    ds_read_b32 v112, v12
    ds_read_b128 a[4:7], v11 offset:2432
    ds_read_b32 v116, v12 offset:2432
    ds_read_b128 a[8:11], v13
    ds_read_b128 a[12:15], v14
    v_mov_b32 v16, v7
    v_mov_b32 v17, v8
    s_nop 0
    v_permlane32_swap_b32 v7, v16
    v_permlane32_swap_b32 v8, v17
    v_max_f32 v7, v7, v16
    v_max_f32 v8, v8, v17
    v_cvt_pk_bf16_f32 v16, v7, v7
    v_lshlrev_b32 v16, 16, v16
    v_sub_f32 v17, v7, v16
    v_cvt_pk_bf16_f32 v18, -v16, -v17
    v_cndmask_b32 v101, 0, v18, s[52:53]
    v_cvt_pk_bf16_f32 v16, v8, v8
    v_lshlrev_b32 v16, 16, v16
    v_sub_f32 v17, v8, v16
    v_cvt_pk_bf16_f32 v18, -v16, -v17
    v_cndmask_b32 v109, 0, v18, s[52:53]
    s_waitcnt lgkmcnt(4)
    v_mfma_f32_32x32x16_bf16 v[16:31], a[0:3], v[96:99], 0
    v_mfma_f32_32x32x16_bf16 v[16:31], v[112:115], v[100:103], v[16:31]
    s_mov_b32 s30, 0
    s_nop 10
.p2align 6
Lsequ_25:
    v_mfma_f32_32x32x16_bf16 v[32:47], a[0:3], v[104:107], 0
    v_exp_f32 v16, v16
    v_exp_f32 v17, v17
    v_exp_f32 v18, v18
    v_exp_f32 v19, v19
    v_cvt_pk_bf16_f32 v48, v16, v17
    v_exp_f32 v20, v20
    v_mfma_f32_32x32x16_bf16 v[32:47], v[112:115], v[108:111], v[32:47]
    v_exp_f32 v21, v21
    v_cvt_pk_bf16_f32 v49, v18, v19
    v_exp_f32 v22, v22
    v_exp_f32 v23, v23
    v_cvt_pk_bf16_f32 v50, v20, v21
    v_exp_f32 v24, v24
    v_mfma_f32_32x32x16_bf16 v[80:95], a[16:19], v[56:59], v[80:95]
    v_exp_f32 v25, v25
    v_cvt_pk_bf16_f32 v51, v22, v23
    v_exp_f32 v26, v26
    v_exp_f32 v27, v27
    v_cvt_pk_bf16_f32 v52, v24, v25
    v_exp_f32 v28, v28
    v_mfma_f32_32x32x16_bf16 v[80:95], a[20:23], v[60:63], v[80:95]
    v_exp_f32 v29, v29
    v_cvt_pk_bf16_f32 v53, v26, v27
    v_exp_f32 v30, v30
    v_exp_f32 v31, v31
    v_cvt_pk_bf16_f32 v54, v28, v29
    v_cvt_pk_bf16_f32 v55, v30, v31
    s_waitcnt lgkmcnt(0)
    v_mfma_f32_32x32x16_bf16 v[16:31], a[4:7], v[96:99], 0
    ds_read_b128 a[0:3], v11 offset:4864
    v_exp_f32 v32, v32
    v_exp_f32 v33, v33
    v_exp_f32 v34, v34
    v_exp_f32 v35, v35
    v_cvt_pk_bf16_f32 v56, v32, v33
    v_exp_f32 v36, v36
    v_mfma_f32_32x32x16_bf16 v[16:31], v[116:119], v[100:103], v[16:31]
    ds_read_b32 v112, v12 offset:4864
    v_exp_f32 v37, v37
    v_cvt_pk_bf16_f32 v57, v34, v35
    v_exp_f32 v38, v38
    v_exp_f32 v39, v39
    v_cvt_pk_bf16_f32 v58, v36, v37
    v_exp_f32 v40, v40
    v_mfma_f32_32x32x16_bf16 v[64:79], a[8:11], v[48:51], v[64:79]
    ds_read_b128 a[16:19], v13 offset:2432
    v_exp_f32 v41, v41
    v_cvt_pk_bf16_f32 v59, v38, v39
    v_exp_f32 v42, v42
    v_exp_f32 v43, v43
    v_cvt_pk_bf16_f32 v60, v40, v41
    v_exp_f32 v44, v44
    v_mfma_f32_32x32x16_bf16 v[64:79], a[12:15], v[52:55], v[64:79]
    ds_read_b128 a[20:23], v14 offset:2432
    v_exp_f32 v45, v45
    v_cvt_pk_bf16_f32 v61, v42, v43
    v_exp_f32 v46, v46
    v_exp_f32 v47, v47
    v_cvt_pk_bf16_f32 v62, v44, v45
    v_cvt_pk_bf16_f32 v63, v46, v47
    v_mfma_f32_32x32x16_bf16 v[32:47], a[4:7], v[104:107], 0
    v_exp_f32 v16, v16
    v_exp_f32 v17, v17
    v_exp_f32 v18, v18
    v_exp_f32 v19, v19
    v_cvt_pk_bf16_f32 v48, v16, v17
    v_exp_f32 v20, v20
    v_mfma_f32_32x32x16_bf16 v[32:47], v[116:119], v[108:111], v[32:47]
    v_exp_f32 v21, v21
    v_cvt_pk_bf16_f32 v49, v18, v19
    v_exp_f32 v22, v22
    v_exp_f32 v23, v23
    v_cvt_pk_bf16_f32 v50, v20, v21
    v_exp_f32 v24, v24
    v_mfma_f32_32x32x16_bf16 v[80:95], a[8:11], v[56:59], v[80:95]
    v_exp_f32 v25, v25
    v_cvt_pk_bf16_f32 v51, v22, v23
    v_exp_f32 v26, v26
    v_exp_f32 v27, v27
    v_cvt_pk_bf16_f32 v52, v24, v25
    v_exp_f32 v28, v28
    v_mfma_f32_32x32x16_bf16 v[80:95], a[12:15], v[60:63], v[80:95]
    v_exp_f32 v29, v29
    v_cvt_pk_bf16_f32 v53, v26, v27
    v_exp_f32 v30, v30
    v_exp_f32 v31, v31
    v_cvt_pk_bf16_f32 v54, v28, v29
    v_cvt_pk_bf16_f32 v55, v30, v31
    s_waitcnt lgkmcnt(0)
    v_mfma_f32_32x32x16_bf16 v[16:31], a[0:3], v[96:99], 0
    ds_read_b128 a[4:7], v11 offset:7296
    v_exp_f32 v32, v32
    v_exp_f32 v33, v33
    v_exp_f32 v34, v34
    v_exp_f32 v35, v35
    v_cvt_pk_bf16_f32 v56, v32, v33
    v_exp_f32 v36, v36
    v_mfma_f32_32x32x16_bf16 v[16:31], v[112:115], v[100:103], v[16:31]
    ds_read_b32 v116, v12 offset:7296
    v_exp_f32 v37, v37
    v_cvt_pk_bf16_f32 v57, v34, v35
    v_exp_f32 v38, v38
    v_exp_f32 v39, v39
    v_cvt_pk_bf16_f32 v58, v36, v37
    v_exp_f32 v40, v40
    v_mfma_f32_32x32x16_bf16 v[64:79], a[16:19], v[48:51], v[64:79]
    ds_read_b128 a[8:11], v13 offset:4864
    v_exp_f32 v41, v41
    v_cvt_pk_bf16_f32 v59, v38, v39
    v_exp_f32 v42, v42
    v_exp_f32 v43, v43
    v_cvt_pk_bf16_f32 v60, v40, v41
    v_exp_f32 v44, v44
    v_mfma_f32_32x32x16_bf16 v[64:79], a[20:23], v[52:55], v[64:79]
    ds_read_b128 a[12:15], v14 offset:4864
    v_exp_f32 v45, v45
    v_cvt_pk_bf16_f32 v61, v42, v43
    v_exp_f32 v46, v46
    v_exp_f32 v47, v47
    v_cvt_pk_bf16_f32 v62, v44, v45
    v_cvt_pk_bf16_f32 v63, v46, v47
    v_mfma_f32_32x32x16_bf16 v[32:47], a[0:3], v[104:107], 0
    v_exp_f32 v16, v16
    v_exp_f32 v17, v17
    v_exp_f32 v18, v18
    v_exp_f32 v19, v19
    v_cvt_pk_bf16_f32 v48, v16, v17
    v_exp_f32 v20, v20
    v_mfma_f32_32x32x16_bf16 v[32:47], v[112:115], v[108:111], v[32:47]
    v_exp_f32 v21, v21
    v_cvt_pk_bf16_f32 v49, v18, v19
    v_exp_f32 v22, v22
    v_exp_f32 v23, v23
    v_cvt_pk_bf16_f32 v50, v20, v21
    v_exp_f32 v24, v24
    v_mfma_f32_32x32x16_bf16 v[80:95], a[16:19], v[56:59], v[80:95]
    v_exp_f32 v25, v25
    v_cvt_pk_bf16_f32 v51, v22, v23
    v_exp_f32 v26, v26
    v_exp_f32 v27, v27
    v_cvt_pk_bf16_f32 v52, v24, v25
    v_exp_f32 v28, v28
    v_mfma_f32_32x32x16_bf16 v[80:95], a[20:23], v[60:63], v[80:95]
    v_exp_f32 v29, v29
    v_cvt_pk_bf16_f32 v53, v26, v27
    v_exp_f32 v30, v30
    v_exp_f32 v31, v31
    v_cvt_pk_bf16_f32 v54, v28, v29
    v_cvt_pk_bf16_f32 v55, v30, v31
    s_waitcnt lgkmcnt(0)
    v_mfma_f32_32x32x16_bf16 v[16:31], a[4:7], v[96:99], 0
    ds_read_b128 a[0:3], v11 offset:9728
    v_exp_f32 v32, v32
    v_exp_f32 v33, v33
    v_exp_f32 v34, v34
    v_exp_f32 v35, v35
    v_cvt_pk_bf16_f32 v56, v32, v33
    v_exp_f32 v36, v36
    v_mfma_f32_32x32x16_bf16 v[16:31], v[116:119], v[100:103], v[16:31]
    ds_read_b32 v112, v12 offset:9728
    v_exp_f32 v37, v37
    v_cvt_pk_bf16_f32 v57, v34, v35
    v_exp_f32 v38, v38
    v_exp_f32 v39, v39
    v_cvt_pk_bf16_f32 v58, v36, v37
    v_exp_f32 v40, v40
    v_mfma_f32_32x32x16_bf16 v[64:79], a[8:11], v[48:51], v[64:79]
    ds_read_b128 a[16:19], v13 offset:7296
    v_exp_f32 v41, v41
    v_cvt_pk_bf16_f32 v59, v38, v39
    v_exp_f32 v42, v42
    v_exp_f32 v43, v43
    v_cvt_pk_bf16_f32 v60, v40, v41
    v_exp_f32 v44, v44
    v_mfma_f32_32x32x16_bf16 v[64:79], a[12:15], v[52:55], v[64:79]
    ds_read_b128 a[20:23], v14 offset:7296
    v_exp_f32 v45, v45
    v_cvt_pk_bf16_f32 v61, v42, v43
    v_exp_f32 v46, v46
    v_exp_f32 v47, v47
    v_cvt_pk_bf16_f32 v62, v44, v45
    v_cvt_pk_bf16_f32 v63, v46, v47
    v_mfma_f32_32x32x16_bf16 v[32:47], a[4:7], v[104:107], 0
    v_exp_f32 v16, v16
    v_exp_f32 v17, v17
    v_exp_f32 v18, v18
    v_exp_f32 v19, v19
    v_cvt_pk_bf16_f32 v48, v16, v17
    v_exp_f32 v20, v20
    v_mfma_f32_32x32x16_bf16 v[32:47], v[116:119], v[108:111], v[32:47]
    v_exp_f32 v21, v21
    v_cvt_pk_bf16_f32 v49, v18, v19
    v_exp_f32 v22, v22
    v_exp_f32 v23, v23
    v_cvt_pk_bf16_f32 v50, v20, v21
    v_exp_f32 v24, v24
    v_mfma_f32_32x32x16_bf16 v[80:95], a[8:11], v[56:59], v[80:95]
    v_exp_f32 v25, v25
    v_cvt_pk_bf16_f32 v51, v22, v23
    v_exp_f32 v26, v26
    v_exp_f32 v27, v27
    v_cvt_pk_bf16_f32 v52, v24, v25
    v_exp_f32 v28, v28
    v_mfma_f32_32x32x16_bf16 v[80:95], a[12:15], v[60:63], v[80:95]
    v_exp_f32 v29, v29
    v_cvt_pk_bf16_f32 v53, v26, v27
    v_exp_f32 v30, v30
    v_exp_f32 v31, v31
    v_cvt_pk_bf16_f32 v54, v28, v29
    v_cvt_pk_bf16_f32 v55, v30, v31
    s_waitcnt lgkmcnt(0)
    v_mfma_f32_32x32x16_bf16 v[16:31], a[0:3], v[96:99], 0
    ds_read_b128 a[4:7], v11 offset:12160
    v_exp_f32 v32, v32
    v_exp_f32 v33, v33
    v_exp_f32 v34, v34
    v_exp_f32 v35, v35
    v_cvt_pk_bf16_f32 v56, v32, v33
    v_exp_f32 v36, v36
    v_mfma_f32_32x32x16_bf16 v[16:31], v[112:115], v[100:103], v[16:31]
    ds_read_b32 v116, v12 offset:12160
    v_exp_f32 v37, v37
    v_cvt_pk_bf16_f32 v57, v34, v35
    v_exp_f32 v38, v38
    v_exp_f32 v39, v39
    v_cvt_pk_bf16_f32 v58, v36, v37
    v_exp_f32 v40, v40
    v_mfma_f32_32x32x16_bf16 v[64:79], a[16:19], v[48:51], v[64:79]
    ds_read_b128 a[8:11], v13 offset:9728
    v_exp_f32 v41, v41
    v_cvt_pk_bf16_f32 v59, v38, v39
    v_exp_f32 v42, v42
    v_exp_f32 v43, v43
    v_cvt_pk_bf16_f32 v60, v40, v41
    v_exp_f32 v44, v44
    v_mfma_f32_32x32x16_bf16 v[64:79], a[20:23], v[52:55], v[64:79]
    ds_read_b128 a[12:15], v14 offset:9728
    v_exp_f32 v45, v45
    v_cvt_pk_bf16_f32 v61, v42, v43
    v_exp_f32 v46, v46
    v_exp_f32 v47, v47
    v_cvt_pk_bf16_f32 v62, v44, v45
    v_cvt_pk_bf16_f32 v63, v46, v47
    v_mfma_f32_32x32x16_bf16 v[32:47], a[0:3], v[104:107], 0
    v_exp_f32 v16, v16
    v_exp_f32 v17, v17
    v_exp_f32 v18, v18
    v_exp_f32 v19, v19
    v_cvt_pk_bf16_f32 v48, v16, v17
    v_exp_f32 v20, v20
    v_mfma_f32_32x32x16_bf16 v[32:47], v[112:115], v[108:111], v[32:47]
    v_exp_f32 v21, v21
    v_cvt_pk_bf16_f32 v49, v18, v19
    v_exp_f32 v22, v22
    v_exp_f32 v23, v23
    v_cvt_pk_bf16_f32 v50, v20, v21
    v_exp_f32 v24, v24
    v_mfma_f32_32x32x16_bf16 v[80:95], a[16:19], v[56:59], v[80:95]
    v_exp_f32 v25, v25
    v_cvt_pk_bf16_f32 v51, v22, v23
    v_exp_f32 v26, v26
    v_exp_f32 v27, v27
    v_cvt_pk_bf16_f32 v52, v24, v25
    v_exp_f32 v28, v28
    v_mfma_f32_32x32x16_bf16 v[80:95], a[20:23], v[60:63], v[80:95]
    v_exp_f32 v29, v29
    v_cvt_pk_bf16_f32 v53, v26, v27
    v_exp_f32 v30, v30
    v_exp_f32 v31, v31
    v_cvt_pk_bf16_f32 v54, v28, v29
    v_cvt_pk_bf16_f32 v55, v30, v31
    s_waitcnt lgkmcnt(0)
    v_mfma_f32_32x32x16_bf16 v[16:31], a[4:7], v[96:99], 0
    ds_read_b128 a[0:3], v11 offset:14592
    v_exp_f32 v32, v32
    v_exp_f32 v33, v33
    v_exp_f32 v34, v34
    v_exp_f32 v35, v35
    v_cvt_pk_bf16_f32 v56, v32, v33
    v_exp_f32 v36, v36
    v_mfma_f32_32x32x16_bf16 v[16:31], v[116:119], v[100:103], v[16:31]
    ds_read_b32 v112, v12 offset:14592
    v_exp_f32 v37, v37
    v_cvt_pk_bf16_f32 v57, v34, v35
    v_exp_f32 v38, v38
    v_exp_f32 v39, v39
    v_cvt_pk_bf16_f32 v58, v36, v37
    v_exp_f32 v40, v40
    v_mfma_f32_32x32x16_bf16 v[64:79], a[8:11], v[48:51], v[64:79]
    ds_read_b128 a[16:19], v13 offset:12160
    v_exp_f32 v41, v41
    v_cvt_pk_bf16_f32 v59, v38, v39
    v_exp_f32 v42, v42
    v_exp_f32 v43, v43
    v_cvt_pk_bf16_f32 v60, v40, v41
    v_exp_f32 v44, v44
    v_mfma_f32_32x32x16_bf16 v[64:79], a[12:15], v[52:55], v[64:79]
    ds_read_b128 a[20:23], v14 offset:12160
    v_exp_f32 v45, v45
    v_cvt_pk_bf16_f32 v61, v42, v43
    v_exp_f32 v46, v46
    v_exp_f32 v47, v47
    v_cvt_pk_bf16_f32 v62, v44, v45
    v_cvt_pk_bf16_f32 v63, v46, v47
    v_mfma_f32_32x32x16_bf16 v[32:47], a[4:7], v[104:107], 0
    v_exp_f32 v16, v16
    v_exp_f32 v17, v17
    v_exp_f32 v18, v18
    v_exp_f32 v19, v19
    v_cvt_pk_bf16_f32 v48, v16, v17
    v_exp_f32 v20, v20
    v_mfma_f32_32x32x16_bf16 v[32:47], v[116:119], v[108:111], v[32:47]
    v_exp_f32 v21, v21
    v_cvt_pk_bf16_f32 v49, v18, v19
    v_exp_f32 v22, v22
    v_exp_f32 v23, v23
    v_cvt_pk_bf16_f32 v50, v20, v21
    v_exp_f32 v24, v24
    v_mfma_f32_32x32x16_bf16 v[80:95], a[8:11], v[56:59], v[80:95]
    v_exp_f32 v25, v25
    v_cvt_pk_bf16_f32 v51, v22, v23
    v_exp_f32 v26, v26
    v_exp_f32 v27, v27
    v_cvt_pk_bf16_f32 v52, v24, v25
    v_exp_f32 v28, v28
    v_mfma_f32_32x32x16_bf16 v[80:95], a[12:15], v[60:63], v[80:95]
    v_exp_f32 v29, v29
    v_cvt_pk_bf16_f32 v53, v26, v27
    v_exp_f32 v30, v30
    v_exp_f32 v31, v31
    v_cvt_pk_bf16_f32 v54, v28, v29
    v_cvt_pk_bf16_f32 v55, v30, v31
    s_waitcnt lgkmcnt(0)
    v_mfma_f32_32x32x16_bf16 v[16:31], a[0:3], v[96:99], 0
    ds_read_b128 a[4:7], v11 offset:17024
    v_exp_f32 v32, v32
    v_exp_f32 v33, v33
    v_exp_f32 v34, v34
    v_exp_f32 v35, v35
    v_cvt_pk_bf16_f32 v56, v32, v33
    v_exp_f32 v36, v36
    v_mfma_f32_32x32x16_bf16 v[16:31], v[112:115], v[100:103], v[16:31]
    ds_read_b32 v116, v12 offset:17024
    v_exp_f32 v37, v37
    v_cvt_pk_bf16_f32 v57, v34, v35
    v_exp_f32 v38, v38
    v_exp_f32 v39, v39
    v_cvt_pk_bf16_f32 v58, v36, v37
    v_exp_f32 v40, v40
    v_mfma_f32_32x32x16_bf16 v[64:79], a[16:19], v[48:51], v[64:79]
    ds_read_b128 a[8:11], v13 offset:14592
    v_exp_f32 v41, v41
    v_cvt_pk_bf16_f32 v59, v38, v39
    v_exp_f32 v42, v42
    v_exp_f32 v43, v43
    v_cvt_pk_bf16_f32 v60, v40, v41
    v_exp_f32 v44, v44
    v_mfma_f32_32x32x16_bf16 v[64:79], a[20:23], v[52:55], v[64:79]
    ds_read_b128 a[12:15], v14 offset:14592
    v_exp_f32 v45, v45
    v_cvt_pk_bf16_f32 v61, v42, v43
    v_exp_f32 v46, v46
    v_exp_f32 v47, v47
    v_cvt_pk_bf16_f32 v62, v44, v45
    v_cvt_pk_bf16_f32 v63, v46, v47
    v_mfma_f32_32x32x16_bf16 v[32:47], a[0:3], v[104:107], 0
    v_exp_f32 v16, v16
    v_exp_f32 v17, v17
    v_exp_f32 v18, v18
    v_exp_f32 v19, v19
    v_cvt_pk_bf16_f32 v48, v16, v17
    v_exp_f32 v20, v20
    v_mfma_f32_32x32x16_bf16 v[32:47], v[112:115], v[108:111], v[32:47]
    v_exp_f32 v21, v21
    v_cvt_pk_bf16_f32 v49, v18, v19
    v_exp_f32 v22, v22
    v_exp_f32 v23, v23
    v_cvt_pk_bf16_f32 v50, v20, v21
    v_exp_f32 v24, v24
    v_mfma_f32_32x32x16_bf16 v[80:95], a[16:19], v[56:59], v[80:95]
    v_exp_f32 v25, v25
    v_cvt_pk_bf16_f32 v51, v22, v23
    v_exp_f32 v26, v26
    v_exp_f32 v27, v27
    v_cvt_pk_bf16_f32 v52, v24, v25
    v_exp_f32 v28, v28
    v_mfma_f32_32x32x16_bf16 v[80:95], a[20:23], v[60:63], v[80:95]
    v_exp_f32 v29, v29
    v_cvt_pk_bf16_f32 v53, v26, v27
    v_exp_f32 v30, v30
    v_exp_f32 v31, v31
    v_cvt_pk_bf16_f32 v54, v28, v29
    v_cvt_pk_bf16_f32 v55, v30, v31
    s_waitcnt lgkmcnt(0)
    v_mfma_f32_32x32x16_bf16 v[16:31], a[4:7], v[96:99], 0
    ds_read_b128 a[0:3], v11 offset:19456
    v_exp_f32 v32, v32
    v_exp_f32 v33, v33
    v_exp_f32 v34, v34
    v_exp_f32 v35, v35
    v_cvt_pk_bf16_f32 v56, v32, v33
    v_exp_f32 v36, v36
    v_mfma_f32_32x32x16_bf16 v[16:31], v[116:119], v[100:103], v[16:31]
    ds_read_b32 v112, v12 offset:19456
    v_exp_f32 v37, v37
    v_cvt_pk_bf16_f32 v57, v34, v35
    v_exp_f32 v38, v38
    v_exp_f32 v39, v39
    v_cvt_pk_bf16_f32 v58, v36, v37
    v_exp_f32 v40, v40
    v_mfma_f32_32x32x16_bf16 v[64:79], a[8:11], v[48:51], v[64:79]
    ds_read_b128 a[16:19], v13 offset:17024
    v_exp_f32 v41, v41
    v_cvt_pk_bf16_f32 v59, v38, v39
    v_exp_f32 v42, v42
    v_exp_f32 v43, v43
    v_cvt_pk_bf16_f32 v60, v40, v41
    v_exp_f32 v44, v44
    v_mfma_f32_32x32x16_bf16 v[64:79], a[12:15], v[52:55], v[64:79]
    ds_read_b128 a[20:23], v14 offset:17024
    v_exp_f32 v45, v45
    v_cvt_pk_bf16_f32 v61, v42, v43
    v_exp_f32 v46, v46
    v_exp_f32 v47, v47
    v_cvt_pk_bf16_f32 v62, v44, v45
    v_cvt_pk_bf16_f32 v63, v46, v47
    v_mfma_f32_32x32x16_bf16 v[32:47], a[4:7], v[104:107], 0
    v_exp_f32 v16, v16
    v_exp_f32 v17, v17
    v_exp_f32 v18, v18
    v_exp_f32 v19, v19
    v_cvt_pk_bf16_f32 v48, v16, v17
    v_exp_f32 v20, v20
    v_mfma_f32_32x32x16_bf16 v[32:47], v[116:119], v[108:111], v[32:47]
    v_exp_f32 v21, v21
    v_cvt_pk_bf16_f32 v49, v18, v19
    v_exp_f32 v22, v22
    v_exp_f32 v23, v23
    v_cvt_pk_bf16_f32 v50, v20, v21
    v_exp_f32 v24, v24
    v_mfma_f32_32x32x16_bf16 v[80:95], a[8:11], v[56:59], v[80:95]
    v_exp_f32 v25, v25
    v_cvt_pk_bf16_f32 v51, v22, v23
    v_exp_f32 v26, v26
    v_exp_f32 v27, v27
    v_cvt_pk_bf16_f32 v52, v24, v25
    v_exp_f32 v28, v28
    v_mfma_f32_32x32x16_bf16 v[80:95], a[12:15], v[60:63], v[80:95]
    v_exp_f32 v29, v29
    v_cvt_pk_bf16_f32 v53, v26, v27
    v_exp_f32 v30, v30
    v_exp_f32 v31, v31
    v_cvt_pk_bf16_f32 v54, v28, v29
    v_cvt_pk_bf16_f32 v55, v30, v31
    s_waitcnt lgkmcnt(0)
    v_mfma_f32_32x32x16_bf16 v[16:31], a[0:3], v[96:99], 0
    ds_read_b128 a[4:7], v11 offset:21888
    v_exp_f32 v32, v32
    v_exp_f32 v33, v33
    v_exp_f32 v34, v34
    v_exp_f32 v35, v35
    v_cvt_pk_bf16_f32 v56, v32, v33
    v_exp_f32 v36, v36
    v_mfma_f32_32x32x16_bf16 v[16:31], v[112:115], v[100:103], v[16:31]
    ds_read_b32 v116, v12 offset:21888
    v_exp_f32 v37, v37
    v_cvt_pk_bf16_f32 v57, v34, v35
    v_exp_f32 v38, v38
    v_exp_f32 v39, v39
    v_cvt_pk_bf16_f32 v58, v36, v37
    v_exp_f32 v40, v40
    v_mfma_f32_32x32x16_bf16 v[64:79], a[16:19], v[48:51], v[64:79]
    ds_read_b128 a[8:11], v13 offset:19456
    v_exp_f32 v41, v41
    v_cvt_pk_bf16_f32 v59, v38, v39
    v_exp_f32 v42, v42
    v_exp_f32 v43, v43
    v_cvt_pk_bf16_f32 v60, v40, v41
    v_exp_f32 v44, v44
    v_mfma_f32_32x32x16_bf16 v[64:79], a[20:23], v[52:55], v[64:79]
    ds_read_b128 a[12:15], v14 offset:19456
    v_exp_f32 v45, v45
    v_cvt_pk_bf16_f32 v61, v42, v43
    v_exp_f32 v46, v46
    v_exp_f32 v47, v47
    v_cvt_pk_bf16_f32 v62, v44, v45
    v_cvt_pk_bf16_f32 v63, v46, v47
    s_add_u32 s30, s30, 1
    v_add_u32 v11, 19456, v11
    v_add_u32 v12, 19456, v12
    v_add_u32 v13, 19456, v13
    v_add_u32 v14, 19456, v14
    s_bitcmp1_b32 s54, s30
    s_cbranch_scc1 Lsequ_26
    s_cmp_lt_u32 s30, 8
    s_cbranch_scc1 Lsequ_25
    v_mfma_f32_32x32x16_bf16 v[80:95], a[16:19], v[56:59], v[80:95]
    v_mfma_f32_32x32x16_bf16 v[80:95], a[20:23], v[60:63], v[80:95]
    s_mul_i32 s27, s29, 36864
    s_add_u32 s27, s27, 7528448
    s_lshl_b32 s46, s28, 10
    s_add_u32 s46, s46, s27
    s_lshl_b32 s47, s28, 7
    s_add_u32 s47, s47, s27
    s_add_u32 s47, s47, 32768
    v_mov_b32 v13, 1073741824
    v_cndmask_b32 v13, v13, v10, s[52:53]
    v_mul_f32 v19, 0, v64
    v_fma_f32 v19, v65, 0, v19
    v_fma_f32 v19, v66, 0, v19
    v_fma_f32 v19, v67, 0, v19
    v_fma_f32 v19, v68, 0, v19
    v_fma_f32 v19, v69, 0, v19
    v_fma_f32 v19, v70, 0, v19
    v_fma_f32 v19, v71, 0, v19
    v_fma_f32 v19, v72, 0, v19
    v_fma_f32 v19, v73, 0, v19
    v_fma_f32 v19, v80, 0, v19
    v_fma_f32 v19, v81, 0, v19
    v_fma_f32 v19, v82, 0, v19
    v_fma_f32 v19, v83, 0, v19
    v_fma_f32 v19, v84, 0, v19
    v_fma_f32 v19, v85, 0, v19
    v_fma_f32 v19, v86, 0, v19
    v_fma_f32 v19, v87, 0, v19
    v_fma_f32 v19, v88, 0, v19
    v_fma_f32 v19, v89, 0, v19
    v_add_f32 v19, v19, v74
    v_add_f32 v19, v19, v90
    v_mov_b32 v17, 0x53800000
    v_cmp_nlt_f32 vcc, v19, v17
    v_mov_b32 v20, v74
    v_mov_b32 v21, v74
    v_mov_b32 v22, v90
    v_mov_b32 v23, v90
    s_cmp_lg_u32 s59, 0
    s_cbranch_scc1 Lsequ_28
    s_cbranch_vccnz Lsequ_27
Lsequ_28:
    v_permlane32_swap_b32 v20, v21
    v_permlane32_swap_b32 v22, v23
    v_rcp_f32 v20, v20
    v_rcp_f32 v22, v22
    v_mul_f32 v64, v64, v20
    v_mul_f32 v65, v65, v20
    v_mul_f32 v66, v66, v20
    v_mul_f32 v67, v67, v20
    v_mul_f32 v68, v68, v20
    v_mul_f32 v69, v69, v20
    v_mul_f32 v70, v70, v20
    v_mul_f32 v71, v71, v20
    v_mul_f32 v72, v72, v20
    v_mul_f32 v73, v73, v20
    v_cvt_pk_bf16_f32 v64, v64, v65
    v_cvt_pk_bf16_f32 v65, v66, v67
    v_cvt_pk_bf16_f32 v66, v68, v69
    v_cvt_pk_bf16_f32 v67, v70, v71
    v_cvt_pk_bf16_f32 v68, v72, v73
    buffer_store_dwordx4 v[64:67], v4, s[20:23], s46 offen sc1
    buffer_store_dword v68, v13, s[20:23], s47 offen sc1
    s_add_u32 s46, s46, 36864
    s_add_u32 s47, s47, 36864
    v_mul_f32 v80, v80, v22
    v_mul_f32 v81, v81, v22
    v_mul_f32 v82, v82, v22
    v_mul_f32 v83, v83, v22
    v_mul_f32 v84, v84, v22
    v_mul_f32 v85, v85, v22
    v_mul_f32 v86, v86, v22
    v_mul_f32 v87, v87, v22
    v_mul_f32 v88, v88, v22
    v_mul_f32 v89, v89, v22
    v_cvt_pk_bf16_f32 v80, v80, v81
    v_cvt_pk_bf16_f32 v81, v82, v83
    v_cvt_pk_bf16_f32 v82, v84, v85
    v_cvt_pk_bf16_f32 v83, v86, v87
    v_cvt_pk_bf16_f32 v84, v88, v89
    buffer_store_dwordx4 v[80:83], v4, s[20:23], s46 offen sc1
    buffer_store_dword v84, v13, s[20:23], s47 offen sc1
    s_add_u32 s46, s46, 36864
    s_add_u32 s47, s47, 36864
    s_lshr_b32 s55, s2, 5
    s_lshl_b32 s55, s55, 12
    s_add_u32 s55, s55, 7389184
    s_and_b32 s31, s2, 31
    v_mov_b32 v24, 1
    v_mov_b32 v27, 1073741824
    v_lshlrev_b32 v26, 7, v1
    v_cmp_eq_u32 vcc, s31, v1
    s_nop 1
    v_cndmask_b32 v25, v27, v26, vcc
    v_cndmask_b32 v26, v27, v26, s[52:53]
    s_waitcnt vmcnt(0) lgkmcnt(0)
    s_barrier
    s_cmp_eq_u32 s24, 0
    s_cselect_b32 s31, s55, 1073741824
    buffer_store_dword v24, v25, s[20:23], s31 offen sc1
    buffer_load_dwordx4 a[24:27], v120, s[20:23], s32 offen sc1
    s_add_u32 s32, s32, 18688
    buffer_load_dwordx4 a[28:31], v120, s[20:23], s32 offen sc1
    s_add_u32 s32, s32, 18688
    buffer_load_dwordx4 a[32:35], v120, s[20:23], s32 offen sc1
    s_add_u32 s32, s32, 18688
    buffer_load_dwordx4 a[36:39], v120, s[20:23], s32 offen sc1
    s_add_u32 s32, s32, 18688
    buffer_load_dwordx4 a[40:43], v120, s[20:23], s32 offen sc1
    s_add_u32 s32, s32, 18688
    buffer_load_dwordx4 a[44:47], v120, s[20:23], s32 offen sc1
    s_add_u32 s32, s32, 18688
    buffer_load_dwordx4 a[48:51], v120, s[20:23], s32 offen sc1
    s_add_u32 s32, s32, 18688
    buffer_load_dwordx4 a[52:55], v120, s[20:23], s32 offen sc1
    s_add_u32 s32, s32, 18688
    buffer_load_dwordx4 a[56:59], v120, s[20:23], s32 offen sc1
    s_add_u32 s32, s32, 18688
    buffer_load_dwordx4 v[32:35], v121, s[12:15], s33 offen
    buffer_load_dword v40, v122, s[20:23], s35 offen offset:12 sc1
    s_cmp_lg_u32 s24, 0
    s_cbranch_scc1 Lsequ_30
    s_mov_b32 s51, 0
    s_mov_b32 s48, 4294967295
    s_mov_b32 s49, 0
Lsequ_35:
    buffer_load_dword v27, v26, s[20:23], s55 offen sc1
    s_waitcnt vmcnt(0)
    v_cmp_eq_u32 vcc, 1, v27
    s_add_u32 s51, s51, 1
    s_nop 2
    s_cmp_eq_u64 vcc, s[48:49]
    s_cbranch_scc1 Lsequ_36
    s_sleep 1
    s_cmp_lt_u32 s51, 200000
    s_cbranch_scc1 Lsequ_35
Lsequ_36:
    v_mov_b32 v12, 163836
    ds_write_b32 v12, v24
    s_branch Lsequ_31
Lsequ_30:
    s_mov_b32 s58, s24
Lsequ_37:
    s_and_b32 s46, s2, 31
    s_mul_i32 s46, s46, 331776
    s_lshr_b32 s47, s58, 1
    s_mul_i32 s47, s47, 36864
    s_add_u32 s46, s46, s47
    s_and_b32 s47, s58, 1
    s_lshl_b32 s47, s47, 10
    s_add_u32 s46, s46, s47
    s_add_u32 s46, s46, 13193216
    s_lshl_b32 s47, s58, 10
    s_add_u32 m0, s47, 0
    s_add_u32 s34, s46, 0
    buffer_load_dwordx4 v4, s[20:23], s34 offen sc1 lds
    s_add_u32 m0, s47, 8192
    s_add_u32 s34, s46, 2048
    buffer_load_dwordx4 v4, s[20:23], s34 offen sc1 lds
    s_add_u32 m0, s47, 16384
    s_add_u32 s34, s46, 4096
    buffer_load_dwordx4 v4, s[20:23], s34 offen sc1 lds
    s_add_u32 m0, s47, 24576
    s_add_u32 s34, s46, 6144
    buffer_load_dwordx4 v4, s[20:23], s34 offen sc1 lds
    s_add_u32 m0, s47, 32768
    s_add_u32 s34, s46, 8192
    buffer_load_dwordx4 v4, s[20:23], s34 offen sc1 lds
    s_add_u32 m0, s47, 40960
    s_add_u32 s34, s46, 10240
    buffer_load_dwordx4 v4, s[20:23], s34 offen sc1 lds
    s_add_u32 m0, s47, 49152
    s_add_u32 s34, s46, 12288
    buffer_load_dwordx4 v4, s[20:23], s34 offen sc1 lds
    s_add_u32 m0, s47, 57344
    s_add_u32 s34, s46, 14336
    buffer_load_dwordx4 v4, s[20:23], s34 offen sc1 lds
    s_add_u32 m0, s47, 65536
    s_add_u32 s34, s46, 16384
    buffer_load_dwordx4 v4, s[20:23], s34 offen sc1 lds
    s_add_u32 m0, s47, 73728
    s_add_u32 s34, s46, 18432
    buffer_load_dwordx4 v4, s[20:23], s34 offen sc1 lds
    s_add_u32 m0, s47, 81920
    s_add_u32 s34, s46, 20480
    buffer_load_dwordx4 v4, s[20:23], s34 offen sc1 lds
    s_add_u32 m0, s47, 90112
    s_add_u32 s34, s46, 22528
    buffer_load_dwordx4 v4, s[20:23], s34 offen sc1 lds
    s_cmp_eq_u32 s58, 7
    s_mov_b32 s58, 0
    s_cbranch_scc1 Lsequ_37
    v_mov_b32 v12, 163836
    s_mov_b32 s51, 0
Lsequ_38:
    ds_read_b32 v13, v12
    s_waitcnt lgkmcnt(0)
    v_readfirstlane_b32 s50, v13
    s_add_u32 s51, s51, 1
    s_nop 0
    s_cmp_eq_u32 s50, 1
    s_cbranch_scc1 Lsequ_31
    s_sleep 1
    s_cmp_lt_u32 s51, 3200000
    s_cbranch_scc1 Lsequ_38
Lsequ_31:
    s_lshl_b32 s31, s24, 10
    s_mul_i32 s48, s25, 36864
    s_add_u32 s48, s48, s31
    s_add_u32 s48, s48, 7528448
    s_add_u32 m0, s31, 98304
    s_add_u32 s34, s48, 0
    buffer_load_dwordx4 v4, s[20:23], s34 offen sc1 lds
    s_add_u32 m0, s31, 106496
    s_add_u32 s34, s48, 8192
    buffer_load_dwordx4 v4, s[20:23], s34 offen sc1 lds
    s_add_u32 m0, s31, 114688
    s_add_u32 s34, s48, 16384
    buffer_load_dwordx4 v4, s[20:23], s34 offen sc1 lds
    s_add_u32 m0, s31, 122880
    s_add_u32 s34, s48, 24576
    buffer_load_dwordx4 v4, s[20:23], s34 offen sc1 lds
    s_cmp_ge_u32 s24, 4
    s_cbranch_scc1 Lsequ_39
    s_add_u32 m0, s31, 131072
    s_add_u32 s34, s48, 32768
    buffer_load_dwordx4 v4, s[20:23], s34 offen sc1 lds
Lsequ_39:
    v_lshlrev_b32 v10, 2, v2
    v_lshl_add_u32 v11, v3, 9, v10
    v_add_u32 v11, 131072, v11
    s_and_b32 s31, s24, 3
    s_mul_i32 s31, s31, 9216
    s_cmp_ge_u32 s24, 4
    s_cselect_b32 s31, 0, s31
    s_add_u32 s31, s31, 98304
    v_add_u32 v15, s31, v4
    v_add_u32 v13, 143360, v10
    s_mov_b32 s44, 0xffff0000
    s_waitcnt vmcnt(0)
    s_barrier
    s_cmp_ge_u32 s24, 4
    s_cbranch_scc1 Lsequ_32
    s_cmp_eq_u32 s24, 3
    s_cbranch_scc1 Lsequ_33
    ds_read_b128 v[48:51], v15 offset:0
    ds_read_b128 v[52:55], v15 offset:1024
    ds_read_b128 v[56:59], v15 offset:2048
    ds_read_b128 v[60:63], v15 offset:3072
    s_waitcnt lgkmcnt(3)
    v_mfma_f32_32x32x16_bf16 v[16:31], a[24:27], v[48:51], 0
    ds_read_b128 v[48:51], v15 offset:4096
    s_waitcnt lgkmcnt(3)
    v_mfma_f32_32x32x16_bf16 v[16:31], a[28:31], v[52:55], v[16:31]
    ds_read_b128 v[52:55], v15 offset:5120
    s_waitcnt lgkmcnt(3)
    v_mfma_f32_32x32x16_bf16 v[16:31], a[32:35], v[56:59], v[16:31]
    ds_read_b128 v[56:59], v15 offset:6144
    s_waitcnt lgkmcnt(3)
    v_mfma_f32_32x32x16_bf16 v[16:31], a[36:39], v[60:63], v[16:31]
    ds_read_b128 v[60:63], v15 offset:7168
    s_waitcnt lgkmcnt(3)
    v_mfma_f32_32x32x16_bf16 v[16:31], a[40:43], v[48:51], v[16:31]
    ds_read_b128 v[48:51], v15 offset:8192
    s_waitcnt lgkmcnt(3)
    v_mfma_f32_32x32x16_bf16 v[16:31], a[44:47], v[52:55], v[16:31]
    s_waitcnt lgkmcnt(2)
    v_mfma_f32_32x32x16_bf16 v[16:31], a[48:51], v[56:59], v[16:31]
    s_waitcnt lgkmcnt(1)
    v_mfma_f32_32x32x16_bf16 v[16:31], a[52:55], v[60:63], v[16:31]
    s_waitcnt lgkmcnt(0)
    v_mfma_f32_32x32x16_bf16 v[16:31], a[56:59], v[48:51], v[16:31]
    s_branch Lsequ_34
Lsequ_33:
    ds_read_b128 v[48:51], v15 offset:0
    ds_read_b128 v[52:55], v15 offset:1024
    ds_read_b128 v[56:59], v15 offset:2048
    ds_read_b128 v[60:63], v15 offset:3072
    s_waitcnt lgkmcnt(3)
    v_mfma_f32_32x32x16_bf16 v[16:31], a[24:27], v[48:51], 0
    ds_read_b128 v[48:51], v15 offset:4096
    s_waitcnt lgkmcnt(3)
    v_mfma_f32_32x32x16_bf16 v[16:31], a[28:31], v[52:55], v[16:31]
    ds_read_b32 v52, v11 offset:0
    ds_read_b32 v53, v11 offset:128
    ds_read_b32 v54, v11 offset:256
    ds_read_b32 v55, v11 offset:384
    s_waitcnt lgkmcnt(6)
    v_mfma_f32_32x32x16_bf16 v[16:31], a[32:35], v[56:59], v[16:31]
    ds_read_b32 v56, v11 offset:1024
    ds_read_b32 v57, v11 offset:1152
    ds_read_b32 v58, v11 offset:1280
    ds_read_b32 v59, v11 offset:1408
    s_waitcnt lgkmcnt(9)
    v_mfma_f32_32x32x16_bf16 v[16:31], a[36:39], v[60:63], v[16:31]
    ds_read_b32 v60, v11 offset:2048
    ds_read_b32 v61, v11 offset:2176
    ds_read_b32 v62, v11 offset:2304
    ds_read_b32 v63, v11 offset:2432
    s_waitcnt lgkmcnt(12)
    v_mfma_f32_32x32x16_bf16 v[16:31], a[40:43], v[48:51], v[16:31]
    ds_read_b32 v48, v11 offset:3072
    ds_read_b32 v49, v11 offset:3200
    ds_read_b32 v50, v11 offset:3328
    ds_read_b32 v51, v11 offset:3456
    s_waitcnt lgkmcnt(12)
    v_mfma_f32_32x32x16_bf16 v[16:31], a[44:47], v[52:55], v[16:31]
    s_waitcnt lgkmcnt(8)
    v_mfma_f32_32x32x16_bf16 v[16:31], a[48:51], v[56:59], v[16:31]
    s_waitcnt lgkmcnt(4)
    v_mfma_f32_32x32x16_bf16 v[16:31], a[52:55], v[60:63], v[16:31]
    s_waitcnt lgkmcnt(0)
    v_mfma_f32_32x32x16_bf16 v[16:31], a[56:59], v[48:51], v[16:31]
Lsequ_34:
    s_lshl_b32 s31, s24, 11
    s_add_u32 s31, s31, 135168
    v_add_u32 v12, s31, v4
    s_lshl_b32 s31, s24, 7
    v_add_u32 v14, s31, v13
    s_nop 6
    v_add_f32 v7, v24, v25
    ds_write_b32 v14, v7
    ds_write_b128 v12, v[16:19]
    ds_write_b128 v12, v[20:23] offset:1024
    s_waitcnt lgkmcnt(0)
    s_barrier
    s_cmp_lg_u32 s24, 1
    s_cbranch_scc1 Lsequ_7
    v_add_u32 v12, 135168, v4
    ds_read_b128 v[48:51], v12 offset:0
    ds_read_b128 v[52:55], v12 offset:1024
    ds_read_b128 v[64:67], v12 offset:4096
    ds_read_b128 v[68:71], v12 offset:5120
    ds_read_b128 v[72:75], v12 offset:6144
    ds_read_b128 v[76:79], v12 offset:7168
    s_waitcnt lgkmcnt(0)
    v_add_f32 v16, v16, v48
    v_add_f32 v64, v64, v72
    v_add_f32 v17, v17, v49
    v_add_f32 v65, v65, v73
    v_add_f32 v18, v18, v50
    v_add_f32 v66, v66, v74
    v_add_f32 v19, v19, v51
    v_add_f32 v67, v67, v75
    v_add_f32 v20, v20, v52
    v_add_f32 v68, v68, v76
    v_add_f32 v21, v21, v53
    v_add_f32 v69, v69, v77
    v_add_f32 v22, v22, v54
    v_add_f32 v70, v70, v78
    v_add_f32 v23, v23, v55
    v_add_f32 v71, v71, v79
    v_add_f32 v16, v16, v64
    v_add_f32 v17, v17, v65
    v_add_f32 v18, v18, v66
    v_add_f32 v19, v19, v67
    v_add_f32 v20, v20, v68
    v_add_f32 v21, v21, v69
    v_add_f32 v22, v22, v70
    v_add_f32 v23, v23, v71
    ds_read_b32 v44, v13 offset:0
    ds_read_b32 v45, v13 offset:128
    ds_read_b32 v46, v13 offset:256
    ds_read_b32 v47, v13 offset:384
    v_lshlrev_b32 v48, 16, v32
    v_and_b32 v49, s44, v32
    v_lshlrev_b32 v50, 16, v33
    v_and_b32 v51, s44, v33
    v_lshlrev_b32 v52, 16, v34
    v_and_b32 v53, s44, v34
    v_lshlrev_b32 v54, 16, v35
    v_and_b32 v55, s44, v35
    s_mul_i32 s36, s25, 36
    s_mul_i32 s37, s26, 9
    s_add_u32 s36, s36, s37
    s_lshl_b32 s37, s45, 1
    s_add_u32 s36, s36, s37
    s_lshl_b32 s36, s36, 10
    s_add_u32 s36, s36, 10563584
    v_add_f32 v16, v16, v48
    v_add_f32 v17, v17, v49
    v_add_f32 v18, v18, v50
    v_add_f32 v19, v19, v51
    v_add_f32 v20, v20, v52
    v_add_f32 v21, v21, v53
    v_add_f32 v22, v22, v54
    v_add_f32 v23, v23, v55
    s_waitcnt lgkmcnt(0)
    v_add_f32 v44, v44, v45
    v_add_f32 v46, v46, v47
    v_add_f32 v40, v40, v44
    v_add_f32 v40, v40, v46
    v_sub_f32 v16, v16, v40
    v_sub_f32 v17, v17, v40
    v_sub_f32 v18, v18, v40
    v_sub_f32 v19, v19, v40
    v_sub_f32 v20, v20, v40
    v_sub_f32 v21, v21, v40
    v_sub_f32 v22, v22, v40
    v_sub_f32 v23, v23, v40
    v_cvt_pk_bf16_f32 v64, v16, v17
    v_cvt_pk_bf16_f32 v65, v18, v19
    v_cvt_pk_bf16_f32 v66, v20, v21
    v_cvt_pk_bf16_f32 v67, v22, v23
    buffer_store_dwordx4 v[64:67], v4, s[20:23], s36 offen offset:0 sc1
    v_mul_f32 v41, v16, v16
    v_fmac_f32 v41, v17, v17
    v_fmac_f32 v41, v18, v18
    v_fmac_f32 v41, v19, v19
    v_fmac_f32 v41, v20, v20
    v_fmac_f32 v41, v21, v21
    v_fmac_f32 v41, v22, v22
    v_fmac_f32 v41, v23, v23
    v_mov_b32 v42, v41
    s_lshl_b32 s35, s25, 2
    s_add_u32 s35, s35, s26
    s_lshl_b32 s35, s35, 3
    s_add_u32 s35, s35, s45
    s_lshl_b32 s35, s35, 7
    s_add_u32 s35, s35, 12931072
    v_permlane32_swap_b32 v41, v42
    v_add_f32 v41, v41, v42
    buffer_store_dword v41, v10, s[20:23], s35 offen sc1
    s_lshl_b32 s34, s25, 7
    s_add_u32 s34, s34, 12922880
    s_cmp_eq_u32 s26, 0
    s_cselect_b32 s34, s34, 1073741824
    buffer_store_dword v40, v10, s[20:23], s34 offen sc1
    s_branch Lsequ_7
Lsequ_32:
    ds_read_b128 v[48:51], v15 offset:0
    ds_read_b128 v[52:55], v15 offset:1024
    ds_read_b128 v[56:59], v15 offset:2048
    ds_read_b128 v[60:63], v15 offset:3072
    s_waitcnt lgkmcnt(3)
    v_mfma_f32_32x32x16_bf16 v[16:31], a[0:3], v[48:51], v[16:31]
    ds_read_b128 v[48:51], v15 offset:4096
    s_waitcnt lgkmcnt(3)
    v_mfma_f32_32x32x16_bf16 v[16:31], a[4:7], v[52:55], v[16:31]
    ds_read_b128 v[52:55], v15 offset:5120
    s_waitcnt lgkmcnt(3)
    v_mfma_f32_32x32x16_bf16 v[16:31], a[8:11], v[56:59], v[16:31]
    ds_read_b128 v[56:59], v15 offset:6144
    s_waitcnt lgkmcnt(3)
    v_mfma_f32_32x32x16_bf16 v[16:31], a[12:15], v[60:63], v[16:31]
    ds_read_b128 v[60:63], v15 offset:7168
    s_waitcnt lgkmcnt(3)
    v_mfma_f32_32x32x16_bf16 v[16:31], a[16:19], v[48:51], v[16:31]
    ds_read_b128 v[48:51], v15 offset:8192
    s_waitcnt lgkmcnt(3)
    v_mfma_f32_32x32x16_bf16 v[16:31], a[20:23], v[52:55], v[16:31]
    ds_read_b128 v[52:55], v15 offset:9216
    s_waitcnt lgkmcnt(3)
    v_mfma_f32_32x32x16_bf16 v[16:31], a[24:27], v[56:59], v[16:31]
    ds_read_b128 v[56:59], v15 offset:10240
    s_waitcnt lgkmcnt(3)
    v_mfma_f32_32x32x16_bf16 v[16:31], a[28:31], v[60:63], v[16:31]
    ds_read_b128 v[60:63], v15 offset:11264
    s_waitcnt lgkmcnt(3)
    v_mfma_f32_32x32x16_bf16 v[16:31], a[32:35], v[48:51], v[16:31]
    ds_read_b128 v[48:51], v15 offset:12288
    s_waitcnt lgkmcnt(3)
    v_mfma_f32_32x32x16_bf16 v[16:31], a[36:39], v[52:55], v[16:31]
    ds_read_b128 v[52:55], v15 offset:13312
    s_waitcnt lgkmcnt(3)
    v_mfma_f32_32x32x16_bf16 v[16:31], a[40:43], v[56:59], v[16:31]
    ds_read_b128 v[56:59], v15 offset:14336
    s_waitcnt lgkmcnt(3)
    v_mfma_f32_32x32x16_bf16 v[16:31], a[44:47], v[60:63], v[16:31]
    ds_read_b128 v[60:63], v15 offset:15360
    s_waitcnt lgkmcnt(3)
    v_mfma_f32_32x32x16_bf16 v[16:31], a[48:51], v[48:51], v[16:31]
    ds_read_b128 v[48:51], v15 offset:16384
    s_waitcnt lgkmcnt(3)
    v_mfma_f32_32x32x16_bf16 v[16:31], a[52:55], v[52:55], v[16:31]
    ds_read_b128 v[52:55], v15 offset:17408
    s_waitcnt lgkmcnt(3)
    v_mfma_f32_32x32x16_bf16 v[16:31], a[56:59], v[56:59], v[16:31]
    ds_read_b128 v[56:59], v15 offset:18432
    s_waitcnt lgkmcnt(3)
    v_mfma_f32_32x32x16_bf16 v[16:31], a[60:63], v[60:63], v[16:31]
    ds_read_b128 v[60:63], v15 offset:19456
    s_waitcnt lgkmcnt(3)
    v_mfma_f32_32x32x16_bf16 v[16:31], a[64:67], v[48:51], v[16:31]
    ds_read_b128 v[48:51], v15 offset:20480
    s_waitcnt lgkmcnt(3)
    v_mfma_f32_32x32x16_bf16 v[16:31], a[68:71], v[52:55], v[16:31]
    ds_read_b128 v[52:55], v15 offset:21504
    s_waitcnt lgkmcnt(3)
    v_mfma_f32_32x32x16_bf16 v[16:31], a[72:75], v[56:59], v[16:31]
    ds_read_b128 v[56:59], v15 offset:22528
    s_waitcnt lgkmcnt(3)
    v_mfma_f32_32x32x16_bf16 v[16:31], a[76:79], v[60:63], v[16:31]
    ds_read_b128 v[60:63], v15 offset:23552
    s_waitcnt lgkmcnt(3)
    v_mfma_f32_32x32x16_bf16 v[16:31], a[80:83], v[48:51], v[16:31]
    ds_read_b128 v[48:51], v15 offset:24576
    s_waitcnt lgkmcnt(3)
    v_mfma_f32_32x32x16_bf16 v[16:31], a[84:87], v[52:55], v[16:31]
    ds_read_b128 v[52:55], v15 offset:25600
    s_waitcnt lgkmcnt(3)
    v_mfma_f32_32x32x16_bf16 v[16:31], a[88:91], v[56:59], v[16:31]
    ds_read_b128 v[56:59], v15 offset:26624
    s_waitcnt lgkmcnt(3)
    v_mfma_f32_32x32x16_bf16 v[16:31], a[92:95], v[60:63], v[16:31]
    ds_read_b128 v[60:63], v15 offset:27648
    s_waitcnt lgkmcnt(3)
    v_mfma_f32_32x32x16_bf16 v[16:31], a[96:99], v[48:51], v[16:31]
    ds_read_b128 v[48:51], v15 offset:28672
    s_waitcnt lgkmcnt(3)
    v_mfma_f32_32x32x16_bf16 v[16:31], a[100:103], v[52:55], v[16:31]
    ds_read_b128 v[52:55], v15 offset:29696
    s_waitcnt lgkmcnt(3)
    v_mfma_f32_32x32x16_bf16 v[16:31], a[104:107], v[56:59], v[16:31]
    ds_read_b128 v[56:59], v15 offset:30720
    s_waitcnt lgkmcnt(3)
    v_mfma_f32_32x32x16_bf16 v[16:31], a[108:111], v[60:63], v[16:31]
    ds_read_b128 v[60:63], v15 offset:31744
    s_waitcnt lgkmcnt(3)
    v_mfma_f32_32x32x16_bf16 v[16:31], a[112:115], v[48:51], v[16:31]
    ds_read_b32 v48, v11 offset:0
    ds_read_b32 v49, v11 offset:128
    ds_read_b32 v50, v11 offset:256
    ds_read_b32 v51, v11 offset:384
    s_waitcnt lgkmcnt(6)
    v_mfma_f32_32x32x16_bf16 v[16:31], a[116:119], v[52:55], v[16:31]
    ds_read_b32 v52, v11 offset:1024
    ds_read_b32 v53, v11 offset:1152
    ds_read_b32 v54, v11 offset:1280
    ds_read_b32 v55, v11 offset:1408
    s_waitcnt lgkmcnt(9)
    v_mfma_f32_32x32x16_bf16 v[16:31], a[120:123], v[56:59], v[16:31]
    ds_read_b32 v56, v11 offset:2048
    ds_read_b32 v57, v11 offset:2176
    ds_read_b32 v58, v11 offset:2304
    ds_read_b32 v59, v11 offset:2432
    s_waitcnt lgkmcnt(12)
    v_mfma_f32_32x32x16_bf16 v[16:31], a[124:127], v[60:63], v[16:31]
    ds_read_b32 v60, v11 offset:3072
    ds_read_b32 v61, v11 offset:3200
    ds_read_b32 v62, v11 offset:3328
    ds_read_b32 v63, v11 offset:3456
    s_waitcnt lgkmcnt(12)
    v_mfma_f32_32x32x16_bf16 v[16:31], v[96:99], v[48:51], v[16:31]
    s_waitcnt lgkmcnt(8)
    v_mfma_f32_32x32x16_bf16 v[16:31], v[100:103], v[52:55], v[16:31]
    s_waitcnt lgkmcnt(4)
    v_mfma_f32_32x32x16_bf16 v[16:31], v[104:107], v[56:59], v[16:31]
    s_waitcnt lgkmcnt(0)
    v_mfma_f32_32x32x16_bf16 v[16:31], v[108:111], v[60:63], v[16:31]
    s_barrier
    ds_read_b32 v44, v13 offset:0
    ds_read_b32 v45, v13 offset:128
    ds_read_b32 v46, v13 offset:256
    ds_read_b32 v47, v13 offset:384
    s_mul_i32 s36, s25, 36
    s_mul_i32 s37, s26, 9
    s_add_u32 s36, s36, s37
    s_lshl_b32 s37, s45, 1
    s_add_u32 s36, s36, s37
    s_lshl_b32 s36, s36, 10
    s_add_u32 s36, s36, 10563584
    s_waitcnt lgkmcnt(0)
    v_add_f32 v44, v44, v45
    v_add_f32 v46, v46, v47
    v_add_f32 v40, v40, v44
    v_add_f32 v40, v40, v46
    v_sub_f32 v16, v16, v40
    v_sub_f32 v17, v17, v40
    v_sub_f32 v18, v18, v40
    v_sub_f32 v19, v19, v40
    v_sub_f32 v20, v20, v40
    v_sub_f32 v21, v21, v40
    v_sub_f32 v22, v22, v40
    v_sub_f32 v23, v23, v40
    v_sub_f32 v24, v24, v40
    v_sub_f32 v25, v25, v40
    v_sub_f32 v26, v26, v40
    v_sub_f32 v27, v27, v40
    v_sub_f32 v28, v28, v40
    v_sub_f32 v29, v29, v40
    v_sub_f32 v30, v30, v40
    v_sub_f32 v31, v31, v40
    v_cvt_pk_bf16_f32 v64, v16, v17
    v_cvt_pk_bf16_f32 v65, v18, v19
    v_cvt_pk_bf16_f32 v66, v20, v21
    v_cvt_pk_bf16_f32 v67, v22, v23
    buffer_store_dwordx4 v[64:67], v4, s[20:23], s36 offen offset:0 sc1
    v_cvt_pk_bf16_f32 v68, v24, v25
    v_cvt_pk_bf16_f32 v69, v26, v27
    v_cvt_pk_bf16_f32 v70, v28, v29
    v_cvt_pk_bf16_f32 v71, v30, v31
    buffer_store_dwordx4 v[68:71], v4, s[20:23], s36 offen offset:1024 sc1
    v_mul_f32 v41, v16, v16
    v_fmac_f32 v41, v17, v17
    v_fmac_f32 v41, v18, v18
    v_fmac_f32 v41, v19, v19
    v_fmac_f32 v41, v20, v20
    v_fmac_f32 v41, v21, v21
    v_fmac_f32 v41, v22, v22
    v_fmac_f32 v41, v23, v23
    v_fmac_f32 v41, v24, v24
    v_fmac_f32 v41, v25, v25
    v_fmac_f32 v41, v26, v26
    v_fmac_f32 v41, v27, v27
    v_fmac_f32 v41, v28, v28
    v_fmac_f32 v41, v29, v29
    v_fmac_f32 v41, v30, v30
    v_fmac_f32 v41, v31, v31
    v_mov_b32 v42, v41
    s_lshl_b32 s35, s25, 2
    s_add_u32 s35, s35, s26
    s_lshl_b32 s35, s35, 3
    s_add_u32 s35, s35, s45
    s_lshl_b32 s35, s35, 7
    s_add_u32 s35, s35, 12931072
    v_permlane32_swap_b32 v41, v42
    v_add_f32 v41, v41, v42
    buffer_store_dword v41, v10, s[20:23], s35 offen sc1
    s_branch Lsequ_7
Lsequ_26:
    s_barrier
    s_branch Lsequ_25
Lsequ_27:
    s_mov_b32 s59, 1
    s_mov_b32 s54, 0
    v_mov_b32 v7, 0xff7fffff
    v_mov_b32 v8, 0xff7fffff
    v_mov_b32 v101, 0
    v_mov_b32 v109, 0
    v_mov_b32 v11, v4
    v_mov_b32 v12, v5
    s_mov_b32 s30, 0
    s_waitcnt lgkmcnt(0)
    v_mov_b32 v64, 0
    v_mov_b32 v65, 0
    v_mov_b32 v66, 0
    v_mov_b32 v67, 0
    v_mov_b32 v68, 0
    v_mov_b32 v69, 0
    v_mov_b32 v70, 0
    v_mov_b32 v71, 0
    v_mov_b32 v72, 0
    v_mov_b32 v73, 0
    v_mov_b32 v74, 0
    v_mov_b32 v75, 0
    v_mov_b32 v76, 0
    v_mov_b32 v77, 0
    v_mov_b32 v78, 0
    v_mov_b32 v79, 0
    v_mov_b32 v80, 0
    v_mov_b32 v81, 0
    v_mov_b32 v82, 0
    v_mov_b32 v83, 0
    v_mov_b32 v84, 0
    v_mov_b32 v85, 0
    v_mov_b32 v86, 0
    v_mov_b32 v87, 0
    v_mov_b32 v88, 0
    v_mov_b32 v89, 0
    v_mov_b32 v90, 0
    v_mov_b32 v91, 0
    v_mov_b32 v92, 0
    v_mov_b32 v93, 0
    v_mov_b32 v94, 0
    v_mov_b32 v95, 0
    v_mov_b32 v56, 0
    v_accvgpr_write_b32 a16, 0
    v_mov_b32 v57, 0
    v_accvgpr_write_b32 a17, 0
    v_mov_b32 v58, 0
    v_accvgpr_write_b32 a18, 0
    v_mov_b32 v59, 0
    v_accvgpr_write_b32 a19, 0
    v_mov_b32 v60, 0
    v_accvgpr_write_b32 a20, 0
    v_mov_b32 v61, 0
    v_accvgpr_write_b32 a21, 0
    v_mov_b32 v62, 0
    v_accvgpr_write_b32 a22, 0
    v_mov_b32 v63, 0
    v_accvgpr_write_b32 a23, 0
Lsequ_40:
    ds_read_b128 a[0:3], v11
    ds_read_b32 v112, v12
    v_add_u32 v11, 2432, v11
    v_add_u32 v12, 2432, v12
    s_waitcnt lgkmcnt(0)
    v_mfma_f32_32x32x16_bf16 v[16:31], a[0:3], v[96:99], 0
    v_mfma_f32_32x32x16_bf16 v[16:31], v[112:115], v[100:103], v[16:31]
    v_mfma_f32_32x32x16_bf16 v[32:47], a[0:3], v[104:107], 0
    v_mfma_f32_32x32x16_bf16 v[32:47], v[112:115], v[108:111], v[32:47]
    s_nop 9
    v_max3_f32 v7, v16, v17, v7
    v_max3_f32 v7, v18, v19, v7
    v_max3_f32 v7, v20, v21, v7
    v_max3_f32 v7, v22, v23, v7
    v_max3_f32 v7, v24, v25, v7
    v_max3_f32 v7, v26, v27, v7
    v_max3_f32 v7, v28, v29, v7
    v_max3_f32 v7, v30, v31, v7
    v_max3_f32 v8, v32, v33, v8
    v_max3_f32 v8, v34, v35, v8
    v_max3_f32 v8, v36, v37, v8
    v_max3_f32 v8, v38, v39, v8
    v_max3_f32 v8, v40, v41, v8
    v_max3_f32 v8, v42, v43, v8
    v_max3_f32 v8, v44, v45, v8
    v_max3_f32 v8, v46, v47, v8
    s_add_u32 s30, s30, 1
    s_cmp_lt_u32 s30, 64
    s_cbranch_scc1 Lsequ_40
    s_branch Lsequ_24
Lsequ_5:
    s_bfe_u32 s31, s2, 0x20001
    s_lshl_b32 s31, s31, 11
    s_add_u32 s31, s31, 7364608
    v_lshrrev_b32 v16, 4, v1
    v_add_u32 v16, 1, v16
    v_lshlrev_b32 v16, 6, v16
    v_and_b32 v17, 15, v1
    v_add_u32 v16, v16, v17
    s_lshr_b32 s50, s2, 5
    s_lshl_b32 s50, s50, 1
    v_add_u32 v17, s50, v17
    v_cmp_gt_u32 vcc, 32, v1
    s_nop 1
    v_cndmask_b32 v16, v17, v16, vcc
    v_lshlrev_b32 v16, 7, v16
    v_mov_b32 v17, 1073741824
    v_cmp_gt_u32 vcc, 34, v1
    s_nop 1
    v_cndmask_b32 v16, v17, v16, vcc
    s_mov_b32 s51, 0
    s_mov_b32 s48, 4294967295
    s_mov_b32 s49, 3
Lsequ_41:
    buffer_load_dword v17, v16, s[20:23], s31 offen sc1
    s_waitcnt vmcnt(0)
    v_cmp_eq_u32 vcc, 1, v17
    s_add_u32 s51, s51, 1
    s_nop 2
    s_cmp_eq_u64 vcc, s[48:49]
    s_cbranch_scc1 Lsequ_42
    s_sleep 1
    s_cmp_lt_u32 s51, 200000
    s_cbranch_scc1 Lsequ_41
Lsequ_42:
    s_branch Lsequ_5_b
Lsequ_23:
    s_setprio 3
    s_load_dwordx4 s[64:67], s[0:1], 32
    s_load_dwordx2 s[68:69], s[0:1], 48
    s_sub_u32 s63, s24, 4
    s_mul_i32 s28, s28, 155648
    s_lshl_b32 s29, s63, 10
    s_add_u32 s28, s28, s29
    s_cmp_lt_u32 s2, 64
    s_cbranch_scc1 Lsequ_43
    s_barrier
    s_barrier
Lsequ_43:
    s_waitcnt lgkmcnt(0)
    s_lshl_b32 s31, s63, 8
    s_add_u32 s31, s31, s2
    s_mov_b32 s18, 5308416
    s_mov_b32 s19, 0x00020000
    s_mov_b32 s38, 5308416
    s_mov_b32 s39, 0x00020000
    v_lshrrev_b32 v7, 4, v1
    v_and_b32 v8, 15, v1
    v_mul_u32_u24 v5, 73728, v7
    v_lshl_add_u32 v5, v8, 4, v5
    v_add_u32 v6, 36864, v5
    s_cmp_ge_u32 s31, 648
    s_cselect_b32 s32, 1, 0
    s_cselect_b32 s16, s66, s64
    s_cselect_b32 s17, s67, s65
    s_mul_i32 s33, s32, 648
    s_sub_u32 s33, s31, s33
    s_mul_i32 s34, s33, 3641
    s_lshr_b32 s34, s34, 16
    s_mul_i32 s35, s34, 18
    s_sub_u32 s35, s33, s35
    s_mul_i32 s58, s35, 294912
    s_lshl_b32 s44, s34, 8
    s_add_u32 s58, s58, s44
    s_mul_i32 s59, s34, 294912
    s_lshl_b32 s44, s35, 11
    s_add_u32 s59, s59, s44
    s_lshl_b32 s44, s32, 10
    s_add_u32 s59, s59, s44
    s_add_u32 s59, s59, 13193216
    s_and_b32 s17, s17, 0xffff
    s_add_u32 s47, s31, 1024
    s_min_u32 s31, s47, 1943
    s_cmp_ge_u32 s31, 1296
    s_cbranch_scc1 Lsequ_44
    s_cmp_ge_u32 s31, 648
    s_cselect_b32 s32, 1, 0
    s_cselect_b32 s36, s66, s64
    s_cselect_b32 s37, s67, s65
    s_mul_i32 s33, s32, 648
    s_sub_u32 s33, s31, s33
    s_mul_i32 s34, s33, 3641
    s_lshr_b32 s34, s34, 16
    s_mul_i32 s35, s34, 18
    s_sub_u32 s35, s33, s35
    s_mul_i32 s48, s35, 294912
    s_lshl_b32 s44, s34, 8
    s_add_u32 s48, s48, s44
    s_mul_i32 s56, s34, 294912
    s_lshl_b32 s44, s35, 11
    s_add_u32 s56, s56, s44
    s_lshl_b32 s44, s32, 10
    s_add_u32 s56, s56, s44
    s_add_u32 s56, s56, 13193216
    v_mov_b32 v9, v5
    v_mov_b32 v12, v6
    v_mov_b32 v10, 0
    s_mov_b32 s57, 0
    s_branch Lsequ_45
Lsequ_44:
    s_mov_b32 s36, s68
    s_mov_b32 s37, s69
    s_sub_u32 s33, s31, 1296
    s_lshl_b32 s33, s33, 6
    v_add_u32 v7, s33, v1
    s_mov_b32 s44, 58255
    v_mul_lo_u32 v8, v7, s44
    v_lshrrev_b32 v8, 22, v8
    v_mul_u32_u24 v9, 72, v8
    v_sub_u32 v9, v7, v9
    v_mul_u32_u24 v10, 57, v9
    v_lshrrev_b32 v10, 9, v10
    v_mul_u32_u24 v11, 9, v10
    v_sub_u32 v11, v9, v11
    v_mul_u32_u24 v10, 663552, v10
    v_lshl_add_u32 v10, v11, 7, v10
    v_mul_u32_u24 v11, 1152, v8
    v_add_u32 v10, v10, v11
    v_lshrrev_b32 v11, 2, v8
    v_and_b32 v8, 3, v8
    v_and_b32 v13, 31, v11
    v_mul_u32_u24 v14, 9, v13
    v_lshrrev_b32 v15, 5, v11
    v_lshl_add_u32 v14, v15, 1, v14
    v_add_u32 v15, 1, v14
    v_mul_u32_u24 v13, 18, v13
    v_lshrrev_b32 v2, 1, v8
    v_mul_u32_u24 v2, 9, v2
    v_add3_u32 v2, v2, v13, 8
    v_cmp_gt_u32 vcc, 0x80, v11
    v_and_b32 v3, 1, v8
    v_lshlrev_b32 v3, 1, v3
    v_cndmask_b32 v14, v2, v14, vcc
    v_cndmask_b32 v15, v2, v15, vcc
    v_add_u32 v2, 1, v3
    v_cndmask_b32 v3, v3, v8, vcc
    v_cndmask_b32 v2, v2, v8, vcc
    v_lshrrev_b32 v13, 3, v15
    v_lshlrev_b32 v13, 7, v13
    v_lshl_add_u32 v13, v2, 5, v13
    v_and_b32 v15, 7, v15
    v_add_u32 v13, v13, v15
    v_mul_u32_u24 v13, 1152, v13
    v_lshl_add_u32 v12, v9, 4, v13
    v_lshrrev_b32 v13, 3, v14
    v_lshlrev_b32 v13, 7, v13
    v_lshl_add_u32 v13, v3, 5, v13
    v_and_b32 v14, 7, v14
    v_add_u32 v13, v13, v14
    v_mul_u32_u24 v13, 1152, v13
    v_lshl_add_u32 v9, v9, 4, v13
    s_mov_b32 s48, 0
    s_mov_b32 s56, 42684416
    s_mov_b32 s57, 1
    s_cmp_lt_u32 s47, 1944
    s_cselect_b32 s56, s56, 1073741824
Lsequ_45:
    s_and_b32 s37, s37, 0xffff
    s_lshl_b32 s44, s63, 11
    s_add_u32 s44, s44, 155648
    v_and_b32 v13, 7, v1
    v_lshrrev_b32 v14, 3, v1
    v_and_b32 v11, 15, v1
    v_lshlrev_b32 v11, 7, v11
    v_lshl_add_u32 v11, v13, 4, v11
    v_add_u32 v11, s44, v11
    v_xor_b32 v15, v13, v14
    v_lshlrev_b32 v15, 4, v15
    v_lshl_add_u32 v15, v14, 7, v15
    v_add_u32 v15, s44, v15
    v_lshlrev_b32 v14, 2, v14
    ds_bpermute_b32 v88, v14, v10 offset:0
    ds_bpermute_b32 v89, v14, v10 offset:32
    ds_bpermute_b32 v90, v14, v10 offset:64
    ds_bpermute_b32 v91, v14, v10 offset:96
    ds_bpermute_b32 v92, v14, v10 offset:128
    ds_bpermute_b32 v93, v14, v10 offset:160
    ds_bpermute_b32 v94, v14, v10 offset:192
    ds_bpermute_b32 v95, v14, v10 offset:224
    v_xor_b32 v80, 0, v11
    v_xor_b32 v81, 16, v11
    v_xor_b32 v82, 32, v11
    v_xor_b32 v83, 48, v11
    v_xor_b32 v84, 64, v11
    v_xor_b32 v85, 80, v11
    v_xor_b32 v86, 96, v11
    v_xor_b32 v87, 112, v11
    s_waitcnt lgkmcnt(0)
    v_lshl_add_u32 v88, v13, 4, v88
    v_lshl_add_u32 v89, v13, 4, v89
    v_lshl_add_u32 v90, v13, 4, v90
    v_lshl_add_u32 v91, v13, 4, v91
    v_lshl_add_u32 v92, v13, 4, v92
    v_lshl_add_u32 v93, v13, 4, v93
    v_lshl_add_u32 v94, v13, 4, v94
    v_lshl_add_u32 v95, v13, 4, v95
    s_lshr_b32 s25, s2, 5
    s_lshl_b32 s25, s25, 3
    s_and_b32 s26, s2, 7
    s_add_u32 s25, s25, s26
    s_bfe_u32 s26, s2, 0x20003
    s_mov_b32 s45, s63
    s_mul_i32 s30, s26, 144
    s_lshl_b32 s31, s45, 5
    s_add_u32 s30, s30, s31
    v_and_b32 v2, 31, v1
    v_lshrrev_b32 v3, 5, v1
    v_and_b32 v7, 0x13, v2
    v_bfe_u32 v8, v2, 2, 1
    v_lshl_add_u32 v7, v8, 3, v7
    v_bfe_u32 v8, v2, 3, 1
    v_lshl_add_u32 v7, v8, 2, v7
    v_add_u32 v7, s30, v7
    v_and_b32 v8, 1, v2
    v_add_u32 v8, 576, v8
    s_cmp_eq_u32 s45, 4
    s_cselect_b32 s31, 15, 63
    v_cmp_lt_u32 vcc, s31, v2
    s_mul_i32 s33, s25, 36864
    s_lshl_b32 s34, s30, 1
    v_cndmask_b32 v7, v7, v8, vcc
    v_mul_u32_u24 v8, 9344, v3
    v_lshl_add_u32 v7, v7, 4, v8
    s_add_u32 s33, s33, s34
    s_lshl_b32 s35, s25, 9
    s_add_u32 s35, s35, 7479296
    v_mul_u32_u24 v8, 1152, v2
    v_lshl_add_u32 v8, v3, 4, v8
    v_lshlrev_b32 v11, 4, v2
    s_mov_b32 s12, s4
    s_and_b32 s13, s5, 0xffff
    s_mov_b32 s14, 2359296
    s_mov_b32 s15, 0x00020000
    s_mov_b32 s40, s8
    s_and_b32 s41, s9, 0xffff
    s_mov_b32 s42, 256
    s_mov_b32 s43, 0x00020000
    v_mov_b32 v10, 0
    s_mov_b32 s60, 0x05040100
    s_mov_b32 s61, 0x07060302
    s_barrier
    s_mov_b32 s30, 10
Lsequ_46:
    s_mov_b32 m0, s29
    s_add_u32 s29, s29, 4096
    buffer_load_dwordx4 v4, s[20:23], s28 offen sc1 lds
    s_add_u32 s28, s28, 4096
    s_sub_u32 s30, s30, 1
    s_cmp_lg_u32 s30, 0
    s_cbranch_scc1 Lsequ_46
    s_waitcnt vmcnt(4)
    s_barrier
    s_mov_b32 s30, 28
Lsequ_47:
    s_mov_b32 m0, s29
    s_add_u32 s29, s29, 4096
    buffer_load_dwordx4 v4, s[20:23], s28 offen sc1 lds
    s_add_u32 s28, s28, 4096
    s_sub_u32 s30, s30, 1
    s_cmp_lg_u32 s30, 0
    s_cbranch_scc1 Lsequ_47
    s_waitcnt vmcnt(0)
    s_barrier
    s_setprio 3
    s_add_u32 s34, s58, 0
    buffer_load_dwordx4 v[16:19], v5, s[16:19], s34 offen
    s_add_u32 s34, s58, 9216
    buffer_load_dwordx4 v[20:23], v5, s[16:19], s34 offen
    s_add_u32 s34, s58, 18432
    buffer_load_dwordx4 v[24:27], v5, s[16:19], s34 offen
    s_add_u32 s34, s58, 27648
    buffer_load_dwordx4 v[28:31], v5, s[16:19], s34 offen
    s_add_u32 s34, s58, 0
    buffer_load_dwordx4 v[32:35], v6, s[16:19], s34 offen
    s_add_u32 s34, s58, 9216
    buffer_load_dwordx4 v[36:39], v6, s[16:19], s34 offen
    s_add_u32 s34, s58, 18432
    buffer_load_dwordx4 v[40:43], v6, s[16:19], s34 offen
    s_add_u32 s34, s58, 27648
    buffer_load_dwordx4 v[44:47], v6, s[16:19], s34 offen
    s_add_u32 s34, s48, 0
    buffer_load_dwordx4 v[96:99], v9, s[36:39], s34 offen
    s_add_u32 s34, s48, 9216
    buffer_load_dwordx4 v[100:103], v9, s[36:39], s34 offen
    s_add_u32 s34, s48, 18432
    buffer_load_dwordx4 v[104:107], v9, s[36:39], s34 offen
    s_add_u32 s34, s48, 27648
    buffer_load_dwordx4 v[108:111], v9, s[36:39], s34 offen
    s_add_u32 s34, s48, 0
    buffer_load_dwordx4 v[112:115], v12, s[36:39], s34 offen
    s_add_u32 s34, s48, 9216
    buffer_load_dwordx4 v[116:119], v12, s[36:39], s34 offen
    s_add_u32 s34, s48, 18432
    buffer_load_dwordx4 v[120:123], v12, s[36:39], s34 offen
    s_add_u32 s34, s48, 27648
    buffer_load_dwordx4 v[124:127], v12, s[36:39], s34 offen
    s_mov_b32 s51, 0
Lsequ_48:
    buffer_load_dword v13, v10, s[40:43], 0 offen offset:4 sc1
    s_waitcnt vmcnt(0)
    v_readfirstlane_b32 s50, v13
    s_add_u32 s51, s51, 1
    s_nop 0
    s_cmp_ge_u32 s50, 20
    s_cbranch_scc1 Lsequ_49
    s_sleep 16
    s_cmp_lt_u32 s51, 200000
    s_cbranch_scc1 Lsequ_48
Lsequ_49:
    v_perm_b32 v48, v20, v16, s60
    v_perm_b32 v49, v28, v24, s60
    v_perm_b32 v50, v36, v32, s60
    v_perm_b32 v51, v44, v40, s60
    buffer_store_dwordx4 v[48:51], v4, s[20:23], s59 offen sc1
    s_add_u32 s59, s59, 36864
    v_perm_b32 v52, v20, v16, s61
    v_perm_b32 v53, v28, v24, s61
    v_perm_b32 v54, v36, v32, s61
    v_perm_b32 v55, v44, v40, s61
    buffer_store_dwordx4 v[52:55], v4, s[20:23], s59 offen sc1
    s_add_u32 s59, s59, 36864
    v_perm_b32 v56, v21, v17, s60
    v_perm_b32 v57, v29, v25, s60
    v_perm_b32 v58, v37, v33, s60
    v_perm_b32 v59, v45, v41, s60
    buffer_store_dwordx4 v[56:59], v4, s[20:23], s59 offen sc1
    s_add_u32 s59, s59, 36864
    v_perm_b32 v60, v21, v17, s61
    v_perm_b32 v61, v29, v25, s61
    v_perm_b32 v62, v37, v33, s61
    v_perm_b32 v63, v45, v41, s61
    buffer_store_dwordx4 v[60:63], v4, s[20:23], s59 offen sc1
    s_add_u32 s59, s59, 36864
    v_perm_b32 v64, v22, v18, s60
    v_perm_b32 v65, v30, v26, s60
    v_perm_b32 v66, v38, v34, s60
    v_perm_b32 v67, v46, v42, s60
    buffer_store_dwordx4 v[64:67], v4, s[20:23], s59 offen sc1
    s_add_u32 s59, s59, 36864
    v_perm_b32 v68, v22, v18, s61
    v_perm_b32 v69, v30, v26, s61
    v_perm_b32 v70, v38, v34, s61
    v_perm_b32 v71, v46, v42, s61
    buffer_store_dwordx4 v[68:71], v4, s[20:23], s59 offen sc1
    s_add_u32 s59, s59, 36864
    v_perm_b32 v72, v23, v19, s60
    v_perm_b32 v73, v31, v27, s60
    v_perm_b32 v74, v39, v35, s60
    v_perm_b32 v75, v47, v43, s60
    buffer_store_dwordx4 v[72:75], v4, s[20:23], s59 offen sc1
    s_add_u32 s59, s59, 36864
    v_perm_b32 v76, v23, v19, s61
    v_perm_b32 v77, v31, v27, s61
    v_perm_b32 v78, v39, v35, s61
    v_perm_b32 v79, v47, v43, s61
    buffer_store_dwordx4 v[76:79], v4, s[20:23], s59 offen sc1
    s_add_u32 s59, s59, 36864
    s_setprio 3
    v_perm_b32 v48, v100, v96, s60
    v_perm_b32 v49, v108, v104, s60
    v_perm_b32 v50, v116, v112, s60
    v_perm_b32 v51, v124, v120, s60
    v_perm_b32 v52, v100, v96, s61
    v_perm_b32 v53, v108, v104, s61
    v_perm_b32 v54, v116, v112, s61
    v_perm_b32 v55, v124, v120, s61
    v_perm_b32 v56, v101, v97, s60
    v_perm_b32 v57, v109, v105, s60
    v_perm_b32 v58, v117, v113, s60
    v_perm_b32 v59, v125, v121, s60
    v_perm_b32 v60, v101, v97, s61
    v_perm_b32 v61, v109, v105, s61
    v_perm_b32 v62, v117, v113, s61
    v_perm_b32 v63, v125, v121, s61
    v_perm_b32 v64, v102, v98, s60
    v_perm_b32 v65, v110, v106, s60
    v_perm_b32 v66, v118, v114, s60
    v_perm_b32 v67, v126, v122, s60
    v_perm_b32 v68, v102, v98, s61
    v_perm_b32 v69, v110, v106, s61
    v_perm_b32 v70, v118, v114, s61
    v_perm_b32 v71, v126, v122, s61
    v_perm_b32 v72, v103, v99, s60
    v_perm_b32 v73, v111, v107, s60
    v_perm_b32 v74, v119, v115, s60
    v_perm_b32 v75, v127, v123, s60
    v_perm_b32 v76, v103, v99, s61
    v_perm_b32 v77, v111, v107, s61
    v_perm_b32 v78, v119, v115, s61
    v_perm_b32 v79, v127, v123, s61
    s_cmp_eq_u32 s57, 1
    s_cbranch_scc1 Lsequ_50
    buffer_store_dwordx4 v[48:51], v4, s[20:23], s56 offen sc1
    s_add_u32 s56, s56, 36864
    buffer_store_dwordx4 v[52:55], v4, s[20:23], s56 offen sc1
    s_add_u32 s56, s56, 36864
    buffer_store_dwordx4 v[56:59], v4, s[20:23], s56 offen sc1
    s_add_u32 s56, s56, 36864
    buffer_store_dwordx4 v[60:63], v4, s[20:23], s56 offen sc1
    s_add_u32 s56, s56, 36864
    buffer_store_dwordx4 v[64:67], v4, s[20:23], s56 offen sc1
    s_add_u32 s56, s56, 36864
    buffer_store_dwordx4 v[68:71], v4, s[20:23], s56 offen sc1
    s_add_u32 s56, s56, 36864
    buffer_store_dwordx4 v[72:75], v4, s[20:23], s56 offen sc1
    s_add_u32 s56, s56, 36864
    buffer_store_dwordx4 v[76:79], v4, s[20:23], s56 offen sc1
    s_add_u32 s56, s56, 36864
    s_branch Lsequ_51
Lsequ_50:
    s_mov_b32 exec_lo, 65535
    s_mov_b32 exec_hi, 0
    ds_write_b128 v80, v[48:51]
    ds_write_b128 v81, v[52:55]
    ds_write_b128 v82, v[56:59]
    ds_write_b128 v83, v[60:63]
    ds_write_b128 v84, v[64:67]
    ds_write_b128 v85, v[68:71]
    ds_write_b128 v86, v[72:75]
    ds_write_b128 v87, v[76:79]
    s_mov_b64 exec, -1
    ds_read_b128 v[16:19], v15 offset:0
    ds_read_b128 v[20:23], v15 offset:1024
    s_mov_b32 exec_lo, 4294901760
    s_mov_b32 exec_hi, 0
    ds_write_b128 v80, v[48:51]
    ds_write_b128 v81, v[52:55]
    ds_write_b128 v82, v[56:59]
    ds_write_b128 v83, v[60:63]
    ds_write_b128 v84, v[64:67]
    ds_write_b128 v85, v[68:71]
    ds_write_b128 v86, v[72:75]
    ds_write_b128 v87, v[76:79]
    s_mov_b64 exec, -1
    ds_read_b128 v[24:27], v15 offset:0
    ds_read_b128 v[28:31], v15 offset:1024
    s_mov_b32 exec_lo, 0
    s_mov_b32 exec_hi, 65535
    ds_write_b128 v80, v[48:51]
    ds_write_b128 v81, v[52:55]
    ds_write_b128 v82, v[56:59]
    ds_write_b128 v83, v[60:63]
    ds_write_b128 v84, v[64:67]
    ds_write_b128 v85, v[68:71]
    ds_write_b128 v86, v[72:75]
    ds_write_b128 v87, v[76:79]
    s_mov_b64 exec, -1
    ds_read_b128 v[32:35], v15 offset:0
    ds_read_b128 v[36:39], v15 offset:1024
    s_mov_b32 exec_lo, 0
    s_mov_b32 exec_hi, 4294901760
    ds_write_b128 v80, v[48:51]
    ds_write_b128 v81, v[52:55]
    ds_write_b128 v82, v[56:59]
    ds_write_b128 v83, v[60:63]
    ds_write_b128 v84, v[64:67]
    ds_write_b128 v85, v[68:71]
    ds_write_b128 v86, v[72:75]
    ds_write_b128 v87, v[76:79]
    s_mov_b64 exec, -1
    ds_read_b128 v[40:43], v15 offset:0
    ds_read_b128 v[44:47], v15 offset:1024
    s_waitcnt lgkmcnt(0)
    buffer_store_dwordx4 v[16:19], v88, s[20:23], s56 offen sc1
    buffer_store_dwordx4 v[20:23], v89, s[20:23], s56 offen sc1
    buffer_store_dwordx4 v[24:27], v90, s[20:23], s56 offen sc1
    buffer_store_dwordx4 v[28:31], v91, s[20:23], s56 offen sc1
    buffer_store_dwordx4 v[32:35], v92, s[20:23], s56 offen sc1
    buffer_store_dwordx4 v[36:39], v93, s[20:23], s56 offen sc1
    buffer_store_dwordx4 v[40:43], v94, s[20:23], s56 offen sc1
    buffer_store_dwordx4 v[44:47], v95, s[20:23], s56 offen sc1
Lsequ_51:
    v_mov_b32 v13, 1073741824
    v_cmp_eq_u32 vcc, 0, v1
    v_mov_b32 v14, 1
    s_nop 0
    v_cndmask_b32 v13, v13, v1, vcc
    s_and_b32 s31, s2, 31
    s_lshl_b32 s31, s31, 8
    s_add_u32 s31, s31, 7356416
    s_waitcnt vmcnt(0)
    buffer_atomic_add v14, v13, s[20:23], s31 offen sc0 sc1
    s_waitcnt vmcnt(0)
    v_readfirstlane_b32 s50, v14
    s_nop 1
    s_cmp_lg_u32 s50, 31
    s_cbranch_scc1 Lsequ_52
    v_mov_b32 v14, 1
    s_mov_b32 s31, 7454720
    buffer_atomic_add v14, v13, s[20:23], s31 offen sc0 sc1
    s_waitcnt vmcnt(0)
    v_readfirstlane_b32 s50, v14
    s_nop 1
    s_cmp_lg_u32 s50, 31
    s_cbranch_scc1 Lsequ_52
    v_mov_b32 v14, 1
    v_min_u32 v13, 7, v1
    v_lshlrev_b32 v13, 7, v13
    buffer_store_dword v14, v13, s[20:23], s31 offen offset:1024 sc1
Lsequ_52:
    s_mov_b32 s32, 9887744
    buffer_load_dwordx4 a[0:3], v7, s[20:23], s32 offen sc1
    s_add_u32 s32, s32, 18688
    buffer_load_dwordx4 a[4:7], v7, s[20:23], s32 offen sc1
    s_add_u32 s32, s32, 18688
    buffer_load_dwordx4 a[8:11], v7, s[20:23], s32 offen sc1
    s_add_u32 s32, s32, 18688
    buffer_load_dwordx4 a[12:15], v7, s[20:23], s32 offen sc1
    s_add_u32 s32, s32, 18688
    buffer_load_dwordx4 a[16:19], v7, s[20:23], s32 offen sc1
    s_add_u32 s32, s32, 18688
    buffer_load_dwordx4 a[20:23], v7, s[20:23], s32 offen sc1
    s_add_u32 s32, s32, 18688
    buffer_load_dwordx4 a[24:27], v7, s[20:23], s32 offen sc1
    s_add_u32 s32, s32, 18688
    buffer_load_dwordx4 a[28:31], v7, s[20:23], s32 offen sc1
    s_add_u32 s32, s32, 18688
    buffer_load_dwordx4 a[32:35], v7, s[20:23], s32 offen sc1
    s_add_u32 s32, s32, 18688
    buffer_load_dwordx4 a[36:39], v7, s[20:23], s32 offen sc1
    s_add_u32 s32, s32, 18688
    buffer_load_dwordx4 a[40:43], v7, s[20:23], s32 offen sc1
    s_add_u32 s32, s32, 18688
    buffer_load_dwordx4 a[44:47], v7, s[20:23], s32 offen sc1
    s_add_u32 s32, s32, 18688
    buffer_load_dwordx4 a[48:51], v7, s[20:23], s32 offen sc1
    s_add_u32 s32, s32, 18688
    buffer_load_dwordx4 a[52:55], v7, s[20:23], s32 offen sc1
    s_add_u32 s32, s32, 18688
    buffer_load_dwordx4 a[56:59], v7, s[20:23], s32 offen sc1
    s_add_u32 s32, s32, 18688
    buffer_load_dwordx4 a[60:63], v7, s[20:23], s32 offen sc1
    s_add_u32 s32, s32, 18688
    buffer_load_dwordx4 a[64:67], v7, s[20:23], s32 offen sc1
    s_add_u32 s32, s32, 18688
    buffer_load_dwordx4 a[68:71], v7, s[20:23], s32 offen sc1
    s_add_u32 s32, s32, 18688
    buffer_load_dwordx4 a[72:75], v7, s[20:23], s32 offen sc1
    s_add_u32 s32, s32, 18688
    buffer_load_dwordx4 a[76:79], v7, s[20:23], s32 offen sc1
    s_add_u32 s32, s32, 18688
    buffer_load_dwordx4 a[80:83], v7, s[20:23], s32 offen sc1
    s_add_u32 s32, s32, 18688
    buffer_load_dwordx4 a[84:87], v7, s[20:23], s32 offen sc1
    s_add_u32 s32, s32, 18688
    buffer_load_dwordx4 a[88:91], v7, s[20:23], s32 offen sc1
    s_add_u32 s32, s32, 18688
    buffer_load_dwordx4 a[92:95], v7, s[20:23], s32 offen sc1
    s_add_u32 s32, s32, 18688
    buffer_load_dwordx4 a[96:99], v7, s[20:23], s32 offen sc1
    s_add_u32 s32, s32, 18688
    buffer_load_dwordx4 a[100:103], v7, s[20:23], s32 offen sc1
    s_add_u32 s32, s32, 18688
    buffer_load_dwordx4 a[104:107], v7, s[20:23], s32 offen sc1
    s_add_u32 s32, s32, 18688
    buffer_load_dwordx4 a[108:111], v7, s[20:23], s32 offen sc1
    s_add_u32 s32, s32, 18688
    buffer_load_dwordx4 a[112:115], v7, s[20:23], s32 offen sc1
    s_add_u32 s32, s32, 18688
    buffer_load_dwordx4 a[116:119], v7, s[20:23], s32 offen sc1
    s_add_u32 s32, s32, 18688
    buffer_load_dwordx4 a[120:123], v7, s[20:23], s32 offen sc1
    s_add_u32 s32, s32, 18688
    buffer_load_dwordx4 a[124:127], v7, s[20:23], s32 offen sc1
    s_add_u32 s32, s32, 18688
    buffer_load_dwordx4 v[96:99], v7, s[20:23], s32 offen sc1
    s_add_u32 s32, s32, 18688
    buffer_load_dwordx4 v[100:103], v7, s[20:23], s32 offen sc1
    s_add_u32 s32, s32, 18688
    buffer_load_dwordx4 v[104:107], v7, s[20:23], s32 offen sc1
    s_add_u32 s32, s32, 18688
    buffer_load_dwordx4 v[108:111], v7, s[20:23], s32 offen sc1
    s_add_u32 s32, s32, 18688
    buffer_load_dwordx4 v[32:35], v8, s[12:15], s33 offen
    buffer_load_dwordx4 v[36:39], v8, s[12:15], s33 offen offset:32
    buffer_load_dword v40, v11, s[20:23], s35 offen offset:12 sc1
    s_cmp_lg_u32 s63, 3
    s_cbranch_scc1 Lsequ_53
    v_mov_b32 v12, 163836
    v_mov_b32 v13, 0
    ds_write_b32 v12, v13
    s_and_b32 s31, s2, 7
    s_lshl_b32 s31, s31, 7
    s_add_u32 s31, s31, 7454720
    s_mov_b32 s51, 0
Lsequ_54:
    buffer_load_dword v14, v10, s[20:23], s31 offen offset:1024 sc1
    s_waitcnt vmcnt(0)
    v_readfirstlane_b32 s50, v14
    s_add_u32 s51, s51, 1
    s_nop 0
    s_cmp_ge_u32 s50, 1
    s_cbranch_scc1 Lsequ_55
    s_sleep 16
    s_cmp_lt_u32 s51, 200000
    s_cbranch_scc1 Lsequ_54
Lsequ_55:
Lsequ_53:
    s_mov_b32 s44, 0xffff0000
    s_waitcnt vmcnt(0)
    v_lshlrev_b32 v16, 16, v32
    v_and_b32 v17, s44, v32
    v_lshlrev_b32 v18, 16, v33
    v_and_b32 v19, s44, v33
    v_lshlrev_b32 v20, 16, v34
    v_and_b32 v21, s44, v34
    v_lshlrev_b32 v22, 16, v35
    v_and_b32 v23, s44, v35
    v_lshlrev_b32 v24, 16, v36
    v_and_b32 v25, s44, v36
    v_lshlrev_b32 v26, 16, v37
    v_and_b32 v27, s44, v37
    v_lshlrev_b32 v28, 16, v38
    v_and_b32 v29, s44, v38
    v_lshlrev_b32 v30, 16, v39
    v_and_b32 v31, s44, v39
    s_setprio 0
    s_waitcnt lgkmcnt(0)
    s_barrier
    s_branch Lsequ_30
Lsequ_2:
    s_load_dwordx2 s[28:29], s[0:1], 16
    s_mov_b32 s44, 0x3f803f80
    s_waitcnt lgkmcnt(0)
    s_mov_b32 s36, s28
    s_and_b32 s37, s29, 0xffff
    s_mov_b32 s38, 663552
    s_mov_b32 s39, 0x00020000
    s_lshl_b32 s28, s2, 3
    s_add_u32 s28, s28, s24
    s_cmp_ge_u32 s28, 72
    s_cbranch_scc1 Lsequ_60
    s_lshr_b32 s29, s28, 1
    s_and_b32 s30, s28, 1
    s_cmp_ge_u32 s29, 32
    s_cbranch_scc1 Lsequ_56
    s_mul_i32 s31, s29, 18
    s_lshl_b32 s32, s30, 3
    s_add_u32 s31, s31, s32
    s_and_b32 s32, s29, 1
    s_lshl_b32 s32, s32, 1
    s_add_u32 s31, s31, s32
    v_add_u32 v7, s31, v5
    s_branch Lsequ_57
Lsequ_56:
    s_sub_u32 s31, s28, 64
    s_mul_i32 s31, s31, 72
    s_add_u32 s31, s31, 16
    v_lshrrev_b32 v7, 2, v5
    v_mul_u32_u24 v7, 36, v7
    v_and_b32 v8, 3, v5
    v_add3_u32 v7, v7, v8, s31
Lsequ_57:
    v_mul_u32_u24 v7, 1152, v7
    v_lshl_add_u32 v7, v6, 4, v7
    v_mov_b32 v4, 0
    buffer_load_dwordx4 v[16:19], v7, s[36:39], 0 offen offset:0
    buffer_load_dwordx4 v[20:23], v7, s[36:39], 0 offen offset:128
    buffer_load_dwordx4 v[24:27], v7, s[36:39], 0 offen offset:256
    buffer_load_dwordx4 v[28:31], v7, s[36:39], 0 offen offset:384
    buffer_load_dwordx4 v[32:35], v7, s[36:39], 0 offen offset:512
    buffer_load_dwordx4 v[36:39], v7, s[36:39], 0 offen offset:640
    buffer_load_dwordx4 v[40:43], v7, s[36:39], 0 offen offset:768
    buffer_load_dwordx4 v[44:47], v7, s[36:39], 0 offen offset:896
    buffer_load_dwordx4 v[48:51], v7, s[36:39], 0 offen offset:1024
    s_waitcnt vmcnt(0)
    v_dot2_f32_bf16 v4, v16, s44, v4
    v_dot2_f32_bf16 v4, v17, s44, v4
    v_dot2_f32_bf16 v4, v18, s44, v4
    v_dot2_f32_bf16 v4, v19, s44, v4
    v_dot2_f32_bf16 v4, v20, s44, v4
    v_dot2_f32_bf16 v4, v21, s44, v4
    v_dot2_f32_bf16 v4, v22, s44, v4
    v_dot2_f32_bf16 v4, v23, s44, v4
    v_dot2_f32_bf16 v4, v24, s44, v4
    v_dot2_f32_bf16 v4, v25, s44, v4
    v_dot2_f32_bf16 v4, v26, s44, v4
    v_dot2_f32_bf16 v4, v27, s44, v4
    v_dot2_f32_bf16 v4, v28, s44, v4
    v_dot2_f32_bf16 v4, v29, s44, v4
    v_dot2_f32_bf16 v4, v30, s44, v4
    v_dot2_f32_bf16 v4, v31, s44, v4
    v_dot2_f32_bf16 v4, v32, s44, v4
    v_dot2_f32_bf16 v4, v33, s44, v4
    v_dot2_f32_bf16 v4, v34, s44, v4
    v_dot2_f32_bf16 v4, v35, s44, v4
    v_dot2_f32_bf16 v4, v36, s44, v4
    v_dot2_f32_bf16 v4, v37, s44, v4
    v_dot2_f32_bf16 v4, v38, s44, v4
    v_dot2_f32_bf16 v4, v39, s44, v4
    v_dot2_f32_bf16 v4, v40, s44, v4
    v_dot2_f32_bf16 v4, v41, s44, v4
    v_dot2_f32_bf16 v4, v42, s44, v4
    v_dot2_f32_bf16 v4, v43, s44, v4
    v_dot2_f32_bf16 v4, v44, s44, v4
    v_dot2_f32_bf16 v4, v45, s44, v4
    v_dot2_f32_bf16 v4, v46, s44, v4
    v_dot2_f32_bf16 v4, v47, s44, v4
    v_dot2_f32_bf16 v4, v48, s44, v4
    v_dot2_f32_bf16 v4, v49, s44, v4
    v_dot2_f32_bf16 v4, v50, s44, v4
    v_dot2_f32_bf16 v4, v51, s44, v4
    s_nop 2
    v_add_f32_dpp v4, v4, v4 quad_perm:[1,0,3,2] row_mask:0xf bank_mask:0xf
    s_nop 1
    v_add_f32_dpp v4, v4, v4 quad_perm:[2,3,0,1] row_mask:0xf bank_mask:0xf
    s_nop 1
    v_add_f32_dpp v4, v4, v4 row_half_mirror row_mask:0xf bank_mask:0xf
    v_mul_f32 v4, 0x3ae38e39, v4
    v_cvt_pk_bf16_f32 v3, v4, v4
    v_lshlrev_b32 v9, 16, v3
    v_sub_f32 v9, v4, v9
    v_cvt_pk_bf16_f32 v9, v9, v9
    s_mul_i32 s31, s28, 9344
    s_add_u32 s31, s31, 9896960
    v_lshlrev_b32 v8, 1, v5
    v_cmp_eq_u32 vcc, 0, v6
    s_nop 1
    v_cndmask_b32 v8, v2, v8, vcc
    buffer_store_short v3, v8, s[20:23], s31 offen sc1
    buffer_store_short v9, v8, s[20:23], s31 offen offset:16 sc1
    s_branch Lsequ_61
Lsequ_60:
    s_sub_u32 s31, s28, 72
    s_cmp_ge_u32 s31, 81
    s_cbranch_scc1 Lsequ_61
    s_mov_b32 s60, 0x05040100
    s_mov_b32 s61, 0x07060302
    s_mov_b32 s48, 0
    s_mov_b32 s49, 1152
    s_mov_b32 s50, 2304
    s_mov_b32 s51, 3456
    s_mov_b32 s52, 0
    s_mov_b32 s53, 1152
    s_mov_b32 s54, 2304
    s_mov_b32 s55, 3456
    s_mov_b32 s56, 9887744
    s_lshl_b32 s44, s24, 11
    s_lshl_b32 s33, s31, 6
    v_add_u32 v7, s33, v1
    s_mov_b32 s34, 58255
    v_mul_lo_u32 v8, v7, s34
    v_lshrrev_b32 v8, 22, v8
    v_mul_u32_u24 v9, 72, v8
    v_sub_u32 v9, v7, v9
    v_mul_u32_u24 v10, 9344, v8
    v_lshl_add_u32 v10, v9, 7, v10
    s_cmp_ge_u32 s31, 72
    s_cbranch_scc1 Lsequ_58
    v_lshrrev_b32 v11, 1, v8
    v_and_b32 v13, 1, v11
    v_mul_u32_u24 v11, 18, v11
    v_lshl_add_u32 v11, v13, 1, v11
    v_and_b32 v8, 1, v8
    v_lshl_add_u32 v11, v8, 3, v11
    v_mul_u32_u24 v11, 1152, v11
    v_lshl_add_u32 v9, v9, 4, v11
    v_add_u32 v12, 4608, v9
    s_branch Lsequ_59
Lsequ_58:
    v_subrev_u32 v8, 64, v8
    v_mul_u32_u24 v11, 72, v8
    v_add_u32 v11, 16, v11
    v_mul_u32_u24 v11, 1152, v11
    v_lshl_add_u32 v9, v9, 4, v11
    v_add_u32 v12, 41472, v9
Lsequ_59:
    s_and_b32 s37, s37, 0xffff
    buffer_load_dwordx4 v[16:19], v9, s[36:39], s48 offen
    buffer_load_dwordx4 v[20:23], v9, s[36:39], s49 offen
    buffer_load_dwordx4 v[24:27], v9, s[36:39], s50 offen
    buffer_load_dwordx4 v[28:31], v9, s[36:39], s51 offen
    buffer_load_dwordx4 v[32:35], v12, s[36:39], s52 offen
    buffer_load_dwordx4 v[36:39], v12, s[36:39], s53 offen
    buffer_load_dwordx4 v[40:43], v12, s[36:39], s54 offen
    buffer_load_dwordx4 v[44:47], v12, s[36:39], s55 offen
    s_waitcnt vmcnt(0)
    v_perm_b32 v48, v20, v16, s60
    v_perm_b32 v49, v28, v24, s60
    v_perm_b32 v50, v36, v32, s60
    v_perm_b32 v51, v44, v40, s60
    v_perm_b32 v52, v20, v16, s61
    v_perm_b32 v53, v28, v24, s61
    v_perm_b32 v54, v36, v32, s61
    v_perm_b32 v55, v44, v40, s61
    v_perm_b32 v56, v21, v17, s60
    v_perm_b32 v57, v29, v25, s60
    v_perm_b32 v58, v37, v33, s60
    v_perm_b32 v59, v45, v41, s60
    v_perm_b32 v60, v21, v17, s61
    v_perm_b32 v61, v29, v25, s61
    v_perm_b32 v62, v37, v33, s61
    v_perm_b32 v63, v45, v41, s61
    v_perm_b32 v64, v22, v18, s60
    v_perm_b32 v65, v30, v26, s60
    v_perm_b32 v66, v38, v34, s60
    v_perm_b32 v67, v46, v42, s60
    v_perm_b32 v68, v22, v18, s61
    v_perm_b32 v69, v30, v26, s61
    v_perm_b32 v70, v38, v34, s61
    v_perm_b32 v71, v46, v42, s61
    v_perm_b32 v72, v23, v19, s60
    v_perm_b32 v73, v31, v27, s60
    v_perm_b32 v74, v39, v35, s60
    v_perm_b32 v75, v47, v43, s60
    v_perm_b32 v76, v23, v19, s61
    v_perm_b32 v77, v31, v27, s61
    v_perm_b32 v78, v39, v35, s61
    v_perm_b32 v79, v47, v43, s61
    v_and_b32 v13, 7, v1
    v_lshrrev_b32 v14, 3, v1
    v_and_b32 v11, 15, v1
    v_lshlrev_b32 v11, 7, v11
    v_lshl_add_u32 v11, v13, 4, v11
    v_add_u32 v11, s44, v11
    v_xor_b32 v15, v13, v14
    v_lshlrev_b32 v15, 4, v15
    v_lshl_add_u32 v15, v14, 7, v15
    v_add_u32 v15, s44, v15
    v_lshlrev_b32 v14, 2, v14
    v_xor_b32 v80, 0, v11
    v_xor_b32 v81, 16, v11
    v_xor_b32 v82, 32, v11
    v_xor_b32 v83, 48, v11
    v_xor_b32 v84, 64, v11
    v_xor_b32 v85, 80, v11
    v_xor_b32 v86, 96, v11
    v_xor_b32 v87, 112, v11
    ds_bpermute_b32 v88, v14, v10 offset:0
    ds_bpermute_b32 v89, v14, v10 offset:32
    ds_bpermute_b32 v90, v14, v10 offset:64
    ds_bpermute_b32 v91, v14, v10 offset:96
    ds_bpermute_b32 v92, v14, v10 offset:128
    ds_bpermute_b32 v93, v14, v10 offset:160
    ds_bpermute_b32 v94, v14, v10 offset:192
    ds_bpermute_b32 v95, v14, v10 offset:224
    s_mov_b32 exec_lo, 65535
    s_mov_b32 exec_hi, 0
    ds_write_b128 v80, v[48:51]
    ds_write_b128 v81, v[52:55]
    ds_write_b128 v82, v[56:59]
    ds_write_b128 v83, v[60:63]
    ds_write_b128 v84, v[64:67]
    ds_write_b128 v85, v[68:71]
    ds_write_b128 v86, v[72:75]
    ds_write_b128 v87, v[76:79]
    s_mov_b64 exec, -1
    ds_read_b128 v[16:19], v15 offset:0
    ds_read_b128 v[20:23], v15 offset:1024
    s_mov_b32 exec_lo, 4294901760
    s_mov_b32 exec_hi, 0
    ds_write_b128 v80, v[48:51]
    ds_write_b128 v81, v[52:55]
    ds_write_b128 v82, v[56:59]
    ds_write_b128 v83, v[60:63]
    ds_write_b128 v84, v[64:67]
    ds_write_b128 v85, v[68:71]
    ds_write_b128 v86, v[72:75]
    ds_write_b128 v87, v[76:79]
    s_mov_b64 exec, -1
    ds_read_b128 v[24:27], v15 offset:0
    ds_read_b128 v[28:31], v15 offset:1024
    s_mov_b32 exec_lo, 0
    s_mov_b32 exec_hi, 65535
    ds_write_b128 v80, v[48:51]
    ds_write_b128 v81, v[52:55]
    ds_write_b128 v82, v[56:59]
    ds_write_b128 v83, v[60:63]
    ds_write_b128 v84, v[64:67]
    ds_write_b128 v85, v[68:71]
    ds_write_b128 v86, v[72:75]
    ds_write_b128 v87, v[76:79]
    s_mov_b64 exec, -1
    ds_read_b128 v[32:35], v15 offset:0
    ds_read_b128 v[36:39], v15 offset:1024
    s_mov_b32 exec_lo, 0
    s_mov_b32 exec_hi, 4294901760
    ds_write_b128 v80, v[48:51]
    ds_write_b128 v81, v[52:55]
    ds_write_b128 v82, v[56:59]
    ds_write_b128 v83, v[60:63]
    ds_write_b128 v84, v[64:67]
    ds_write_b128 v85, v[68:71]
    ds_write_b128 v86, v[72:75]
    ds_write_b128 v87, v[76:79]
    s_mov_b64 exec, -1
    ds_read_b128 v[40:43], v15 offset:0
    ds_read_b128 v[44:47], v15 offset:1024
    s_waitcnt lgkmcnt(0)
    v_lshl_add_u32 v88, v13, 4, v88
    buffer_store_dwordx4 v[16:19], v88, s[20:23], s56 offen sc1
    v_lshl_add_u32 v89, v13, 4, v89
    buffer_store_dwordx4 v[20:23], v89, s[20:23], s56 offen sc1
    v_lshl_add_u32 v90, v13, 4, v90
    buffer_store_dwordx4 v[24:27], v90, s[20:23], s56 offen sc1
    v_lshl_add_u32 v91, v13, 4, v91
    buffer_store_dwordx4 v[28:31], v91, s[20:23], s56 offen sc1
    v_lshl_add_u32 v92, v13, 4, v92
    buffer_store_dwordx4 v[32:35], v92, s[20:23], s56 offen sc1
    v_lshl_add_u32 v93, v13, 4, v93
    buffer_store_dwordx4 v[36:39], v93, s[20:23], s56 offen sc1
    v_lshl_add_u32 v94, v13, 4, v94
    buffer_store_dwordx4 v[40:43], v94, s[20:23], s56 offen sc1
    v_lshl_add_u32 v95, v13, 4, v95
    buffer_store_dwordx4 v[44:47], v95, s[20:23], s56 offen sc1
Lsequ_61:
    s_waitcnt vmcnt(0) lgkmcnt(0)
    s_barrier
    s_cmp_lg_u32 s24, 0
    s_cbranch_scc1 Lsequ_6
    s_mov_b32 s40, s8
    s_and_b32 s41, s9, 0xffff
    s_mov_b32 s42, 256
    s_mov_b32 s43, 0x00020000
    v_mov_b32 v2, 1073741824
    v_cmp_eq_u32 vcc, 0, v1
    v_mov_b32 v3, 1
    s_nop 0
    v_cndmask_b32 v2, v2, v1, vcc
    s_cmp_lt_u32 s2, 20
    s_cselect_b32 s31, 0, 1073741824
    buffer_atomic_add v3, v2, s[40:43], s31 offen offset:4 sc1
    s_mov_b32 s51, 0
Lsequ_62:
    buffer_load_dword v3, v2, s[40:43], 0 offen offset:128 sc1
    s_waitcnt vmcnt(0)
    v_readfirstlane_b32 s50, v3
    s_add_u32 s51, s51, 1
    s_nop 0
    s_cmp_ge_u32 s50, 1
    s_cbranch_scc1 Lsequ_63
    s_sleep 8
    s_cmp_lt_u32 s51, 200000
    s_cbranch_scc1 Lsequ_62
Lsequ_63:
    s_branch Lsequ_6
Lsequ_7:
    s_load_dwordx2 s[4:5], s[0:1], 56
    s_lshl_b32 s56, s25, 2
    s_add_u32 s56, s56, s26
    s_lshl_b32 s56, s56, 7
    s_add_u32 s56, s56, 7421952
    s_lshr_b32 s25, s2, 5
    s_and_b32 s26, s2, 31
    s_lshl_b32 s27, s25, 3
    s_add_u32 s27, s27, s24
    s_mul_i32 s28, s27, 36864
    s_add_u32 s28, s28, 10563584
    s_mul_i32 s29, s26, 331776
    s_add_u32 s29, s29, 13193216
    s_lshl_b32 s30, s24, 10
    v_and_b32 v2, 15, v1
    v_lshlrev_b32 v5, 4, v2
    v_lshrrev_b32 v3, 4, v1
    v_lshl_add_u32 v6, v3, 9, v5
    s_lshl_b32 s31, s27, 12
    s_add_u32 s31, s31, 12931072
    s_waitcnt lgkmcnt(0)
    s_add_u32 s32, s29, s30
    s_lshr_b32 s45, s24, 1
    s_mul_i32 s45, s45, 36864
    s_and_b32 s33, s24, 1
    s_lshl_b32 s33, s33, 10
    s_add_u32 s45, s45, s33
    s_add_u32 s45, s45, s29
    s_mov_b32 s12, s4
    s_and_b32 s13, s5, 0xffff
    s_mov_b32 s14, 2359296
    s_mov_b32 s15, 0x00020000
    s_lshr_b32 s36, s27, 1
    s_mul_i32 s36, s36, 589824
    s_and_b32 s37, s27, 1
    s_lshl_b32 s37, s37, 11
    s_add_u32 s36, s36, s37
    s_add_u32 s36, s36, 23810048
    s_lshr_b32 s37, s26, 1
    s_lshl_b32 s37, s37, 12
    s_and_b32 s39, s26, 1
    s_lshl_b32 s39, s39, 9
    s_add_u32 s39, s39, s37
    s_add_u32 s39, s39, s36
    s_add_u32 s39, s39, 524288
    s_lshl_b32 s37, s26, 12
    s_add_u32 s36, s36, s37
    v_add_u32 v12, 0x10000, v4
    s_lshl_b32 s41, s25, 10
    s_add_u32 s41, s41, 7348224
    v_mov_b32 v7, 1073741824
    v_cmp_eq_u32 vcc, 0, v0
    s_nop 1
    v_cndmask_b32 v7, v7, v0, vcc
    s_bfe_u32 s42, s2, 0x20001
    s_lshl_b32 s43, s25, 2
    s_add_u32 s42, s42, s43
    s_and_b32 s43, s2, 1
    s_lshl_b32 s43, s43, 2
    s_bfe_u32 s44, s2, 0x20003
    s_add_u32 s43, s43, s44
    s_lshr_b32 s44, s42, 2
    s_lshl_b32 s44, s44, 10
    s_add_u32 s44, s44, 7348224
    s_mul_i32 s60, s42, 589824
    s_lshl_b32 s61, s24, 13
    s_add_u32 s49, s61, 98304
    s_add_u32 s60, s60, s61
    s_add_u32 s60, s60, 23810048
    s_add_u32 s61, s60, 4096
    s_mul_i32 s54, s24, 9216
    s_mul_i32 s55, s43, 663552
    s_add_u32 s54, s54, s55
    s_add_u32 s54, s54, 42684416
    s_add_u32 s55, s54, 4608
    v_mul_u32_u24 v13, 1152, v3
    v_add_u32 v13, v13, v5
    v_lshlrev_b32 v2, 2, v2
    v_lshl_add_u32 v2, v3, 10, v2
    v_mov_b32 v16, 1
    v_lshlrev_b32 v17, 7, v1
    v_mov_b32 v18, 1073741824
    v_cmp_gt_u32 vcc, 4, v1
    s_nop 1
    v_cndmask_b32 v17, v18, v17, vcc
    s_lshl_b32 s57, s27, 9
    s_add_u32 s57, s57, 7421952
    s_mov_b32 s58, s49
    s_waitcnt vmcnt(0)
    s_barrier
    buffer_store_dword v16, v7, s[20:23], s56 offen sc1
    ds_read_b128 v[80:83], v4 offset:0
    ds_read_b128 v[84:87], v4 offset:1024
    ds_read_b128 v[88:91], v4 offset:2048
    ds_read_b128 v[92:95], v4 offset:3072
    ds_read_b128 v[96:99], v4 offset:4096
    s_mov_b32 s51, 0
    s_mov_b32 s48, 15
    s_mov_b32 s49, 0
Lsequ_64:
    buffer_load_dword v18, v17, s[20:23], s57 offen sc1
    s_waitcnt vmcnt(0)
    v_cmp_eq_u32 vcc, 1, v18
    s_add_u32 s51, s51, 1
    s_nop 2
    s_cmp_eq_u64 vcc, s[48:49]
    s_cbranch_scc1 Lsequ_65
    s_sleep 1
    s_cmp_lt_u32 s51, 200000
    s_cbranch_scc1 Lsequ_64
Lsequ_65:
    s_mov_b32 s49, s58
    buffer_load_dwordx4 a[0:3], v6, s[20:23], s28 offen offset:0 sc1
    buffer_load_dwordx4 a[4:7], v6, s[20:23], s28 offen offset:256 sc1
    buffer_load_dwordx4 a[8:11], v6, s[20:23], s28 offen offset:2048 sc1
    buffer_load_dwordx4 a[12:15], v6, s[20:23], s28 offen offset:2304 sc1
    s_add_u32 s28, s28, 4096
    buffer_load_dwordx4 a[16:19], v6, s[20:23], s28 offen offset:0 sc1
    buffer_load_dwordx4 a[20:23], v6, s[20:23], s28 offen offset:256 sc1
    s_waitcnt vmcnt(4) lgkmcnt(4)
    v_mfma_f32_16x16x32_bf16 v[16:19], v[80:83], a[0:3], 0
    ds_read_b128 v[100:103], v4 offset:5120
    v_mfma_f32_16x16x32_bf16 v[20:23], v[80:83], a[4:7], 0
    buffer_load_dwordx4 a[24:27], v6, s[20:23], s28 offen offset:2048 sc1
    s_waitcnt lgkmcnt(4)
    v_mfma_f32_16x16x32_bf16 v[24:27], v[84:87], a[0:3], 0
    ds_read_b128 v[80:83], v4 offset:6144
    v_mfma_f32_16x16x32_bf16 v[28:31], v[84:87], a[4:7], 0
    s_waitcnt lgkmcnt(4)
    v_mfma_f32_16x16x32_bf16 v[32:35], v[88:91], a[0:3], 0
    ds_read_b128 v[84:87], v4 offset:7168
    v_mfma_f32_16x16x32_bf16 v[36:39], v[88:91], a[4:7], 0
    s_waitcnt lgkmcnt(4)
    v_mfma_f32_16x16x32_bf16 v[40:43], v[92:95], a[0:3], 0
    ds_read_b128 v[88:91], v4 offset:8192
    v_mfma_f32_16x16x32_bf16 v[44:47], v[92:95], a[4:7], 0
    buffer_load_dwordx4 a[28:31], v6, s[20:23], s28 offen offset:2304 sc1
    s_waitcnt lgkmcnt(4)
    v_mfma_f32_16x16x32_bf16 v[48:51], v[96:99], a[0:3], 0
    ds_read_b128 v[92:95], v4 offset:9216
    v_mfma_f32_16x16x32_bf16 v[52:55], v[96:99], a[4:7], 0
    s_waitcnt lgkmcnt(4)
    v_mfma_f32_16x16x32_bf16 v[56:59], v[100:103], a[0:3], 0
    ds_read_b128 v[96:99], v4 offset:10240
    v_mfma_f32_16x16x32_bf16 v[60:63], v[100:103], a[4:7], 0
    s_waitcnt lgkmcnt(4)
    v_mfma_f32_16x16x32_bf16 v[64:67], v[80:83], a[0:3], 0
    ds_read_b128 v[100:103], v4 offset:11264
    v_mfma_f32_16x16x32_bf16 v[68:71], v[80:83], a[4:7], 0
    s_add_u32 s28, s28, 4096
    buffer_load_dwordx4 a[32:35], v6, s[20:23], s28 offen offset:0 sc1
    s_waitcnt lgkmcnt(4)
    v_mfma_f32_16x16x32_bf16 v[72:75], v[84:87], a[0:3], 0
    ds_read_b128 v[80:83], v4 offset:12288
    v_mfma_f32_16x16x32_bf16 v[76:79], v[84:87], a[4:7], 0
    s_waitcnt vmcnt(5) lgkmcnt(4)
    v_mfma_f32_16x16x32_bf16 v[16:19], v[88:91], a[8:11], v[16:19]
    ds_read_b128 v[84:87], v4 offset:13312
    v_mfma_f32_16x16x32_bf16 v[20:23], v[88:91], a[12:15], v[20:23]
    s_waitcnt lgkmcnt(4)
    v_mfma_f32_16x16x32_bf16 v[24:27], v[92:95], a[8:11], v[24:27]
    ds_read_b128 v[88:91], v4 offset:14336
    v_mfma_f32_16x16x32_bf16 v[28:31], v[92:95], a[12:15], v[28:31]
    buffer_load_dwordx4 a[36:39], v6, s[20:23], s28 offen offset:256 sc1
    s_waitcnt lgkmcnt(4)
    v_mfma_f32_16x16x32_bf16 v[32:35], v[96:99], a[8:11], v[32:35]
    ds_read_b128 v[92:95], v4 offset:15360
    v_mfma_f32_16x16x32_bf16 v[36:39], v[96:99], a[12:15], v[36:39]
    s_waitcnt lgkmcnt(4)
    v_mfma_f32_16x16x32_bf16 v[40:43], v[100:103], a[8:11], v[40:43]
    ds_read_b128 v[96:99], v4 offset:16384
    v_mfma_f32_16x16x32_bf16 v[44:47], v[100:103], a[12:15], v[44:47]
    s_waitcnt lgkmcnt(4)
    v_mfma_f32_16x16x32_bf16 v[48:51], v[80:83], a[8:11], v[48:51]
    ds_read_b128 v[100:103], v4 offset:17408
    v_mfma_f32_16x16x32_bf16 v[52:55], v[80:83], a[12:15], v[52:55]
    buffer_load_dwordx4 a[40:43], v6, s[20:23], s28 offen offset:2048 sc1
    s_waitcnt lgkmcnt(4)
    v_mfma_f32_16x16x32_bf16 v[56:59], v[84:87], a[8:11], v[56:59]
    ds_read_b128 v[80:83], v4 offset:18432
    v_mfma_f32_16x16x32_bf16 v[60:63], v[84:87], a[12:15], v[60:63]
    s_waitcnt lgkmcnt(4)
    v_mfma_f32_16x16x32_bf16 v[64:67], v[88:91], a[8:11], v[64:67]
    ds_read_b128 v[84:87], v4 offset:19456
    v_mfma_f32_16x16x32_bf16 v[68:71], v[88:91], a[12:15], v[68:71]
    s_waitcnt lgkmcnt(4)
    v_mfma_f32_16x16x32_bf16 v[72:75], v[92:95], a[8:11], v[72:75]
    ds_read_b128 v[88:91], v4 offset:20480
    v_mfma_f32_16x16x32_bf16 v[76:79], v[92:95], a[12:15], v[76:79]
    buffer_load_dwordx4 a[44:47], v6, s[20:23], s28 offen offset:2304 sc1
    s_waitcnt vmcnt(6) lgkmcnt(4)
    v_mfma_f32_16x16x32_bf16 v[16:19], v[96:99], a[16:19], v[16:19]
    ds_read_b128 v[92:95], v4 offset:21504
    v_mfma_f32_16x16x32_bf16 v[20:23], v[96:99], a[20:23], v[20:23]
    s_waitcnt lgkmcnt(4)
    v_mfma_f32_16x16x32_bf16 v[24:27], v[100:103], a[16:19], v[24:27]
    ds_read_b128 v[96:99], v4 offset:22528
    v_mfma_f32_16x16x32_bf16 v[28:31], v[100:103], a[20:23], v[28:31]
    s_waitcnt lgkmcnt(4)
    v_mfma_f32_16x16x32_bf16 v[32:35], v[80:83], a[16:19], v[32:35]
    ds_read_b128 v[100:103], v4 offset:23552
    v_mfma_f32_16x16x32_bf16 v[36:39], v[80:83], a[20:23], v[36:39]
    s_waitcnt lgkmcnt(4)
    v_mfma_f32_16x16x32_bf16 v[40:43], v[84:87], a[16:19], v[40:43]
    ds_read_b128 v[80:83], v4 offset:24576
    v_mfma_f32_16x16x32_bf16 v[44:47], v[84:87], a[20:23], v[44:47]
    s_waitcnt lgkmcnt(4)
    v_mfma_f32_16x16x32_bf16 v[48:51], v[88:91], a[16:19], v[48:51]
    ds_read_b128 v[84:87], v4 offset:25600
    v_mfma_f32_16x16x32_bf16 v[52:55], v[88:91], a[20:23], v[52:55]
    s_waitcnt lgkmcnt(4)
    v_mfma_f32_16x16x32_bf16 v[56:59], v[92:95], a[16:19], v[56:59]
    ds_read_b128 v[88:91], v4 offset:26624
    v_mfma_f32_16x16x32_bf16 v[60:63], v[92:95], a[20:23], v[60:63]
    s_waitcnt lgkmcnt(4)
    v_mfma_f32_16x16x32_bf16 v[64:67], v[96:99], a[16:19], v[64:67]
    ds_read_b128 v[92:95], v4 offset:27648
    v_mfma_f32_16x16x32_bf16 v[68:71], v[96:99], a[20:23], v[68:71]
    s_waitcnt lgkmcnt(4)
    v_mfma_f32_16x16x32_bf16 v[72:75], v[100:103], a[16:19], v[72:75]
    ds_read_b128 v[96:99], v4 offset:28672
    v_mfma_f32_16x16x32_bf16 v[76:79], v[100:103], a[20:23], v[76:79]
    s_waitcnt vmcnt(4) lgkmcnt(4)
    v_mfma_f32_16x16x32_bf16 v[16:19], v[80:83], a[24:27], v[16:19]
    ds_read_b128 v[100:103], v4 offset:29696
    v_mfma_f32_16x16x32_bf16 v[20:23], v[80:83], a[28:31], v[20:23]
    s_add_u32 s28, s28, 4096
    buffer_load_dwordx4 a[48:51], v6, s[20:23], s28 offen offset:0 sc1
    s_waitcnt lgkmcnt(4)
    v_mfma_f32_16x16x32_bf16 v[24:27], v[84:87], a[24:27], v[24:27]
    ds_read_b128 v[80:83], v4 offset:30720
    v_mfma_f32_16x16x32_bf16 v[28:31], v[84:87], a[28:31], v[28:31]
    s_waitcnt lgkmcnt(4)
    v_mfma_f32_16x16x32_bf16 v[32:35], v[88:91], a[24:27], v[32:35]
    ds_read_b128 v[84:87], v4 offset:31744
    v_mfma_f32_16x16x32_bf16 v[36:39], v[88:91], a[28:31], v[36:39]
    s_waitcnt lgkmcnt(4)
    v_mfma_f32_16x16x32_bf16 v[40:43], v[92:95], a[24:27], v[40:43]
    ds_read_b128 v[88:91], v4 offset:32768
    v_mfma_f32_16x16x32_bf16 v[44:47], v[92:95], a[28:31], v[44:47]
    buffer_load_dwordx4 a[52:55], v6, s[20:23], s28 offen offset:256 sc1
    s_waitcnt lgkmcnt(4)
    v_mfma_f32_16x16x32_bf16 v[48:51], v[96:99], a[24:27], v[48:51]
    ds_read_b128 v[92:95], v4 offset:33792
    v_mfma_f32_16x16x32_bf16 v[52:55], v[96:99], a[28:31], v[52:55]
    s_waitcnt lgkmcnt(4)
    v_mfma_f32_16x16x32_bf16 v[56:59], v[100:103], a[24:27], v[56:59]
    ds_read_b128 v[96:99], v4 offset:34816
    v_mfma_f32_16x16x32_bf16 v[60:63], v[100:103], a[28:31], v[60:63]
    s_waitcnt lgkmcnt(4)
    v_mfma_f32_16x16x32_bf16 v[64:67], v[80:83], a[24:27], v[64:67]
    ds_read_b128 v[100:103], v4 offset:35840
    v_mfma_f32_16x16x32_bf16 v[68:71], v[80:83], a[28:31], v[68:71]
    buffer_load_dwordx4 a[56:59], v6, s[20:23], s28 offen offset:2048 sc1
    s_waitcnt lgkmcnt(4)
    v_mfma_f32_16x16x32_bf16 v[72:75], v[84:87], a[24:27], v[72:75]
    ds_read_b128 v[80:83], v4 offset:36864
    v_mfma_f32_16x16x32_bf16 v[76:79], v[84:87], a[28:31], v[76:79]
    s_waitcnt vmcnt(5) lgkmcnt(4)
    v_mfma_f32_16x16x32_bf16 v[16:19], v[88:91], a[32:35], v[16:19]
    ds_read_b128 v[84:87], v4 offset:37888
    v_mfma_f32_16x16x32_bf16 v[20:23], v[88:91], a[36:39], v[20:23]
    s_waitcnt lgkmcnt(4)
    v_mfma_f32_16x16x32_bf16 v[24:27], v[92:95], a[32:35], v[24:27]
    ds_read_b128 v[88:91], v4 offset:38912
    v_mfma_f32_16x16x32_bf16 v[28:31], v[92:95], a[36:39], v[28:31]
    buffer_load_dwordx4 a[60:63], v6, s[20:23], s28 offen offset:2304 sc1
    s_waitcnt lgkmcnt(4)
    v_mfma_f32_16x16x32_bf16 v[32:35], v[96:99], a[32:35], v[32:35]
    ds_read_b128 v[92:95], v4 offset:39936
    v_mfma_f32_16x16x32_bf16 v[36:39], v[96:99], a[36:39], v[36:39]
    s_waitcnt lgkmcnt(4)
    v_mfma_f32_16x16x32_bf16 v[40:43], v[100:103], a[32:35], v[40:43]
    ds_read_b128 v[96:99], v4 offset:40960
    v_mfma_f32_16x16x32_bf16 v[44:47], v[100:103], a[36:39], v[44:47]
    s_waitcnt lgkmcnt(4)
    v_mfma_f32_16x16x32_bf16 v[48:51], v[80:83], a[32:35], v[48:51]
    ds_read_b128 v[100:103], v4 offset:41984
    v_mfma_f32_16x16x32_bf16 v[52:55], v[80:83], a[36:39], v[52:55]
    s_add_u32 s28, s28, 4096
    buffer_load_dwordx4 a[64:67], v6, s[20:23], s28 offen offset:0 sc1
    s_waitcnt lgkmcnt(4)
    v_mfma_f32_16x16x32_bf16 v[56:59], v[84:87], a[32:35], v[56:59]
    ds_read_b128 v[80:83], v4 offset:43008
    v_mfma_f32_16x16x32_bf16 v[60:63], v[84:87], a[36:39], v[60:63]
    s_waitcnt lgkmcnt(4)
    v_mfma_f32_16x16x32_bf16 v[64:67], v[88:91], a[32:35], v[64:67]
    ds_read_b128 v[84:87], v4 offset:44032
    v_mfma_f32_16x16x32_bf16 v[68:71], v[88:91], a[36:39], v[68:71]
    s_waitcnt lgkmcnt(4)
    v_mfma_f32_16x16x32_bf16 v[72:75], v[92:95], a[32:35], v[72:75]
    ds_read_b128 v[88:91], v4 offset:45056
    v_mfma_f32_16x16x32_bf16 v[76:79], v[92:95], a[36:39], v[76:79]
    buffer_load_dwordx4 a[68:71], v6, s[20:23], s28 offen offset:256 sc1
    s_waitcnt vmcnt(6) lgkmcnt(4)
    v_mfma_f32_16x16x32_bf16 v[16:19], v[96:99], a[40:43], v[16:19]
    ds_read_b128 v[92:95], v4 offset:46080
    v_mfma_f32_16x16x32_bf16 v[20:23], v[96:99], a[44:47], v[20:23]
    s_waitcnt lgkmcnt(4)
    v_mfma_f32_16x16x32_bf16 v[24:27], v[100:103], a[40:43], v[24:27]
    ds_read_b128 v[96:99], v4 offset:47104
    v_mfma_f32_16x16x32_bf16 v[28:31], v[100:103], a[44:47], v[28:31]
    s_waitcnt lgkmcnt(4)
    v_mfma_f32_16x16x32_bf16 v[32:35], v[80:83], a[40:43], v[32:35]
    ds_read_b128 v[100:103], v4 offset:48128
    v_mfma_f32_16x16x32_bf16 v[36:39], v[80:83], a[44:47], v[36:39]
    s_waitcnt lgkmcnt(4)
    v_mfma_f32_16x16x32_bf16 v[40:43], v[84:87], a[40:43], v[40:43]
    s_waitcnt vmcnt(18)
    s_barrier
    ds_read_b128 v[80:83], v4 offset:49152
    v_mfma_f32_16x16x32_bf16 v[44:47], v[84:87], a[44:47], v[44:47]
    s_waitcnt lgkmcnt(4)
    v_mfma_f32_16x16x32_bf16 v[48:51], v[88:91], a[40:43], v[48:51]
    ds_read_b128 v[84:87], v4 offset:50176
    v_mfma_f32_16x16x32_bf16 v[52:55], v[88:91], a[44:47], v[52:55]
    s_waitcnt lgkmcnt(4)
    v_mfma_f32_16x16x32_bf16 v[56:59], v[92:95], a[40:43], v[56:59]
    ds_read_b128 v[88:91], v4 offset:51200
    v_mfma_f32_16x16x32_bf16 v[60:63], v[92:95], a[44:47], v[60:63]
    s_waitcnt lgkmcnt(4)
    v_mfma_f32_16x16x32_bf16 v[64:67], v[96:99], a[40:43], v[64:67]
    ds_read_b128 v[92:95], v4 offset:52224
    v_mfma_f32_16x16x32_bf16 v[68:71], v[96:99], a[44:47], v[68:71]
    s_waitcnt lgkmcnt(4)
    v_mfma_f32_16x16x32_bf16 v[72:75], v[100:103], a[40:43], v[72:75]
    ds_read_b128 v[96:99], v4 offset:53248
    v_mfma_f32_16x16x32_bf16 v[76:79], v[100:103], a[44:47], v[76:79]
    s_waitcnt vmcnt(4) lgkmcnt(4)
    v_mfma_f32_16x16x32_bf16 v[16:19], v[80:83], a[48:51], v[16:19]
    ds_read_b128 v[100:103], v4 offset:54272
    v_mfma_f32_16x16x32_bf16 v[20:23], v[80:83], a[52:55], v[20:23]
    buffer_load_dwordx4 a[72:75], v6, s[20:23], s28 offen offset:2048 sc1
    s_waitcnt lgkmcnt(4)
    v_mfma_f32_16x16x32_bf16 v[24:27], v[84:87], a[48:51], v[24:27]
    ds_read_b128 v[80:83], v4 offset:55296
    v_mfma_f32_16x16x32_bf16 v[28:31], v[84:87], a[52:55], v[28:31]
    s_waitcnt lgkmcnt(4)
    v_mfma_f32_16x16x32_bf16 v[32:35], v[88:91], a[48:51], v[32:35]
    ds_read_b128 v[84:87], v4 offset:56320
    v_mfma_f32_16x16x32_bf16 v[36:39], v[88:91], a[52:55], v[36:39]
    buffer_load_dwordx4 a[76:79], v6, s[20:23], s28 offen offset:2304 sc1
    s_waitcnt lgkmcnt(4)
    v_mfma_f32_16x16x32_bf16 v[40:43], v[92:95], a[48:51], v[40:43]
    ds_read_b128 v[88:91], v4 offset:57344
    v_mfma_f32_16x16x32_bf16 v[44:47], v[92:95], a[52:55], v[44:47]
    s_waitcnt lgkmcnt(4)
    v_mfma_f32_16x16x32_bf16 v[48:51], v[96:99], a[48:51], v[48:51]
    ds_read_b128 v[92:95], v4 offset:58368
    v_mfma_f32_16x16x32_bf16 v[52:55], v[96:99], a[52:55], v[52:55]
    s_add_u32 s28, s28, 4096
    buffer_load_dwordx4 a[80:83], v6, s[20:23], s28 offen offset:0 sc1
    s_waitcnt lgkmcnt(4)
    v_mfma_f32_16x16x32_bf16 v[56:59], v[100:103], a[48:51], v[56:59]
    ds_read_b128 v[96:99], v4 offset:59392
    v_mfma_f32_16x16x32_bf16 v[60:63], v[100:103], a[52:55], v[60:63]
    s_waitcnt lgkmcnt(4)
    v_mfma_f32_16x16x32_bf16 v[64:67], v[80:83], a[48:51], v[64:67]
    ds_read_b128 v[100:103], v4 offset:60416
    v_mfma_f32_16x16x32_bf16 v[68:71], v[80:83], a[52:55], v[68:71]
    buffer_load_dwordx4 a[84:87], v6, s[20:23], s28 offen offset:256 sc1
    s_waitcnt lgkmcnt(4)
    v_mfma_f32_16x16x32_bf16 v[72:75], v[84:87], a[48:51], v[72:75]
    ds_read_b128 v[80:83], v4 offset:61440
    v_mfma_f32_16x16x32_bf16 v[76:79], v[84:87], a[52:55], v[76:79]
    s_waitcnt vmcnt(6) lgkmcnt(4)
    v_mfma_f32_16x16x32_bf16 v[16:19], v[88:91], a[56:59], v[16:19]
    ds_read_b128 v[84:87], v4 offset:62464
    v_mfma_f32_16x16x32_bf16 v[20:23], v[88:91], a[60:63], v[20:23]
    buffer_load_dwordx4 a[88:91], v6, s[20:23], s28 offen offset:2048 sc1
    s_waitcnt lgkmcnt(4)
    v_mfma_f32_16x16x32_bf16 v[24:27], v[92:95], a[56:59], v[24:27]
    ds_read_b128 v[88:91], v4 offset:63488
    v_mfma_f32_16x16x32_bf16 v[28:31], v[92:95], a[60:63], v[28:31]
    s_waitcnt lgkmcnt(4)
    v_mfma_f32_16x16x32_bf16 v[32:35], v[96:99], a[56:59], v[32:35]
    ds_read_b128 v[92:95], v4 offset:64512
    v_mfma_f32_16x16x32_bf16 v[36:39], v[96:99], a[60:63], v[36:39]
    buffer_load_dwordx4 a[92:95], v6, s[20:23], s28 offen offset:2304 sc1
    s_waitcnt lgkmcnt(4)
    v_mfma_f32_16x16x32_bf16 v[40:43], v[100:103], a[56:59], v[40:43]
    ds_read_b128 v[96:99], v12 offset:0
    v_mfma_f32_16x16x32_bf16 v[44:47], v[100:103], a[60:63], v[44:47]
    s_waitcnt lgkmcnt(4)
    v_mfma_f32_16x16x32_bf16 v[48:51], v[80:83], a[56:59], v[48:51]
    ds_read_b128 v[100:103], v12 offset:1024
    v_mfma_f32_16x16x32_bf16 v[52:55], v[80:83], a[60:63], v[52:55]
    s_add_u32 m0, s30, 0
    s_add_u32 s33, s45, 24576
    buffer_load_dwordx4 v4, s[20:23], s33 offen sc1 lds
    s_waitcnt lgkmcnt(4)
    v_mfma_f32_16x16x32_bf16 v[56:59], v[84:87], a[56:59], v[56:59]
    ds_read_b128 v[80:83], v12 offset:2048
    v_mfma_f32_16x16x32_bf16 v[60:63], v[84:87], a[60:63], v[60:63]
    s_waitcnt lgkmcnt(4)
    v_mfma_f32_16x16x32_bf16 v[64:67], v[88:91], a[56:59], v[64:67]
    ds_read_b128 v[84:87], v12 offset:3072
    v_mfma_f32_16x16x32_bf16 v[68:71], v[88:91], a[60:63], v[68:71]
    s_add_u32 m0, s30, 8192
    s_add_u32 s33, s45, 26624
    buffer_load_dwordx4 v4, s[20:23], s33 offen sc1 lds
    s_waitcnt lgkmcnt(4)
    v_mfma_f32_16x16x32_bf16 v[72:75], v[92:95], a[56:59], v[72:75]
    ds_read_b128 v[88:91], v12 offset:4096
    v_mfma_f32_16x16x32_bf16 v[76:79], v[92:95], a[60:63], v[76:79]
    s_waitcnt vmcnt(8) lgkmcnt(4)
    v_mfma_f32_16x16x32_bf16 v[16:19], v[96:99], a[64:67], v[16:19]
    ds_read_b128 v[92:95], v12 offset:5120
    v_mfma_f32_16x16x32_bf16 v[20:23], v[96:99], a[68:71], v[20:23]
    s_add_u32 m0, s30, 16384
    s_add_u32 s33, s45, 28672
    buffer_load_dwordx4 v4, s[20:23], s33 offen sc1 lds
    s_waitcnt lgkmcnt(4)
    v_mfma_f32_16x16x32_bf16 v[24:27], v[100:103], a[64:67], v[24:27]
    ds_read_b128 v[96:99], v12 offset:6144
    v_mfma_f32_16x16x32_bf16 v[28:31], v[100:103], a[68:71], v[28:31]
    s_waitcnt lgkmcnt(4)
    v_mfma_f32_16x16x32_bf16 v[32:35], v[80:83], a[64:67], v[32:35]
    ds_read_b128 v[100:103], v12 offset:7168
    v_mfma_f32_16x16x32_bf16 v[36:39], v[80:83], a[68:71], v[36:39]
    s_waitcnt lgkmcnt(4)
    v_mfma_f32_16x16x32_bf16 v[40:43], v[84:87], a[64:67], v[40:43]
    s_waitcnt vmcnt(27)
    s_barrier
    ds_read_b128 v[80:83], v12 offset:8192
    v_mfma_f32_16x16x32_bf16 v[44:47], v[84:87], a[68:71], v[44:47]
    s_waitcnt lgkmcnt(4)
    v_mfma_f32_16x16x32_bf16 v[48:51], v[88:91], a[64:67], v[48:51]
    ds_read_b128 v[84:87], v12 offset:9216
    v_mfma_f32_16x16x32_bf16 v[52:55], v[88:91], a[68:71], v[52:55]
    s_waitcnt lgkmcnt(4)
    v_mfma_f32_16x16x32_bf16 v[56:59], v[92:95], a[64:67], v[56:59]
    ds_read_b128 v[88:91], v12 offset:10240
    v_mfma_f32_16x16x32_bf16 v[60:63], v[92:95], a[68:71], v[60:63]
    s_waitcnt lgkmcnt(4)
    v_mfma_f32_16x16x32_bf16 v[64:67], v[96:99], a[64:67], v[64:67]
    ds_read_b128 v[92:95], v12 offset:11264
    v_mfma_f32_16x16x32_bf16 v[68:71], v[96:99], a[68:71], v[68:71]
    s_waitcnt lgkmcnt(4)
    v_mfma_f32_16x16x32_bf16 v[72:75], v[100:103], a[64:67], v[72:75]
    ds_read_b128 v[96:99], v12 offset:12288
    v_mfma_f32_16x16x32_bf16 v[76:79], v[100:103], a[68:71], v[76:79]
    s_waitcnt vmcnt(7) lgkmcnt(4)
    v_mfma_f32_16x16x32_bf16 v[16:19], v[80:83], a[72:75], v[16:19]
    ds_read_b128 v[100:103], v12 offset:13312
    s_add_u32 s28, s28, 4096
    buffer_load_dwordx4 a[96:99], v6, s[20:23], s28 offen offset:0 sc1
    v_mfma_f32_16x16x32_bf16 v[20:23], v[80:83], a[76:79], v[20:23]
    buffer_load_dwordx4 a[100:103], v6, s[20:23], s28 offen offset:256 sc1
    s_waitcnt lgkmcnt(4)
    v_mfma_f32_16x16x32_bf16 v[24:27], v[84:87], a[72:75], v[24:27]
    ds_read_b128 v[80:83], v12 offset:14336
    v_mfma_f32_16x16x32_bf16 v[28:31], v[84:87], a[76:79], v[28:31]
    buffer_load_dwordx4 a[104:107], v6, s[20:23], s28 offen offset:2048 sc1
    s_waitcnt lgkmcnt(4)
    v_mfma_f32_16x16x32_bf16 v[32:35], v[88:91], a[72:75], v[32:35]
    ds_read_b128 v[84:87], v12 offset:15360
    v_mfma_f32_16x16x32_bf16 v[36:39], v[88:91], a[76:79], v[36:39]
    buffer_load_dwordx4 a[108:111], v6, s[20:23], s28 offen offset:2304 sc1
    s_waitcnt lgkmcnt(4)
    v_mfma_f32_16x16x32_bf16 v[40:43], v[92:95], a[72:75], v[40:43]
    ds_read_b128 v[88:91], v12 offset:16384
    v_mfma_f32_16x16x32_bf16 v[44:47], v[92:95], a[76:79], v[44:47]
    s_add_u32 s28, s28, 4096
    buffer_load_dwordx4 a[112:115], v6, s[20:23], s28 offen offset:0 sc1
    s_waitcnt lgkmcnt(4)
    v_mfma_f32_16x16x32_bf16 v[48:51], v[96:99], a[72:75], v[48:51]
    ds_read_b128 v[92:95], v12 offset:17408
    v_mfma_f32_16x16x32_bf16 v[52:55], v[96:99], a[76:79], v[52:55]
    buffer_load_dwordx4 a[116:119], v6, s[20:23], s28 offen offset:256 sc1
    s_waitcnt lgkmcnt(4)
    v_mfma_f32_16x16x32_bf16 v[56:59], v[100:103], a[72:75], v[56:59]
    ds_read_b128 v[96:99], v12 offset:18432
    v_mfma_f32_16x16x32_bf16 v[60:63], v[100:103], a[76:79], v[60:63]
    s_add_u32 m0, s30, 24576
    s_add_u32 s33, s45, 30720
    buffer_load_dwordx4 v4, s[20:23], s33 offen sc1 lds
    s_waitcnt lgkmcnt(4)
    v_mfma_f32_16x16x32_bf16 v[64:67], v[80:83], a[72:75], v[64:67]
    ds_read_b128 v[100:103], v12 offset:19456
    v_mfma_f32_16x16x32_bf16 v[68:71], v[80:83], a[76:79], v[68:71]
    s_add_u32 m0, s30, 32768
    s_add_u32 s33, s45, 32768
    buffer_load_dwordx4 v4, s[20:23], s33 offen sc1 lds
    s_waitcnt lgkmcnt(4)
    v_mfma_f32_16x16x32_bf16 v[72:75], v[84:87], a[72:75], v[72:75]
    ds_read_b128 v[80:83], v12 offset:20480
    v_mfma_f32_16x16x32_bf16 v[76:79], v[84:87], a[76:79], v[76:79]
    s_add_u32 m0, s30, 40960
    s_add_u32 s33, s45, 34816
    buffer_load_dwordx4 v4, s[20:23], s33 offen sc1 lds
    s_waitcnt vmcnt(14) lgkmcnt(4)
    v_mfma_f32_16x16x32_bf16 v[16:19], v[88:91], a[80:83], v[16:19]
    ds_read_b128 v[84:87], v12 offset:21504
    v_mfma_f32_16x16x32_bf16 v[20:23], v[88:91], a[84:87], v[20:23]
    buffer_load_dword v8, v2, s[20:23], s31 offen offset:0 sc1
    s_waitcnt lgkmcnt(4)
    v_mfma_f32_16x16x32_bf16 v[24:27], v[92:95], a[80:83], v[24:27]
    ds_read_b128 v[88:91], v12 offset:22528
    v_mfma_f32_16x16x32_bf16 v[28:31], v[92:95], a[84:87], v[28:31]
    buffer_load_dword v9, v2, s[20:23], s31 offen offset:128 sc1
    s_waitcnt lgkmcnt(4)
    v_mfma_f32_16x16x32_bf16 v[32:35], v[96:99], a[80:83], v[32:35]
    ds_read_b128 v[92:95], v12 offset:23552
    v_mfma_f32_16x16x32_bf16 v[36:39], v[96:99], a[84:87], v[36:39]
    buffer_load_dword v10, v2, s[20:23], s31 offen offset:256 sc1
    s_waitcnt lgkmcnt(4)
    v_mfma_f32_16x16x32_bf16 v[40:43], v[100:103], a[80:83], v[40:43]
    ds_read_b128 v[96:99], v12 offset:24576
    v_mfma_f32_16x16x32_bf16 v[44:47], v[100:103], a[84:87], v[44:47]
    buffer_load_dword v11, v2, s[20:23], s31 offen offset:384 sc1
    s_waitcnt lgkmcnt(4)
    v_mfma_f32_16x16x32_bf16 v[48:51], v[80:83], a[80:83], v[48:51]
    ds_read_b128 v[100:103], v12 offset:25600
    v_mfma_f32_16x16x32_bf16 v[52:55], v[80:83], a[84:87], v[52:55]
    buffer_load_dword v104, v2, s[20:23], s31 offen offset:512 sc1
    s_waitcnt lgkmcnt(4)
    v_mfma_f32_16x16x32_bf16 v[56:59], v[84:87], a[80:83], v[56:59]
    ds_read_b128 v[80:83], v12 offset:26624
    v_mfma_f32_16x16x32_bf16 v[60:63], v[84:87], a[84:87], v[60:63]
    buffer_load_dword v108, v2, s[20:23], s31 offen offset:64 sc1
    s_waitcnt lgkmcnt(4)
    v_mfma_f32_16x16x32_bf16 v[64:67], v[88:91], a[80:83], v[64:67]
    ds_read_b128 v[84:87], v12 offset:27648
    v_mfma_f32_16x16x32_bf16 v[68:71], v[88:91], a[84:87], v[68:71]
    buffer_load_dword v109, v2, s[20:23], s31 offen offset:192 sc1
    s_waitcnt lgkmcnt(4)
    v_mfma_f32_16x16x32_bf16 v[72:75], v[92:95], a[80:83], v[72:75]
    ds_read_b128 v[88:91], v12 offset:28672
    v_mfma_f32_16x16x32_bf16 v[76:79], v[92:95], a[84:87], v[76:79]
    buffer_load_dword v110, v2, s[20:23], s31 offen offset:320 sc1
    s_waitcnt vmcnt(20) lgkmcnt(4)
    v_mfma_f32_16x16x32_bf16 v[16:19], v[96:99], a[88:91], v[16:19]
    ds_read_b128 v[92:95], v12 offset:29696
    v_mfma_f32_16x16x32_bf16 v[20:23], v[96:99], a[92:95], v[20:23]
    buffer_load_dword v111, v2, s[20:23], s31 offen offset:448 sc1
    s_waitcnt lgkmcnt(4)
    v_mfma_f32_16x16x32_bf16 v[24:27], v[100:103], a[88:91], v[24:27]
    ds_read_b128 v[96:99], v12 offset:30720
    v_mfma_f32_16x16x32_bf16 v[28:31], v[100:103], a[92:95], v[28:31]
    buffer_load_dword v105, v2, s[20:23], s31 offen offset:576 sc1
    s_waitcnt lgkmcnt(4)
    v_mfma_f32_16x16x32_bf16 v[32:35], v[80:83], a[88:91], v[32:35]
    ds_read_b128 v[100:103], v12 offset:31744
    v_mfma_f32_16x16x32_bf16 v[36:39], v[80:83], a[92:95], v[36:39]
    s_waitcnt lgkmcnt(4)
    v_mfma_f32_16x16x32_bf16 v[40:43], v[84:87], a[88:91], v[40:43]
    s_waitcnt vmcnt(19)
    s_barrier
    ds_read_b128 v[80:83], v4 offset:0
    v_mfma_f32_16x16x32_bf16 v[44:47], v[84:87], a[92:95], v[44:47]
    s_waitcnt lgkmcnt(4)
    v_mfma_f32_16x16x32_bf16 v[48:51], v[88:91], a[88:91], v[48:51]
    ds_read_b128 v[84:87], v4 offset:1024
    v_mfma_f32_16x16x32_bf16 v[52:55], v[88:91], a[92:95], v[52:55]
    s_waitcnt lgkmcnt(4)
    v_mfma_f32_16x16x32_bf16 v[56:59], v[92:95], a[88:91], v[56:59]
    ds_read_b128 v[88:91], v4 offset:2048
    v_mfma_f32_16x16x32_bf16 v[60:63], v[92:95], a[92:95], v[60:63]
    s_waitcnt lgkmcnt(4)
    v_mfma_f32_16x16x32_bf16 v[64:67], v[96:99], a[88:91], v[64:67]
    ds_read_b128 v[92:95], v4 offset:3072
    v_mfma_f32_16x16x32_bf16 v[68:71], v[96:99], a[92:95], v[68:71]
    s_waitcnt lgkmcnt(4)
    v_mfma_f32_16x16x32_bf16 v[72:75], v[100:103], a[88:91], v[72:75]
    ds_read_b128 v[96:99], v4 offset:4096
    v_mfma_f32_16x16x32_bf16 v[76:79], v[100:103], a[92:95], v[76:79]
    s_waitcnt vmcnt(17) lgkmcnt(4)
    v_mfma_f32_16x16x32_bf16 v[16:19], v[80:83], a[96:99], v[16:19]
    ds_read_b128 v[100:103], v4 offset:5120
    v_mfma_f32_16x16x32_bf16 v[20:23], v[80:83], a[100:103], v[20:23]
    buffer_load_dwordx4 a[120:123], v6, s[20:23], s28 offen offset:2048 sc1
    s_waitcnt lgkmcnt(4)
    v_mfma_f32_16x16x32_bf16 v[24:27], v[84:87], a[96:99], v[24:27]
    ds_read_b128 v[80:83], v4 offset:6144
    v_mfma_f32_16x16x32_bf16 v[28:31], v[84:87], a[100:103], v[28:31]
    s_waitcnt lgkmcnt(4)
    v_mfma_f32_16x16x32_bf16 v[32:35], v[88:91], a[96:99], v[32:35]
    ds_read_b128 v[84:87], v4 offset:7168
    v_mfma_f32_16x16x32_bf16 v[36:39], v[88:91], a[100:103], v[36:39]
    buffer_load_dwordx4 a[124:127], v6, s[20:23], s28 offen offset:2304 sc1
    s_waitcnt lgkmcnt(4)
    v_mfma_f32_16x16x32_bf16 v[40:43], v[92:95], a[96:99], v[40:43]
    ds_read_b128 v[88:91], v4 offset:8192
    v_mfma_f32_16x16x32_bf16 v[44:47], v[92:95], a[100:103], v[44:47]
    s_waitcnt lgkmcnt(4)
    v_mfma_f32_16x16x32_bf16 v[48:51], v[96:99], a[96:99], v[48:51]
    ds_read_b128 v[92:95], v4 offset:9216
    v_mfma_f32_16x16x32_bf16 v[52:55], v[96:99], a[100:103], v[52:55]
    s_add_u32 s28, s28, 4096
    buffer_load_dwordx4 v[112:115], v6, s[20:23], s28 offen offset:0 sc1
    s_waitcnt lgkmcnt(4)
    v_mfma_f32_16x16x32_bf16 v[56:59], v[100:103], a[96:99], v[56:59]
    ds_read_b128 v[96:99], v4 offset:10240
    v_mfma_f32_16x16x32_bf16 v[60:63], v[100:103], a[100:103], v[60:63]
    s_waitcnt lgkmcnt(4)
    v_mfma_f32_16x16x32_bf16 v[64:67], v[80:83], a[96:99], v[64:67]
    ds_read_b128 v[100:103], v4 offset:11264
    v_mfma_f32_16x16x32_bf16 v[68:71], v[80:83], a[100:103], v[68:71]
    buffer_load_dwordx4 v[116:119], v6, s[20:23], s28 offen offset:256 sc1
    s_waitcnt lgkmcnt(4)
    v_mfma_f32_16x16x32_bf16 v[72:75], v[84:87], a[96:99], v[72:75]
    ds_read_b128 v[80:83], v4 offset:12288
    v_mfma_f32_16x16x32_bf16 v[76:79], v[84:87], a[100:103], v[76:79]
    s_waitcnt vmcnt(19) lgkmcnt(4)
    v_mfma_f32_16x16x32_bf16 v[16:19], v[88:91], a[104:107], v[16:19]
    ds_read_b128 v[84:87], v4 offset:13312
    v_mfma_f32_16x16x32_bf16 v[20:23], v[88:91], a[108:111], v[20:23]
    buffer_load_dwordx4 v[120:123], v6, s[20:23], s28 offen offset:2048 sc1
    s_waitcnt lgkmcnt(4)
    v_mfma_f32_16x16x32_bf16 v[24:27], v[92:95], a[104:107], v[24:27]
    ds_read_b128 v[88:91], v4 offset:14336
    v_mfma_f32_16x16x32_bf16 v[28:31], v[92:95], a[108:111], v[28:31]
    s_waitcnt lgkmcnt(4)
    v_mfma_f32_16x16x32_bf16 v[32:35], v[96:99], a[104:107], v[32:35]
    ds_read_b128 v[92:95], v4 offset:15360
    v_mfma_f32_16x16x32_bf16 v[36:39], v[96:99], a[108:111], v[36:39]
    buffer_load_dwordx4 v[124:127], v6, s[20:23], s28 offen offset:2304 sc1
    s_waitcnt lgkmcnt(4)
    v_mfma_f32_16x16x32_bf16 v[40:43], v[100:103], a[104:107], v[40:43]
    ds_read_b128 v[96:99], v4 offset:16384
    v_mfma_f32_16x16x32_bf16 v[44:47], v[100:103], a[108:111], v[44:47]
    s_waitcnt lgkmcnt(4)
    v_mfma_f32_16x16x32_bf16 v[48:51], v[80:83], a[104:107], v[48:51]
    ds_read_b128 v[100:103], v4 offset:17408
    v_mfma_f32_16x16x32_bf16 v[52:55], v[80:83], a[108:111], v[52:55]
    s_add_u32 m0, s30, 49152
    s_add_u32 s33, s32, 147456
    buffer_load_dwordx4 v4, s[20:23], s33 offen sc1 lds
    s_waitcnt lgkmcnt(4)
    v_mfma_f32_16x16x32_bf16 v[56:59], v[84:87], a[104:107], v[56:59]
    ds_read_b128 v[80:83], v4 offset:18432
    v_mfma_f32_16x16x32_bf16 v[60:63], v[84:87], a[108:111], v[60:63]
    s_waitcnt lgkmcnt(4)
    v_mfma_f32_16x16x32_bf16 v[64:67], v[88:91], a[104:107], v[64:67]
    ds_read_b128 v[84:87], v4 offset:19456
    s_add_u32 m0, s30, 57344
    s_add_u32 s33, s32, 155648
    buffer_load_dwordx4 v4, s[20:23], s33 offen sc1 lds
    v_mfma_f32_16x16x32_bf16 v[68:71], v[88:91], a[108:111], v[68:71]
    s_waitcnt vmcnt(8)
    s_waitcnt lgkmcnt(4)
    v_mfma_f32_16x16x32_bf16 v[72:75], v[92:95], a[104:107], v[72:75]
    ds_read_b128 v[88:91], v4 offset:20480
    v_mfma_f32_16x16x32_bf16 v[76:79], v[92:95], a[108:111], v[76:79]
    v_add_f32 v8, v8, v9
    s_waitcnt vmcnt(21) lgkmcnt(4)
    v_mfma_f32_16x16x32_bf16 v[16:19], v[96:99], a[112:115], v[16:19]
    ds_read_b128 v[92:95], v4 offset:21504
    s_add_u32 m0, s30, 65536
    s_add_u32 s33, s32, 163840
    buffer_load_dwordx4 v4, s[20:23], s33 offen sc1 lds
    v_mfma_f32_16x16x32_bf16 v[20:23], v[96:99], a[116:119], v[20:23]
    v_add_f32 v10, v10, v11
    s_waitcnt lgkmcnt(4)
    v_mfma_f32_16x16x32_bf16 v[24:27], v[100:103], a[112:115], v[24:27]
    ds_read_b128 v[96:99], v4 offset:22528
    v_mfma_f32_16x16x32_bf16 v[28:31], v[100:103], a[116:119], v[28:31]
    v_add_f32 v8, v8, v104
    s_waitcnt lgkmcnt(4)
    v_mfma_f32_16x16x32_bf16 v[32:35], v[80:83], a[112:115], v[32:35]
    ds_read_b128 v[100:103], v4 offset:23552
    v_mfma_f32_16x16x32_bf16 v[36:39], v[80:83], a[116:119], v[36:39]
    v_add_f32 v8, v8, v10
    s_waitcnt lgkmcnt(4)
    v_mfma_f32_16x16x32_bf16 v[40:43], v[84:87], a[112:115], v[40:43]
    s_waitcnt vmcnt(19)
    s_barrier
    ds_read_b128 v[80:83], v4 offset:24576
    v_mfma_f32_16x16x32_bf16 v[44:47], v[84:87], a[116:119], v[44:47]
    v_mov_b32 v9, v8
    s_waitcnt lgkmcnt(4)
    v_mfma_f32_16x16x32_bf16 v[48:51], v[88:91], a[112:115], v[48:51]
    ds_read_b128 v[84:87], v4 offset:25600
    s_add_u32 m0, s30, 73728
    s_add_u32 s33, s32, 172032
    buffer_load_dwordx4 v4, s[20:23], s33 offen sc1 lds
    v_mfma_f32_16x16x32_bf16 v[52:55], v[88:91], a[116:119], v[52:55]
    v_permlane16_swap_b32 v8, v9
    s_waitcnt lgkmcnt(4)
    v_mfma_f32_16x16x32_bf16 v[56:59], v[92:95], a[112:115], v[56:59]
    ds_read_b128 v[88:91], v4 offset:26624
    v_mfma_f32_16x16x32_bf16 v[60:63], v[92:95], a[116:119], v[60:63]
    v_add_f32 v8, v8, v9
    s_waitcnt lgkmcnt(4)
    v_mfma_f32_16x16x32_bf16 v[64:67], v[96:99], a[112:115], v[64:67]
    ds_read_b128 v[92:95], v4 offset:27648
    s_add_u32 m0, s30, 81920
    s_add_u32 s33, s32, 180224
    buffer_load_dwordx4 v4, s[20:23], s33 offen sc1 lds
    v_mfma_f32_16x16x32_bf16 v[68:71], v[96:99], a[116:119], v[68:71]
    v_mov_b32 v9, v8
    s_waitcnt lgkmcnt(4)
    v_mfma_f32_16x16x32_bf16 v[72:75], v[100:103], a[112:115], v[72:75]
    ds_read_b128 v[96:99], v4 offset:28672
    v_mfma_f32_16x16x32_bf16 v[76:79], v[100:103], a[116:119], v[76:79]
    v_permlane32_swap_b32 v8, v9
    s_waitcnt vmcnt(9) lgkmcnt(4)
    v_mfma_f32_16x16x32_bf16 v[16:19], v[80:83], a[120:123], v[16:19]
    ds_read_b128 v[100:103], v4 offset:29696
    v_mfma_f32_16x16x32_bf16 v[20:23], v[80:83], a[124:127], v[20:23]
    v_add_f32 v8, v8, v9
    s_waitcnt lgkmcnt(4)
    v_mfma_f32_16x16x32_bf16 v[24:27], v[84:87], a[120:123], v[24:27]
    ds_read_b128 v[80:83], v4 offset:30720
    s_add_u32 m0, s30, 90112
    s_add_u32 s33, s32, 188416
    buffer_load_dwordx4 v4, s[20:23], s33 offen sc1 lds
    v_mfma_f32_16x16x32_bf16 v[28:31], v[84:87], a[124:127], v[28:31]
    v_mov_b32 v2, 0x3727c5ac
    s_waitcnt lgkmcnt(4)
    v_mfma_f32_16x16x32_bf16 v[32:35], v[88:91], a[120:123], v[32:35]
    ds_read_b128 v[84:87], v4 offset:31744
    v_mfma_f32_16x16x32_bf16 v[36:39], v[88:91], a[124:127], v[36:39]
    v_fmac_f32 v2, 0x3ae38e39, v8
    s_waitcnt lgkmcnt(4)
    v_mfma_f32_16x16x32_bf16 v[40:43], v[92:95], a[120:123], v[40:43]
    ds_read_b128 v[88:91], v4 offset:32768
    v_mfma_f32_16x16x32_bf16 v[44:47], v[92:95], a[124:127], v[44:47]
    v_rsq_f32 v14, v2
    s_waitcnt lgkmcnt(4)
    v_mfma_f32_16x16x32_bf16 v[48:51], v[96:99], a[120:123], v[48:51]
    ds_read_b128 v[92:95], v4 offset:33792
    v_mfma_f32_16x16x32_bf16 v[52:55], v[96:99], a[124:127], v[52:55]
    v_mul_f32 v14, 0xbfb8aa3b, v14
    s_waitcnt lgkmcnt(4)
    v_mfma_f32_16x16x32_bf16 v[56:59], v[100:103], a[120:123], v[56:59]
    ds_read_b128 v[96:99], v4 offset:34816
    v_mfma_f32_16x16x32_bf16 v[60:63], v[100:103], a[124:127], v[60:63]
    v_add_f32 v108, v108, v109
    s_waitcnt lgkmcnt(4)
    v_mfma_f32_16x16x32_bf16 v[64:67], v[80:83], a[120:123], v[64:67]
    ds_read_b128 v[100:103], v4 offset:35840
    v_mfma_f32_16x16x32_bf16 v[68:71], v[80:83], a[124:127], v[68:71]
    v_add_f32 v110, v110, v111
    s_waitcnt lgkmcnt(4)
    v_mfma_f32_16x16x32_bf16 v[72:75], v[84:87], a[120:123], v[72:75]
    ds_read_b128 v[80:83], v4 offset:36864
    v_mfma_f32_16x16x32_bf16 v[76:79], v[84:87], a[124:127], v[76:79]
    v_add_f32 v108, v108, v105
    s_waitcnt vmcnt(8) lgkmcnt(4)
    v_mfma_f32_16x16x32_bf16 v[16:19], v[88:91], v[112:115], v[16:19]
    ds_read_b128 v[84:87], v4 offset:37888
    v_mfma_f32_16x16x32_bf16 v[20:23], v[88:91], v[116:119], v[20:23]
    v_add_f32 v108, v108, v110
    s_waitcnt lgkmcnt(4)
    v_mfma_f32_16x16x32_bf16 v[24:27], v[92:95], v[112:115], v[24:27]
    ds_read_b128 v[88:91], v4 offset:38912
    v_mfma_f32_16x16x32_bf16 v[28:31], v[92:95], v[116:119], v[28:31]
    v_mov_b32 v109, v108
    s_waitcnt lgkmcnt(4)
    v_mfma_f32_16x16x32_bf16 v[32:35], v[96:99], v[112:115], v[32:35]
    ds_read_b128 v[92:95], v4 offset:39936
    v_mfma_f32_16x16x32_bf16 v[36:39], v[96:99], v[116:119], v[36:39]
    v_permlane16_swap_b32 v108, v109
    s_waitcnt lgkmcnt(4)
    v_mfma_f32_16x16x32_bf16 v[40:43], v[100:103], v[112:115], v[40:43]
    ds_read_b128 v[96:99], v4 offset:40960
    v_mfma_f32_16x16x32_bf16 v[44:47], v[100:103], v[116:119], v[44:47]
    v_add_f32 v108, v108, v109
    s_waitcnt lgkmcnt(4)
    v_mfma_f32_16x16x32_bf16 v[48:51], v[80:83], v[112:115], v[48:51]
    ds_read_b128 v[100:103], v4 offset:41984
    v_mfma_f32_16x16x32_bf16 v[52:55], v[80:83], v[116:119], v[52:55]
    v_mov_b32 v109, v108
    s_waitcnt lgkmcnt(4)
    v_mfma_f32_16x16x32_bf16 v[56:59], v[84:87], v[112:115], v[56:59]
    ds_read_b128 v[80:83], v4 offset:43008
    v_mfma_f32_16x16x32_bf16 v[60:63], v[84:87], v[116:119], v[60:63]
    v_permlane32_swap_b32 v108, v109
    s_waitcnt lgkmcnt(4)
    v_mfma_f32_16x16x32_bf16 v[64:67], v[88:91], v[112:115], v[64:67]
    ds_read_b128 v[84:87], v4 offset:44032
    v_mfma_f32_16x16x32_bf16 v[68:71], v[88:91], v[116:119], v[68:71]
    v_add_f32 v108, v108, v109
    s_waitcnt lgkmcnt(4)
    v_mfma_f32_16x16x32_bf16 v[72:75], v[92:95], v[112:115], v[72:75]
    ds_read_b128 v[88:91], v4 offset:45056
    v_mfma_f32_16x16x32_bf16 v[76:79], v[92:95], v[116:119], v[76:79]
    v_mov_b32 v3, 0x3727c5ac
    s_waitcnt vmcnt(6) lgkmcnt(4)
    v_mfma_f32_16x16x32_bf16 v[16:19], v[96:99], v[120:123], v[16:19]
    ds_read_b128 v[92:95], v4 offset:46080
    v_mfma_f32_16x16x32_bf16 v[20:23], v[96:99], v[124:127], v[20:23]
    v_fmac_f32 v3, 0x3ae38e39, v108
    s_waitcnt lgkmcnt(4)
    v_mfma_f32_16x16x32_bf16 v[24:27], v[100:103], v[120:123], v[24:27]
    ds_read_b128 v[96:99], v4 offset:47104
    v_mfma_f32_16x16x32_bf16 v[28:31], v[100:103], v[124:127], v[28:31]
    v_rsq_f32 v15, v3
    s_waitcnt lgkmcnt(4)
    v_mfma_f32_16x16x32_bf16 v[32:35], v[80:83], v[120:123], v[32:35]
    ds_read_b128 v[100:103], v4 offset:48128
    v_mfma_f32_16x16x32_bf16 v[36:39], v[80:83], v[124:127], v[36:39]
    v_mul_f32 v15, 0xbfb8aa3b, v15
    s_waitcnt lgkmcnt(4)
    v_mfma_f32_16x16x32_bf16 v[40:43], v[84:87], v[120:123], v[40:43]
    s_waitcnt vmcnt(3)
    s_barrier
    ds_read_b128 v[80:83], v4 offset:49152
    v_mfma_f32_16x16x32_bf16 v[44:47], v[84:87], v[124:127], v[44:47]
    s_waitcnt lgkmcnt(4)
    v_mfma_f32_16x16x32_bf16 v[48:51], v[88:91], v[120:123], v[48:51]
    ds_read_b128 v[84:87], v4 offset:50176
    s_add_u32 m0, s30, 0
    s_add_u32 s33, s32, 196608
    buffer_load_dwordx4 v4, s[20:23], s33 offen sc1 lds
    v_mul_f32 v104, v16, v14
    v_mul_f32 v105, v17, v14
    v_mul_f32 v106, v18, v14
    v_mul_f32 v107, v19, v14
    v_exp_f32 v104, v104
    v_exp_f32 v105, v105
    v_mfma_f32_16x16x32_bf16 v[52:55], v[88:91], v[124:127], v[52:55]
    v_exp_f32 v106, v106
    v_exp_f32 v107, v107
    v_mul_f32 v16, v16, v24
    v_mul_f32 v17, v17, v25
    v_mul_f32 v18, v18, v26
    v_mul_f32 v19, v19, v27
    v_fma_f32 v104, v104, v2, v2
    s_waitcnt lgkmcnt(4)
    v_mfma_f32_16x16x32_bf16 v[56:59], v[92:95], v[120:123], v[56:59]
    ds_read_b128 v[88:91], v4 offset:51200
    v_fma_f32 v105, v105, v2, v2
    v_fma_f32 v106, v106, v2, v2
    v_fma_f32 v107, v107, v2, v2
    v_rcp_f32 v104, v104
    v_rcp_f32 v105, v105
    v_rcp_f32 v106, v106
    v_mfma_f32_16x16x32_bf16 v[60:63], v[92:95], v[124:127], v[60:63]
    v_rcp_f32 v107, v107
    v_mul_f32 v16, v16, v104
    v_mul_f32 v17, v17, v105
    v_mul_f32 v18, v18, v106
    v_mul_f32 v19, v19, v107
    v_cvt_pk_bf16_f32 v108, v16, v17
    v_cvt_pk_bf16_f32 v109, v18, v19
    s_waitcnt lgkmcnt(4)
    v_mfma_f32_16x16x32_bf16 v[64:67], v[96:99], v[120:123], v[64:67]
    ds_read_b128 v[92:95], v4 offset:52224
    s_add_u32 m0, s30, 8192
    s_add_u32 s33, s32, 204800
    buffer_load_dwordx4 v4, s[20:23], s33 offen sc1 lds
    v_mul_f32 v104, v20, v15
    v_mul_f32 v105, v21, v15
    v_mul_f32 v106, v22, v15
    v_mul_f32 v107, v23, v15
    v_exp_f32 v104, v104
    v_exp_f32 v105, v105
    v_mfma_f32_16x16x32_bf16 v[68:71], v[96:99], v[124:127], v[68:71]
    v_exp_f32 v106, v106
    v_exp_f32 v107, v107
    v_mul_f32 v20, v20, v28
    v_mul_f32 v21, v21, v29
    v_mul_f32 v22, v22, v30
    v_mul_f32 v23, v23, v31
    v_fma_f32 v104, v104, v3, v3
    s_waitcnt lgkmcnt(4)
    v_mfma_f32_16x16x32_bf16 v[72:75], v[100:103], v[120:123], v[72:75]
    ds_read_b128 v[96:99], v4 offset:53248
    v_fma_f32 v105, v105, v3, v3
    v_fma_f32 v106, v106, v3, v3
    v_fma_f32 v107, v107, v3, v3
    v_rcp_f32 v104, v104
    v_rcp_f32 v105, v105
    v_rcp_f32 v106, v106
    v_mfma_f32_16x16x32_bf16 v[76:79], v[100:103], v[124:127], v[76:79]
    v_rcp_f32 v107, v107
    v_mul_f32 v20, v20, v104
    v_mul_f32 v21, v21, v105
    v_mul_f32 v22, v22, v106
    v_mul_f32 v23, v23, v107
    v_cvt_pk_bf16_f32 v8, v20, v21
    v_cvt_pk_bf16_f32 v9, v22, v23
    s_waitcnt lgkmcnt(4)
    v_mfma_f32_16x16x32_bf16 v[16:19], v[80:83], a[0:3], 0
    ds_read_b128 v[100:103], v4 offset:54272
    v_mfma_f32_16x16x32_bf16 v[20:23], v[80:83], a[4:7], 0
    s_waitcnt lgkmcnt(4)
    v_mfma_f32_16x16x32_bf16 v[24:27], v[84:87], a[0:3], 0
    ds_read_b128 v[80:83], v4 offset:55296
    v_mfma_f32_16x16x32_bf16 v[28:31], v[84:87], a[4:7], 0
    s_add_u32 m0, s30, 16384
    s_add_u32 s33, s32, 212992
    buffer_load_dwordx4 v4, s[20:23], s33 offen sc1 lds
    s_waitcnt lgkmcnt(4)
    v_mfma_f32_16x16x32_bf16 v[16:19], v[88:91], a[8:11], v[16:19]
    ds_read_b128 v[84:87], v4 offset:56320
    v_mul_f32 v104, v32, v14
    v_mfma_f32_16x16x32_bf16 v[20:23], v[88:91], a[12:15], v[20:23]
    v_mul_f32 v105, v33, v14
    v_mul_f32 v106, v34, v14
    s_waitcnt lgkmcnt(4)
    v_mfma_f32_16x16x32_bf16 v[24:27], v[92:95], a[8:11], v[24:27]
    ds_read_b128 v[88:91], v4 offset:57344
    v_mul_f32 v107, v35, v14
    v_mfma_f32_16x16x32_bf16 v[28:31], v[92:95], a[12:15], v[28:31]
    v_exp_f32 v104, v104
    v_exp_f32 v105, v105
    s_waitcnt lgkmcnt(4)
    v_mfma_f32_16x16x32_bf16 v[16:19], v[96:99], a[16:19], v[16:19]
    ds_read_b128 v[92:95], v4 offset:58368
    v_exp_f32 v106, v106
    v_mfma_f32_16x16x32_bf16 v[20:23], v[96:99], a[20:23], v[20:23]
    v_exp_f32 v107, v107
    v_mul_f32 v32, v32, v40
    s_waitcnt lgkmcnt(4)
    v_mfma_f32_16x16x32_bf16 v[24:27], v[100:103], a[16:19], v[24:27]
    ds_read_b128 v[96:99], v4 offset:59392
    v_mul_f32 v33, v33, v41
    v_mfma_f32_16x16x32_bf16 v[28:31], v[100:103], a[20:23], v[28:31]
    v_mul_f32 v34, v34, v42
    s_waitcnt lgkmcnt(4)
    v_mfma_f32_16x16x32_bf16 v[16:19], v[80:83], a[24:27], v[16:19]
    ds_read_b128 v[100:103], v4 offset:60416
    v_mul_f32 v35, v35, v43
    v_mfma_f32_16x16x32_bf16 v[20:23], v[80:83], a[28:31], v[20:23]
    v_fma_f32 v104, v104, v2, v2
    v_fma_f32 v105, v105, v2, v2
    s_waitcnt lgkmcnt(4)
    v_mfma_f32_16x16x32_bf16 v[24:27], v[84:87], a[24:27], v[24:27]
    ds_read_b128 v[80:83], v4 offset:61440
    v_fma_f32 v106, v106, v2, v2
    v_mfma_f32_16x16x32_bf16 v[28:31], v[84:87], a[28:31], v[28:31]
    v_fma_f32 v107, v107, v2, v2
    v_rcp_f32 v104, v104
    s_waitcnt lgkmcnt(4)
    v_mfma_f32_16x16x32_bf16 v[16:19], v[88:91], a[32:35], v[16:19]
    ds_read_b128 v[84:87], v4 offset:62464
    v_rcp_f32 v105, v105
    v_mfma_f32_16x16x32_bf16 v[20:23], v[88:91], a[36:39], v[20:23]
    v_rcp_f32 v106, v106
    s_waitcnt lgkmcnt(4)
    v_mfma_f32_16x16x32_bf16 v[24:27], v[92:95], a[32:35], v[24:27]
    ds_read_b128 v[88:91], v4 offset:63488
    v_rcp_f32 v107, v107
    v_mfma_f32_16x16x32_bf16 v[28:31], v[92:95], a[36:39], v[28:31]
    v_mul_f32 v32, v32, v104
    v_mul_f32 v33, v33, v105
    s_waitcnt lgkmcnt(4)
    v_mfma_f32_16x16x32_bf16 v[16:19], v[96:99], a[40:43], v[16:19]
    ds_read_b128 v[92:95], v4 offset:64512
    v_mul_f32 v34, v34, v106
    v_mfma_f32_16x16x32_bf16 v[20:23], v[96:99], a[44:47], v[20:23]
    v_mul_f32 v35, v35, v107
    v_cvt_pk_bf16_f32 v110, v32, v33
    s_waitcnt lgkmcnt(4)
    v_mfma_f32_16x16x32_bf16 v[24:27], v[100:103], a[40:43], v[24:27]
    ds_read_b128 v[96:99], v12 offset:0
    v_cvt_pk_bf16_f32 v111, v34, v35
    v_mfma_f32_16x16x32_bf16 v[28:31], v[100:103], a[44:47], v[28:31]
    s_add_u32 s33, s36, 0
    buffer_store_dwordx4 v[108:111], v4, s[20:23], s33 offen offset:0 sc1
    s_waitcnt lgkmcnt(4)
    v_mfma_f32_16x16x32_bf16 v[16:19], v[80:83], a[48:51], v[16:19]
    ds_read_b128 v[100:103], v12 offset:1024
    v_mul_f32 v104, v36, v15
    v_mfma_f32_16x16x32_bf16 v[20:23], v[80:83], a[52:55], v[20:23]
    v_mul_f32 v105, v37, v15
    v_mul_f32 v106, v38, v15
    s_waitcnt lgkmcnt(4)
    v_mfma_f32_16x16x32_bf16 v[24:27], v[84:87], a[48:51], v[24:27]
    ds_read_b128 v[80:83], v12 offset:2048
    v_mul_f32 v107, v39, v15
    v_mfma_f32_16x16x32_bf16 v[28:31], v[84:87], a[52:55], v[28:31]
    v_exp_f32 v104, v104
    v_exp_f32 v105, v105
    s_waitcnt lgkmcnt(4)
    v_mfma_f32_16x16x32_bf16 v[16:19], v[88:91], a[56:59], v[16:19]
    ds_read_b128 v[84:87], v12 offset:3072
    v_exp_f32 v106, v106
    v_mfma_f32_16x16x32_bf16 v[20:23], v[88:91], a[60:63], v[20:23]
    v_exp_f32 v107, v107
    v_mul_f32 v36, v36, v44
    s_waitcnt lgkmcnt(4)
    v_mfma_f32_16x16x32_bf16 v[24:27], v[92:95], a[56:59], v[24:27]
    ds_read_b128 v[88:91], v12 offset:4096
    v_mul_f32 v37, v37, v45
    v_mfma_f32_16x16x32_bf16 v[28:31], v[92:95], a[60:63], v[28:31]
    v_mul_f32 v38, v38, v46
    s_waitcnt lgkmcnt(4)
    v_mfma_f32_16x16x32_bf16 v[16:19], v[96:99], a[64:67], v[16:19]
    ds_read_b128 v[92:95], v12 offset:5120
    v_mul_f32 v39, v39, v47
    v_mfma_f32_16x16x32_bf16 v[20:23], v[96:99], a[68:71], v[20:23]
    v_fma_f32 v104, v104, v3, v3
    v_fma_f32 v105, v105, v3, v3
    s_waitcnt lgkmcnt(4)
    v_mfma_f32_16x16x32_bf16 v[24:27], v[100:103], a[64:67], v[24:27]
    ds_read_b128 v[96:99], v12 offset:6144
    v_fma_f32 v106, v106, v3, v3
    v_mfma_f32_16x16x32_bf16 v[28:31], v[100:103], a[68:71], v[28:31]
    v_fma_f32 v107, v107, v3, v3
    v_rcp_f32 v104, v104
    s_waitcnt lgkmcnt(4)
    v_mfma_f32_16x16x32_bf16 v[16:19], v[80:83], a[72:75], v[16:19]
    ds_read_b128 v[100:103], v12 offset:7168
    v_rcp_f32 v105, v105
    v_mfma_f32_16x16x32_bf16 v[20:23], v[80:83], a[76:79], v[20:23]
    v_rcp_f32 v106, v106
    s_waitcnt lgkmcnt(4)
    v_mfma_f32_16x16x32_bf16 v[24:27], v[84:87], a[72:75], v[24:27]
    s_waitcnt vmcnt(3)
    s_barrier
    ds_read_b128 v[80:83], v12 offset:8192
    v_rcp_f32 v107, v107
    v_mfma_f32_16x16x32_bf16 v[28:31], v[84:87], a[76:79], v[28:31]
    v_mul_f32 v36, v36, v104
    v_mul_f32 v37, v37, v105
    s_waitcnt lgkmcnt(4)
    v_mfma_f32_16x16x32_bf16 v[16:19], v[88:91], a[80:83], v[16:19]
    ds_read_b128 v[84:87], v12 offset:9216
    s_add_u32 m0, s30, 24576
    s_add_u32 s33, s32, 221184
    buffer_load_dwordx4 v4, s[20:23], s33 offen sc1 lds
    v_mul_f32 v38, v38, v106
    v_mfma_f32_16x16x32_bf16 v[20:23], v[88:91], a[84:87], v[20:23]
    v_mul_f32 v39, v39, v107
    v_cvt_pk_bf16_f32 v10, v36, v37
    s_waitcnt lgkmcnt(4)
    v_mfma_f32_16x16x32_bf16 v[24:27], v[92:95], a[80:83], v[24:27]
    ds_read_b128 v[88:91], v12 offset:10240
    v_cvt_pk_bf16_f32 v11, v38, v39
    v_mfma_f32_16x16x32_bf16 v[28:31], v[92:95], a[84:87], v[28:31]
    s_add_u32 s33, s36, 0
    buffer_store_dwordx4 v[8:11], v4, s[20:23], s33 offen offset:1024 sc1
    s_waitcnt lgkmcnt(4)
    v_mfma_f32_16x16x32_bf16 v[16:19], v[96:99], a[88:91], v[16:19]
    ds_read_b128 v[92:95], v12 offset:11264
    s_add_u32 m0, s30, 32768
    s_add_u32 s33, s32, 229376
    buffer_load_dwordx4 v4, s[20:23], s33 offen sc1 lds
    v_mul_f32 v104, v48, v14
    v_mfma_f32_16x16x32_bf16 v[20:23], v[96:99], a[92:95], v[20:23]
    v_mul_f32 v105, v49, v14
    v_mul_f32 v106, v50, v14
    s_waitcnt lgkmcnt(4)
    v_mfma_f32_16x16x32_bf16 v[24:27], v[100:103], a[88:91], v[24:27]
    ds_read_b128 v[96:99], v12 offset:12288
    v_mul_f32 v107, v51, v14
    v_mfma_f32_16x16x32_bf16 v[28:31], v[100:103], a[92:95], v[28:31]
    v_exp_f32 v104, v104
    s_waitcnt lgkmcnt(4)
    v_mfma_f32_16x16x32_bf16 v[16:19], v[80:83], a[96:99], v[16:19]
    ds_read_b128 v[100:103], v12 offset:13312
    v_exp_f32 v105, v105
    v_mfma_f32_16x16x32_bf16 v[20:23], v[80:83], a[100:103], v[20:23]
    v_exp_f32 v106, v106
    s_waitcnt lgkmcnt(4)
    v_mfma_f32_16x16x32_bf16 v[24:27], v[84:87], a[96:99], v[24:27]
    ds_read_b128 v[80:83], v12 offset:14336
    s_add_u32 m0, s30, 40960
    s_add_u32 s33, s32, 237568
    buffer_load_dwordx4 v4, s[20:23], s33 offen sc1 lds
    v_exp_f32 v107, v107
    v_mfma_f32_16x16x32_bf16 v[28:31], v[84:87], a[100:103], v[28:31]
    v_mul_f32 v48, v48, v56
    v_mul_f32 v49, v49, v57
    s_waitcnt lgkmcnt(4)
    v_mfma_f32_16x16x32_bf16 v[16:19], v[88:91], a[104:107], v[16:19]
    ds_read_b128 v[84:87], v12 offset:15360
    v_mul_f32 v50, v50, v58
    v_mfma_f32_16x16x32_bf16 v[20:23], v[88:91], a[108:111], v[20:23]
    v_mul_f32 v51, v51, v59
    s_waitcnt lgkmcnt(4)
    v_mfma_f32_16x16x32_bf16 v[24:27], v[92:95], a[104:107], v[24:27]
    ds_read_b128 v[88:91], v12 offset:16384
    v_fma_f32 v104, v104, v2, v2
    v_mfma_f32_16x16x32_bf16 v[28:31], v[92:95], a[108:111], v[28:31]
    v_fma_f32 v105, v105, v2, v2
    s_waitcnt lgkmcnt(4)
    v_mfma_f32_16x16x32_bf16 v[16:19], v[96:99], a[112:115], v[16:19]
    ds_read_b128 v[92:95], v12 offset:17408
    v_fma_f32 v106, v106, v2, v2
    v_mfma_f32_16x16x32_bf16 v[20:23], v[96:99], a[116:119], v[20:23]
    v_fma_f32 v107, v107, v2, v2
    s_waitcnt lgkmcnt(4)
    v_mfma_f32_16x16x32_bf16 v[24:27], v[100:103], a[112:115], v[24:27]
    ds_read_b128 v[96:99], v12 offset:18432
    v_rcp_f32 v104, v104
    v_mfma_f32_16x16x32_bf16 v[28:31], v[100:103], a[116:119], v[28:31]
    v_rcp_f32 v105, v105
    v_rcp_f32 v106, v106
    s_waitcnt lgkmcnt(4)
    v_mfma_f32_16x16x32_bf16 v[16:19], v[80:83], a[120:123], v[16:19]
    ds_read_b128 v[100:103], v12 offset:19456
    v_rcp_f32 v107, v107
    v_mfma_f32_16x16x32_bf16 v[20:23], v[80:83], a[124:127], v[20:23]
    v_mul_f32 v48, v48, v104
    s_waitcnt lgkmcnt(4)
    v_mfma_f32_16x16x32_bf16 v[24:27], v[84:87], a[120:123], v[24:27]
    ds_read_b128 v[80:83], v12 offset:20480
    v_mul_f32 v49, v49, v105
    v_mfma_f32_16x16x32_bf16 v[28:31], v[84:87], a[124:127], v[28:31]
    v_mul_f32 v50, v50, v106
    s_waitcnt lgkmcnt(4)
    v_mfma_f32_16x16x32_bf16 v[16:19], v[88:91], v[112:115], v[16:19]
    ds_read_b128 v[84:87], v12 offset:21504
    v_mul_f32 v51, v51, v107
    v_mfma_f32_16x16x32_bf16 v[20:23], v[88:91], v[116:119], v[20:23]
    v_cvt_pk_bf16_f32 v108, v48, v49
    s_waitcnt lgkmcnt(4)
    v_mfma_f32_16x16x32_bf16 v[24:27], v[92:95], v[112:115], v[24:27]
    ds_read_b128 v[88:91], v12 offset:22528
    v_cvt_pk_bf16_f32 v109, v50, v51
    v_mfma_f32_16x16x32_bf16 v[28:31], v[92:95], v[116:119], v[28:31]
    v_mul_f32 v104, v52, v15
    v_mul_f32 v105, v53, v15
    s_waitcnt lgkmcnt(4)
    v_mfma_f32_16x16x32_bf16 v[16:19], v[96:99], v[120:123], v[16:19]
    ds_read_b128 v[92:95], v12 offset:23552
    v_mul_f32 v106, v54, v15
    v_mfma_f32_16x16x32_bf16 v[20:23], v[96:99], v[124:127], v[20:23]
    v_mul_f32 v107, v55, v15
    s_waitcnt lgkmcnt(4)
    v_mfma_f32_16x16x32_bf16 v[24:27], v[100:103], v[120:123], v[24:27]
    ds_read_b128 v[96:99], v12 offset:24576
    v_exp_f32 v104, v104
    v_mfma_f32_16x16x32_bf16 v[28:31], v[100:103], v[124:127], v[28:31]
    v_exp_f32 v105, v105
    s_waitcnt lgkmcnt(4)
    v_mfma_f32_16x16x32_bf16 v[32:35], v[80:83], a[0:3], 0
    ds_read_b128 v[100:103], v12 offset:25600
    v_exp_f32 v106, v106
    v_mfma_f32_16x16x32_bf16 v[36:39], v[80:83], a[4:7], 0
    v_exp_f32 v107, v107
    s_waitcnt lgkmcnt(4)
    v_mfma_f32_16x16x32_bf16 v[40:43], v[84:87], a[0:3], 0
    ds_read_b128 v[80:83], v12 offset:26624
    v_mul_f32 v52, v52, v60
    v_mfma_f32_16x16x32_bf16 v[44:47], v[84:87], a[4:7], 0
    v_mul_f32 v53, v53, v61
    v_mul_f32 v54, v54, v62
    s_waitcnt lgkmcnt(4)
    v_mfma_f32_16x16x32_bf16 v[32:35], v[88:91], a[8:11], v[32:35]
    ds_read_b128 v[84:87], v12 offset:27648
    v_mul_f32 v55, v55, v63
    v_mfma_f32_16x16x32_bf16 v[36:39], v[88:91], a[12:15], v[36:39]
    v_fma_f32 v104, v104, v3, v3
    s_waitcnt lgkmcnt(4)
    v_mfma_f32_16x16x32_bf16 v[40:43], v[92:95], a[8:11], v[40:43]
    ds_read_b128 v[88:91], v12 offset:28672
    v_fma_f32 v105, v105, v3, v3
    v_mfma_f32_16x16x32_bf16 v[44:47], v[92:95], a[12:15], v[44:47]
    v_fma_f32 v106, v106, v3, v3
    s_waitcnt lgkmcnt(4)
    v_mfma_f32_16x16x32_bf16 v[32:35], v[96:99], a[16:19], v[32:35]
    ds_read_b128 v[92:95], v12 offset:29696
    v_fma_f32 v107, v107, v3, v3
    v_mfma_f32_16x16x32_bf16 v[36:39], v[96:99], a[20:23], v[36:39]
    v_rcp_f32 v104, v104
    s_waitcnt lgkmcnt(4)
    v_mfma_f32_16x16x32_bf16 v[40:43], v[100:103], a[16:19], v[40:43]
    ds_read_b128 v[96:99], v12 offset:30720
    v_rcp_f32 v105, v105
    v_mfma_f32_16x16x32_bf16 v[44:47], v[100:103], a[20:23], v[44:47]
    v_rcp_f32 v106, v106
    v_rcp_f32 v107, v107
    s_waitcnt lgkmcnt(4)
    v_mfma_f32_16x16x32_bf16 v[32:35], v[80:83], a[24:27], v[32:35]
    ds_read_b128 v[100:103], v12 offset:31744
    v_mul_f32 v52, v52, v104
    v_mfma_f32_16x16x32_bf16 v[36:39], v[80:83], a[28:31], v[36:39]
    v_mul_f32 v53, v53, v105
    s_waitcnt lgkmcnt(4)
    v_mfma_f32_16x16x32_bf16 v[40:43], v[84:87], a[24:27], v[40:43]
    s_waitcnt vmcnt(0)
    s_barrier
    v_mov_b32 v5, 1
    buffer_atomic_add v5, v7, s[20:23], s41 offen offset:0 sc1
    ds_read_b128 v[80:83], v4 offset:0
    v_mul_f32 v54, v54, v106
    v_mfma_f32_16x16x32_bf16 v[44:47], v[84:87], a[28:31], v[44:47]
    v_mul_f32 v55, v55, v107
    s_waitcnt lgkmcnt(4)
    v_mfma_f32_16x16x32_bf16 v[32:35], v[88:91], a[32:35], v[32:35]
    ds_read_b128 v[84:87], v4 offset:1024
    s_add_u32 m0, s30, 49152
    s_add_u32 s33, s32, 245760
    buffer_load_dwordx4 v4, s[20:23], s33 offen sc1 lds
    v_mfma_f32_16x16x32_bf16 v[36:39], v[88:91], a[36:39], v[36:39]
    v_cvt_pk_bf16_f32 v8, v52, v53
    v_cvt_pk_bf16_f32 v9, v54, v55
    s_waitcnt lgkmcnt(4)
    v_mfma_f32_16x16x32_bf16 v[40:43], v[92:95], a[32:35], v[40:43]
    ds_read_b128 v[88:91], v4 offset:2048
    v_mul_f32 v104, v64, v14
    v_mfma_f32_16x16x32_bf16 v[44:47], v[92:95], a[36:39], v[44:47]
    v_mul_f32 v105, v65, v14
    v_mul_f32 v106, v66, v14
    s_waitcnt lgkmcnt(4)
    v_mfma_f32_16x16x32_bf16 v[32:35], v[96:99], a[40:43], v[32:35]
    ds_read_b128 v[92:95], v4 offset:3072
    s_add_u32 m0, s30, 57344
    s_add_u32 s33, s32, 253952
    buffer_load_dwordx4 v4, s[20:23], s33 offen sc1 lds
    v_mfma_f32_16x16x32_bf16 v[36:39], v[96:99], a[44:47], v[36:39]
    v_mul_f32 v107, v67, v14
    v_exp_f32 v104, v104
    s_waitcnt lgkmcnt(4)
    v_mfma_f32_16x16x32_bf16 v[40:43], v[100:103], a[40:43], v[40:43]
    ds_read_b128 v[96:99], v4 offset:4096
    v_exp_f32 v105, v105
    v_mfma_f32_16x16x32_bf16 v[44:47], v[100:103], a[44:47], v[44:47]
    v_exp_f32 v106, v106
    v_exp_f32 v107, v107
    s_waitcnt lgkmcnt(4)
    v_mfma_f32_16x16x32_bf16 v[32:35], v[80:83], a[48:51], v[32:35]
    ds_read_b128 v[100:103], v4 offset:5120
    v_mul_f32 v64, v64, v72
    v_mfma_f32_16x16x32_bf16 v[36:39], v[80:83], a[52:55], v[36:39]
    v_mul_f32 v65, v65, v73
    s_waitcnt lgkmcnt(4)
    v_mfma_f32_16x16x32_bf16 v[40:43], v[84:87], a[48:51], v[40:43]
    ds_read_b128 v[80:83], v4 offset:6144
    s_add_u32 m0, s30, 65536
    s_add_u32 s33, s32, 262144
    buffer_load_dwordx4 v4, s[20:23], s33 offen sc1 lds
    v_mfma_f32_16x16x32_bf16 v[44:47], v[84:87], a[52:55], v[44:47]
    v_mul_f32 v66, v66, v74
    v_mul_f32 v67, v67, v75
    s_waitcnt lgkmcnt(4)
    v_mfma_f32_16x16x32_bf16 v[32:35], v[88:91], a[56:59], v[32:35]
    ds_read_b128 v[84:87], v4 offset:7168
    s_add_u32 m0, s49, 0
    s_nop 0
    buffer_load_dwordx4 v13, s[20:23], s54 offen offset:0 sc1 lds
    v_fma_f32 v104, v104, v2, v2
    v_mfma_f32_16x16x32_bf16 v[36:39], v[88:91], a[60:63], v[36:39]
    v_fma_f32 v105, v105, v2, v2
    v_fma_f32 v106, v106, v2, v2
    s_waitcnt lgkmcnt(4)
    v_mfma_f32_16x16x32_bf16 v[40:43], v[92:95], a[56:59], v[40:43]
    ds_read_b128 v[88:91], v4 offset:8192
    v_fma_f32 v107, v107, v2, v2
    v_mfma_f32_16x16x32_bf16 v[44:47], v[92:95], a[60:63], v[44:47]
    v_rcp_f32 v104, v104
    s_waitcnt lgkmcnt(4)
    v_mfma_f32_16x16x32_bf16 v[32:35], v[96:99], a[64:67], v[32:35]
    ds_read_b128 v[92:95], v4 offset:9216
    v_rcp_f32 v105, v105
    v_mfma_f32_16x16x32_bf16 v[36:39], v[96:99], a[68:71], v[36:39]
    v_rcp_f32 v106, v106
    s_waitcnt lgkmcnt(4)
    v_mfma_f32_16x16x32_bf16 v[40:43], v[100:103], a[64:67], v[40:43]
    ds_read_b128 v[96:99], v4 offset:10240
    v_rcp_f32 v107, v107
    v_mfma_f32_16x16x32_bf16 v[44:47], v[100:103], a[68:71], v[44:47]
    v_mul_f32 v64, v64, v104
    v_mul_f32 v65, v65, v105
    s_waitcnt lgkmcnt(4)
    v_mfma_f32_16x16x32_bf16 v[32:35], v[80:83], a[72:75], v[32:35]
    ds_read_b128 v[100:103], v4 offset:11264
    v_mul_f32 v66, v66, v106
    v_mfma_f32_16x16x32_bf16 v[36:39], v[80:83], a[76:79], v[36:39]
    v_mul_f32 v67, v67, v107
    s_waitcnt lgkmcnt(4)
    v_mfma_f32_16x16x32_bf16 v[40:43], v[84:87], a[72:75], v[40:43]
    ds_read_b128 v[80:83], v4 offset:12288
    s_add_u32 m0, s49, 768
    s_nop 0
    buffer_load_dwordx4 v13, s[20:23], s54 offen offset:256 sc1 lds
    v_mfma_f32_16x16x32_bf16 v[44:47], v[84:87], a[76:79], v[44:47]
    v_cvt_pk_bf16_f32 v110, v64, v65
    v_cvt_pk_bf16_f32 v111, v66, v67
    s_waitcnt lgkmcnt(4)
    v_mfma_f32_16x16x32_bf16 v[32:35], v[88:91], a[80:83], v[32:35]
    ds_read_b128 v[84:87], v4 offset:13312
    s_add_u32 s33, s36, 131072
    buffer_store_dwordx4 v[108:111], v4, s[20:23], s33 offen offset:0 sc1
    v_mfma_f32_16x16x32_bf16 v[36:39], v[88:91], a[84:87], v[36:39]
    v_mul_f32 v104, v68, v15
    v_mul_f32 v105, v69, v15
    s_waitcnt lgkmcnt(4)
    v_mfma_f32_16x16x32_bf16 v[40:43], v[92:95], a[80:83], v[40:43]
    ds_read_b128 v[88:91], v4 offset:14336
    v_mul_f32 v106, v70, v15
    v_mfma_f32_16x16x32_bf16 v[44:47], v[92:95], a[84:87], v[44:47]
    v_mul_f32 v107, v71, v15
    s_waitcnt lgkmcnt(4)
    v_mfma_f32_16x16x32_bf16 v[32:35], v[96:99], a[88:91], v[32:35]
    ds_read_b128 v[92:95], v4 offset:15360
    v_exp_f32 v104, v104
    v_mfma_f32_16x16x32_bf16 v[36:39], v[96:99], a[92:95], v[36:39]
    v_exp_f32 v105, v105
    s_waitcnt lgkmcnt(4)
    v_mfma_f32_16x16x32_bf16 v[40:43], v[100:103], a[88:91], v[40:43]
    ds_read_b128 v[96:99], v4 offset:16384
    v_exp_f32 v106, v106
    v_mfma_f32_16x16x32_bf16 v[44:47], v[100:103], a[92:95], v[44:47]
    v_exp_f32 v107, v107
    v_mul_f32 v68, v68, v76
    s_waitcnt lgkmcnt(4)
    v_mfma_f32_16x16x32_bf16 v[32:35], v[80:83], a[96:99], v[32:35]
    ds_read_b128 v[100:103], v4 offset:17408
    s_add_u32 m0, s49, 1536
    s_nop 0
    buffer_load_dwordx4 v13, s[20:23], s54 offen offset:512 sc1 lds
    v_mfma_f32_16x16x32_bf16 v[36:39], v[80:83], a[100:103], v[36:39]
    v_mul_f32 v69, v69, v77
    v_mul_f32 v70, v70, v78
    s_waitcnt lgkmcnt(4)
    v_mfma_f32_16x16x32_bf16 v[40:43], v[84:87], a[96:99], v[40:43]
    ds_read_b128 v[80:83], v4 offset:18432
    v_mul_f32 v71, v71, v79
    v_mfma_f32_16x16x32_bf16 v[44:47], v[84:87], a[100:103], v[44:47]
    v_fma_f32 v104, v104, v3, v3
    s_waitcnt lgkmcnt(4)
    v_mfma_f32_16x16x32_bf16 v[32:35], v[88:91], a[104:107], v[32:35]
    ds_read_b128 v[84:87], v4 offset:19456
    v_fma_f32 v105, v105, v3, v3
    v_mfma_f32_16x16x32_bf16 v[36:39], v[88:91], a[108:111], v[36:39]
    v_fma_f32 v106, v106, v3, v3
    v_fma_f32 v107, v107, v3, v3
    s_waitcnt lgkmcnt(4)
    v_mfma_f32_16x16x32_bf16 v[40:43], v[92:95], a[104:107], v[40:43]
    ds_read_b128 v[88:91], v4 offset:20480
    v_rcp_f32 v104, v104
    v_mfma_f32_16x16x32_bf16 v[44:47], v[92:95], a[108:111], v[44:47]
    v_rcp_f32 v105, v105
    s_waitcnt lgkmcnt(4)
    v_mfma_f32_16x16x32_bf16 v[32:35], v[96:99], a[112:115], v[32:35]
    ds_read_b128 v[92:95], v4 offset:21504
    v_rcp_f32 v106, v106
    v_mfma_f32_16x16x32_bf16 v[36:39], v[96:99], a[116:119], v[36:39]
    v_rcp_f32 v107, v107
    s_waitcnt lgkmcnt(4)
    v_mfma_f32_16x16x32_bf16 v[40:43], v[100:103], a[112:115], v[40:43]
    ds_read_b128 v[96:99], v4 offset:22528
    s_add_u32 m0, s49, 2304
    s_nop 0
    buffer_load_dwordx4 v13, s[20:23], s54 offen offset:768 sc1 lds
    v_mul_f32 v68, v68, v104
    v_mfma_f32_16x16x32_bf16 v[44:47], v[100:103], a[116:119], v[44:47]
    v_mul_f32 v69, v69, v105
    v_mul_f32 v70, v70, v106
    s_waitcnt lgkmcnt(4)
    v_mfma_f32_16x16x32_bf16 v[32:35], v[80:83], a[120:123], v[32:35]
    ds_read_b128 v[100:103], v4 offset:23552
    v_mul_f32 v71, v71, v107
    v_mfma_f32_16x16x32_bf16 v[36:39], v[80:83], a[124:127], v[36:39]
    v_cvt_pk_bf16_f32 v10, v68, v69
    s_waitcnt lgkmcnt(4)
    v_mfma_f32_16x16x32_bf16 v[40:43], v[84:87], a[120:123], v[40:43]
    s_waitcnt vmcnt(7)
    s_barrier
    ds_read_b128 v[80:83], v4 offset:24576
    v_cvt_pk_bf16_f32 v11, v70, v71
    v_mfma_f32_16x16x32_bf16 v[44:47], v[84:87], a[124:127], v[44:47]
    s_add_u32 s33, s36, 131072
    buffer_store_dwordx4 v[8:11], v4, s[20:23], s33 offen offset:1024 sc1
    s_waitcnt lgkmcnt(4)
    v_mfma_f32_16x16x32_bf16 v[32:35], v[88:91], v[112:115], v[32:35]
    ds_read_b128 v[84:87], v4 offset:25600
    s_add_u32 m0, s30, 73728
    s_add_u32 s33, s32, 270336
    buffer_load_dwordx4 v4, s[20:23], s33 offen sc1 lds
    v_mul_f32 v104, v16, v14
    v_mfma_f32_16x16x32_bf16 v[36:39], v[88:91], v[116:119], v[36:39]
    v_mul_f32 v105, v17, v14
    v_mul_f32 v106, v18, v14
    s_waitcnt lgkmcnt(4)
    v_mfma_f32_16x16x32_bf16 v[40:43], v[92:95], v[112:115], v[40:43]
    ds_read_b128 v[88:91], v4 offset:26624
    v_mul_f32 v107, v19, v14
    v_mfma_f32_16x16x32_bf16 v[44:47], v[92:95], v[116:119], v[44:47]
    v_exp_f32 v104, v104
    s_waitcnt lgkmcnt(4)
    v_mfma_f32_16x16x32_bf16 v[32:35], v[96:99], v[120:123], v[32:35]
    ds_read_b128 v[92:95], v4 offset:27648
    s_add_u32 m0, s30, 81920
    s_add_u32 s33, s32, 278528
    buffer_load_dwordx4 v4, s[20:23], s33 offen sc1 lds
    v_exp_f32 v105, v105
    v_mfma_f32_16x16x32_bf16 v[36:39], v[96:99], v[124:127], v[36:39]
    v_exp_f32 v106, v106
    v_exp_f32 v107, v107
    s_waitcnt lgkmcnt(4)
    v_mfma_f32_16x16x32_bf16 v[40:43], v[100:103], v[120:123], v[40:43]
    ds_read_b128 v[96:99], v4 offset:28672
    v_mul_f32 v16, v16, v24
    v_mfma_f32_16x16x32_bf16 v[44:47], v[100:103], v[124:127], v[44:47]
    v_mul_f32 v17, v17, v25
    s_waitcnt lgkmcnt(4)
    v_mfma_f32_16x16x32_bf16 v[48:51], v[80:83], a[0:3], 0
    ds_read_b128 v[100:103], v4 offset:29696
    v_mul_f32 v18, v18, v26
    v_mfma_f32_16x16x32_bf16 v[52:55], v[80:83], a[4:7], 0
    v_mul_f32 v19, v19, v27
    s_waitcnt lgkmcnt(4)
    v_mfma_f32_16x16x32_bf16 v[56:59], v[84:87], a[0:3], 0
    ds_read_b128 v[80:83], v4 offset:30720
    s_add_u32 m0, s30, 90112
    s_add_u32 s33, s32, 286720
    buffer_load_dwordx4 v4, s[20:23], s33 offen sc1 lds
    v_fma_f32 v104, v104, v2, v2
    v_mfma_f32_16x16x32_bf16 v[60:63], v[84:87], a[4:7], 0
    v_fma_f32 v105, v105, v2, v2
    v_fma_f32 v106, v106, v2, v2
    s_waitcnt lgkmcnt(4)
    v_mfma_f32_16x16x32_bf16 v[48:51], v[88:91], a[8:11], v[48:51]
    ds_read_b128 v[84:87], v4 offset:31744
    v_fma_f32 v107, v107, v2, v2
    v_mfma_f32_16x16x32_bf16 v[52:55], v[88:91], a[12:15], v[52:55]
    v_rcp_f32 v104, v104
    s_waitcnt lgkmcnt(4)
    v_mfma_f32_16x16x32_bf16 v[56:59], v[92:95], a[8:11], v[56:59]
    ds_read_b128 v[88:91], v4 offset:32768
    v_rcp_f32 v105, v105
    v_mfma_f32_16x16x32_bf16 v[60:63], v[92:95], a[12:15], v[60:63]
    v_rcp_f32 v106, v106
    s_waitcnt lgkmcnt(4)
    v_mfma_f32_16x16x32_bf16 v[48:51], v[96:99], a[16:19], v[48:51]
    ds_read_b128 v[92:95], v4 offset:33792
    v_rcp_f32 v107, v107
    v_mfma_f32_16x16x32_bf16 v[52:55], v[96:99], a[20:23], v[52:55]
    v_mul_f32 v16, v16, v104
    v_mul_f32 v17, v17, v105
    s_waitcnt lgkmcnt(4)
    v_mfma_f32_16x16x32_bf16 v[56:59], v[100:103], a[16:19], v[56:59]
    ds_read_b128 v[96:99], v4 offset:34816
    v_mul_f32 v18, v18, v106
    v_mfma_f32_16x16x32_bf16 v[60:63], v[100:103], a[20:23], v[60:63]
    v_mul_f32 v19, v19, v107
    s_waitcnt lgkmcnt(4)
    v_mfma_f32_16x16x32_bf16 v[48:51], v[80:83], a[24:27], v[48:51]
    ds_read_b128 v[100:103], v4 offset:35840
    v_cvt_pk_bf16_f32 v108, v16, v17
    v_mfma_f32_16x16x32_bf16 v[52:55], v[80:83], a[28:31], v[52:55]
    v_cvt_pk_bf16_f32 v109, v18, v19
    s_waitcnt lgkmcnt(4)
    v_mfma_f32_16x16x32_bf16 v[56:59], v[84:87], a[24:27], v[56:59]
    ds_read_b128 v[80:83], v4 offset:36864
    v_mul_f32 v104, v20, v15
    v_mfma_f32_16x16x32_bf16 v[60:63], v[84:87], a[28:31], v[60:63]
    v_mul_f32 v105, v21, v15
    v_mul_f32 v106, v22, v15
    s_waitcnt lgkmcnt(4)
    v_mfma_f32_16x16x32_bf16 v[48:51], v[88:91], a[32:35], v[48:51]
    ds_read_b128 v[84:87], v4 offset:37888
    v_mul_f32 v107, v23, v15
    v_mfma_f32_16x16x32_bf16 v[52:55], v[88:91], a[36:39], v[52:55]
    v_exp_f32 v104, v104
    s_waitcnt lgkmcnt(4)
    v_mfma_f32_16x16x32_bf16 v[56:59], v[92:95], a[32:35], v[56:59]
    ds_read_b128 v[88:91], v4 offset:38912
    v_exp_f32 v105, v105
    v_mfma_f32_16x16x32_bf16 v[60:63], v[92:95], a[36:39], v[60:63]
    v_exp_f32 v106, v106
    v_exp_f32 v107, v107
    s_waitcnt lgkmcnt(4)
    v_mfma_f32_16x16x32_bf16 v[48:51], v[96:99], a[40:43], v[48:51]
    ds_read_b128 v[92:95], v4 offset:39936
    v_mul_f32 v20, v20, v28
    v_mfma_f32_16x16x32_bf16 v[52:55], v[96:99], a[44:47], v[52:55]
    v_mul_f32 v21, v21, v29
    s_waitcnt lgkmcnt(4)
    v_mfma_f32_16x16x32_bf16 v[56:59], v[100:103], a[40:43], v[56:59]
    ds_read_b128 v[96:99], v4 offset:40960
    v_mul_f32 v22, v22, v30
    v_mfma_f32_16x16x32_bf16 v[60:63], v[100:103], a[44:47], v[60:63]
    v_mul_f32 v23, v23, v31
    s_waitcnt lgkmcnt(4)
    v_mfma_f32_16x16x32_bf16 v[48:51], v[80:83], a[48:51], v[48:51]
    ds_read_b128 v[100:103], v4 offset:41984
    v_fma_f32 v104, v104, v3, v3
    v_mfma_f32_16x16x32_bf16 v[52:55], v[80:83], a[52:55], v[52:55]
    v_fma_f32 v105, v105, v3, v3
    v_fma_f32 v106, v106, v3, v3
    s_waitcnt lgkmcnt(4)
    v_mfma_f32_16x16x32_bf16 v[56:59], v[84:87], a[48:51], v[56:59]
    ds_read_b128 v[80:83], v4 offset:43008
    v_fma_f32 v107, v107, v3, v3
    v_mfma_f32_16x16x32_bf16 v[60:63], v[84:87], a[52:55], v[60:63]
    v_rcp_f32 v104, v104
    s_waitcnt lgkmcnt(4)
    v_mfma_f32_16x16x32_bf16 v[48:51], v[88:91], a[56:59], v[48:51]
    ds_read_b128 v[84:87], v4 offset:44032
    v_rcp_f32 v105, v105
    v_mfma_f32_16x16x32_bf16 v[52:55], v[88:91], a[60:63], v[52:55]
    v_rcp_f32 v106, v106
    s_waitcnt lgkmcnt(4)
    v_mfma_f32_16x16x32_bf16 v[56:59], v[92:95], a[56:59], v[56:59]
    ds_read_b128 v[88:91], v4 offset:45056
    v_rcp_f32 v107, v107
    v_mfma_f32_16x16x32_bf16 v[60:63], v[92:95], a[60:63], v[60:63]
    v_mul_f32 v20, v20, v104
    v_mul_f32 v21, v21, v105
    s_waitcnt lgkmcnt(4)
    v_mfma_f32_16x16x32_bf16 v[48:51], v[96:99], a[64:67], v[48:51]
    ds_read_b128 v[92:95], v4 offset:46080
    v_mul_f32 v22, v22, v106
    v_mfma_f32_16x16x32_bf16 v[52:55], v[96:99], a[68:71], v[52:55]
    v_mul_f32 v23, v23, v107
    s_waitcnt lgkmcnt(4)
    v_mfma_f32_16x16x32_bf16 v[56:59], v[100:103], a[64:67], v[56:59]
    ds_read_b128 v[96:99], v4 offset:47104
    v_cvt_pk_bf16_f32 v8, v20, v21
    v_mfma_f32_16x16x32_bf16 v[60:63], v[100:103], a[68:71], v[60:63]
    v_cvt_pk_bf16_f32 v9, v22, v23
    s_waitcnt lgkmcnt(4)
    v_mfma_f32_16x16x32_bf16 v[48:51], v[80:83], a[72:75], v[48:51]
    ds_read_b128 v[100:103], v4 offset:48128
    v_mul_f32 v104, v32, v14
    v_mfma_f32_16x16x32_bf16 v[52:55], v[80:83], a[76:79], v[52:55]
    v_mul_f32 v105, v33, v14
    v_mul_f32 v106, v34, v14
    s_waitcnt lgkmcnt(4)
    v_mfma_f32_16x16x32_bf16 v[56:59], v[84:87], a[72:75], v[56:59]
    s_waitcnt vmcnt(0)
    s_barrier
    v_mov_b32 v5, 1
    buffer_atomic_add v5, v7, s[20:23], s41 offen offset:768 sc1
    ds_read_b128 v[80:83], v4 offset:49152
    v_mul_f32 v107, v35, v14
    v_mfma_f32_16x16x32_bf16 v[60:63], v[84:87], a[76:79], v[60:63]
    v_exp_f32 v104, v104
    s_waitcnt lgkmcnt(4)
    v_mfma_f32_16x16x32_bf16 v[48:51], v[88:91], a[80:83], v[48:51]
    ds_read_b128 v[84:87], v4 offset:50176
    s_add_u32 m0, s30, 0
    s_add_u32 s33, s32, 294912
    buffer_load_dwordx4 v4, s[20:23], s33 offen sc1 lds
    v_exp_f32 v105, v105
    v_mfma_f32_16x16x32_bf16 v[52:55], v[88:91], a[84:87], v[52:55]
    v_exp_f32 v106, v106
    v_exp_f32 v107, v107
    s_waitcnt lgkmcnt(4)
    v_mfma_f32_16x16x32_bf16 v[56:59], v[92:95], a[80:83], v[56:59]
    ds_read_b128 v[88:91], v4 offset:51200
    v_mul_f32 v32, v32, v40
    v_mfma_f32_16x16x32_bf16 v[60:63], v[92:95], a[84:87], v[60:63]
    v_mul_f32 v33, v33, v41
    s_waitcnt lgkmcnt(4)
    v_mfma_f32_16x16x32_bf16 v[48:51], v[96:99], a[88:91], v[48:51]
    ds_read_b128 v[92:95], v4 offset:52224
    s_add_u32 m0, s30, 8192
    s_add_u32 s33, s32, 303104
    buffer_load_dwordx4 v4, s[20:23], s33 offen sc1 lds
    v_mul_f32 v34, v34, v42
    v_mfma_f32_16x16x32_bf16 v[52:55], v[96:99], a[92:95], v[52:55]
    v_mul_f32 v35, v35, v43
    v_fma_f32 v104, v104, v2, v2
    s_waitcnt lgkmcnt(4)
    v_mfma_f32_16x16x32_bf16 v[56:59], v[100:103], a[88:91], v[56:59]
    ds_read_b128 v[96:99], v4 offset:53248
    v_fma_f32 v105, v105, v2, v2
    v_mfma_f32_16x16x32_bf16 v[60:63], v[100:103], a[92:95], v[60:63]
    v_fma_f32 v106, v106, v2, v2
    s_waitcnt lgkmcnt(4)
    v_mfma_f32_16x16x32_bf16 v[48:51], v[80:83], a[96:99], v[48:51]
    ds_read_b128 v[100:103], v4 offset:54272
    v_fma_f32 v107, v107, v2, v2
    v_mfma_f32_16x16x32_bf16 v[52:55], v[80:83], a[100:103], v[52:55]
    v_rcp_f32 v104, v104
    v_rcp_f32 v105, v105
    s_waitcnt lgkmcnt(4)
    v_mfma_f32_16x16x32_bf16 v[56:59], v[84:87], a[96:99], v[56:59]
    ds_read_b128 v[80:83], v4 offset:55296
    s_add_u32 m0, s30, 16384
    s_add_u32 s33, s32, 311296
    buffer_load_dwordx4 v4, s[20:23], s33 offen sc1 lds
    v_mfma_f32_16x16x32_bf16 v[60:63], v[84:87], a[100:103], v[60:63]
    v_rcp_f32 v106, v106
    v_rcp_f32 v107, v107
    s_waitcnt lgkmcnt(4)
    v_mfma_f32_16x16x32_bf16 v[48:51], v[88:91], a[104:107], v[48:51]
    ds_read_b128 v[84:87], v4 offset:56320
    s_add_u32 m0, s49, 4096
    s_nop 0
    buffer_load_dwordx4 v13, s[20:23], s55 offen offset:0 sc1 lds
    v_mul_f32 v32, v32, v104
    v_mfma_f32_16x16x32_bf16 v[52:55], v[88:91], a[108:111], v[52:55]
    v_mul_f32 v33, v33, v105
    v_mul_f32 v34, v34, v106
    s_waitcnt lgkmcnt(4)
    v_mfma_f32_16x16x32_bf16 v[56:59], v[92:95], a[104:107], v[56:59]
    ds_read_b128 v[88:91], v4 offset:57344
    v_mul_f32 v35, v35, v107
    v_mfma_f32_16x16x32_bf16 v[60:63], v[92:95], a[108:111], v[60:63]
    v_cvt_pk_bf16_f32 v110, v32, v33
    s_waitcnt lgkmcnt(4)
    v_mfma_f32_16x16x32_bf16 v[48:51], v[96:99], a[112:115], v[48:51]
    ds_read_b128 v[92:95], v4 offset:58368
    v_cvt_pk_bf16_f32 v111, v34, v35
    v_mfma_f32_16x16x32_bf16 v[52:55], v[96:99], a[116:119], v[52:55]
    s_add_u32 s33, s36, 262144
    buffer_store_dwordx4 v[108:111], v4, s[20:23], s33 offen offset:0 sc1
    s_waitcnt lgkmcnt(4)
    v_mfma_f32_16x16x32_bf16 v[56:59], v[100:103], a[112:115], v[56:59]
    ds_read_b128 v[96:99], v4 offset:59392
    v_mul_f32 v104, v36, v15
    v_mfma_f32_16x16x32_bf16 v[60:63], v[100:103], a[116:119], v[60:63]
    v_mul_f32 v105, v37, v15
    v_mul_f32 v106, v38, v15
    s_waitcnt lgkmcnt(4)
    v_mfma_f32_16x16x32_bf16 v[48:51], v[80:83], a[120:123], v[48:51]
    ds_read_b128 v[100:103], v4 offset:60416
    v_mul_f32 v107, v39, v15
    v_mfma_f32_16x16x32_bf16 v[52:55], v[80:83], a[124:127], v[52:55]
    v_exp_f32 v104, v104
    s_waitcnt lgkmcnt(4)
    v_mfma_f32_16x16x32_bf16 v[56:59], v[84:87], a[120:123], v[56:59]
    ds_read_b128 v[80:83], v4 offset:61440
    v_exp_f32 v105, v105
    v_mfma_f32_16x16x32_bf16 v[60:63], v[84:87], a[124:127], v[60:63]
    v_exp_f32 v106, v106
    v_exp_f32 v107, v107
    s_waitcnt lgkmcnt(4)
    v_mfma_f32_16x16x32_bf16 v[48:51], v[88:91], v[112:115], v[48:51]
    ds_read_b128 v[84:87], v4 offset:62464
    s_add_u32 m0, s49, 4864
    s_nop 0
    buffer_load_dwordx4 v13, s[20:23], s55 offen offset:256 sc1 lds
    v_mfma_f32_16x16x32_bf16 v[52:55], v[88:91], v[116:119], v[52:55]
    v_mul_f32 v36, v36, v44
    v_mul_f32 v37, v37, v45
    s_waitcnt lgkmcnt(4)
    v_mfma_f32_16x16x32_bf16 v[56:59], v[92:95], v[112:115], v[56:59]
    ds_read_b128 v[88:91], v4 offset:63488
    v_mul_f32 v38, v38, v46
    v_mfma_f32_16x16x32_bf16 v[60:63], v[92:95], v[116:119], v[60:63]
    v_mul_f32 v39, v39, v47
    v_fma_f32 v104, v104, v3, v3
    s_waitcnt lgkmcnt(4)
    v_mfma_f32_16x16x32_bf16 v[48:51], v[96:99], v[120:123], v[48:51]
    ds_read_b128 v[92:95], v4 offset:64512
    v_fma_f32 v105, v105, v3, v3
    v_mfma_f32_16x16x32_bf16 v[52:55], v[96:99], v[124:127], v[52:55]
    v_fma_f32 v106, v106, v3, v3
    s_waitcnt lgkmcnt(4)
    v_mfma_f32_16x16x32_bf16 v[56:59], v[100:103], v[120:123], v[56:59]
    ds_read_b128 v[96:99], v12 offset:0
    v_fma_f32 v107, v107, v3, v3
    v_mfma_f32_16x16x32_bf16 v[60:63], v[100:103], v[124:127], v[60:63]
    v_rcp_f32 v104, v104
    v_rcp_f32 v105, v105
    s_waitcnt lgkmcnt(4)
    v_mfma_f32_16x16x32_bf16 v[64:67], v[80:83], a[0:3], 0
    ds_read_b128 v[100:103], v12 offset:1024
    v_rcp_f32 v106, v106
    v_mfma_f32_16x16x32_bf16 v[68:71], v[80:83], a[4:7], 0
    v_rcp_f32 v107, v107
    s_waitcnt lgkmcnt(4)
    v_mfma_f32_16x16x32_bf16 v[72:75], v[84:87], a[0:3], 0
    ds_read_b128 v[80:83], v12 offset:2048
    v_mul_f32 v36, v36, v104
    v_mfma_f32_16x16x32_bf16 v[76:79], v[84:87], a[4:7], 0
    v_mul_f32 v37, v37, v105
    v_mul_f32 v38, v38, v106
    s_waitcnt lgkmcnt(4)
    v_mfma_f32_16x16x32_bf16 v[64:67], v[88:91], a[8:11], v[64:67]
    ds_read_b128 v[84:87], v12 offset:3072
    s_add_u32 m0, s49, 5632
    s_nop 0
    buffer_load_dwordx4 v13, s[20:23], s55 offen offset:512 sc1 lds
    v_mfma_f32_16x16x32_bf16 v[68:71], v[88:91], a[12:15], v[68:71]
    v_mul_f32 v39, v39, v107
    v_cvt_pk_bf16_f32 v10, v36, v37
    s_waitcnt lgkmcnt(4)
    v_mfma_f32_16x16x32_bf16 v[72:75], v[92:95], a[8:11], v[72:75]
    ds_read_b128 v[88:91], v12 offset:4096
    v_cvt_pk_bf16_f32 v11, v38, v39
    v_mfma_f32_16x16x32_bf16 v[76:79], v[92:95], a[12:15], v[76:79]
    s_add_u32 s33, s36, 262144
    buffer_store_dwordx4 v[8:11], v4, s[20:23], s33 offen offset:1024 sc1
    s_waitcnt lgkmcnt(4)
    v_mfma_f32_16x16x32_bf16 v[64:67], v[96:99], a[16:19], v[64:67]
    ds_read_b128 v[92:95], v12 offset:5120
    v_mul_f32 v104, v48, v14
    v_mfma_f32_16x16x32_bf16 v[68:71], v[96:99], a[20:23], v[68:71]
    v_mul_f32 v105, v49, v14
    s_waitcnt lgkmcnt(4)
    v_mfma_f32_16x16x32_bf16 v[72:75], v[100:103], a[16:19], v[72:75]
    ds_read_b128 v[96:99], v12 offset:6144
    v_mul_f32 v106, v50, v14
    v_mfma_f32_16x16x32_bf16 v[76:79], v[100:103], a[20:23], v[76:79]
    v_mul_f32 v107, v51, v14
    s_waitcnt lgkmcnt(4)
    v_mfma_f32_16x16x32_bf16 v[64:67], v[80:83], a[24:27], v[64:67]
    ds_read_b128 v[100:103], v12 offset:7168
    v_exp_f32 v104, v104
    v_mfma_f32_16x16x32_bf16 v[68:71], v[80:83], a[28:31], v[68:71]
    v_exp_f32 v105, v105
    s_waitcnt lgkmcnt(4)
    v_mfma_f32_16x16x32_bf16 v[72:75], v[84:87], a[24:27], v[72:75]
    s_waitcnt vmcnt(6)
    s_barrier
    buffer_load_dword v6, v7, s[20:23], s44 offen offset:0 sc1
    ds_read_b128 v[80:83], v12 offset:8192
    v_exp_f32 v106, v106
    v_mfma_f32_16x16x32_bf16 v[76:79], v[84:87], a[28:31], v[76:79]
    v_exp_f32 v107, v107
    s_waitcnt lgkmcnt(4)
    v_mfma_f32_16x16x32_bf16 v[64:67], v[88:91], a[32:35], v[64:67]
    ds_read_b128 v[84:87], v12 offset:9216
    s_add_u32 m0, s30, 24576
    s_add_u32 s33, s32, 319488
    buffer_load_dwordx4 v4, s[20:23], s33 offen sc1 lds
    v_mfma_f32_16x16x32_bf16 v[68:71], v[88:91], a[36:39], v[68:71]
    v_mul_f32 v48, v48, v56
    v_mul_f32 v49, v49, v57
    s_waitcnt lgkmcnt(4)
    v_mfma_f32_16x16x32_bf16 v[72:75], v[92:95], a[32:35], v[72:75]
    ds_read_b128 v[88:91], v12 offset:10240
    v_mul_f32 v50, v50, v58
    v_mfma_f32_16x16x32_bf16 v[76:79], v[92:95], a[36:39], v[76:79]
    v_mul_f32 v51, v51, v59
    s_waitcnt lgkmcnt(4)
    v_mfma_f32_16x16x32_bf16 v[64:67], v[96:99], a[40:43], v[64:67]
    ds_read_b128 v[92:95], v12 offset:11264
    v_fma_f32 v104, v104, v2, v2
    v_mfma_f32_16x16x32_bf16 v[68:71], v[96:99], a[44:47], v[68:71]
    v_fma_f32 v105, v105, v2, v2
    s_waitcnt lgkmcnt(4)
    v_mfma_f32_16x16x32_bf16 v[72:75], v[100:103], a[40:43], v[72:75]
    ds_read_b128 v[96:99], v12 offset:12288
    s_add_u32 m0, s49, 6400
    s_nop 0
    buffer_load_dwordx4 v13, s[20:23], s55 offen offset:768 sc1 lds
    v_mfma_f32_16x16x32_bf16 v[76:79], v[100:103], a[44:47], v[76:79]
    v_fma_f32 v106, v106, v2, v2
    v_fma_f32 v107, v107, v2, v2
    s_waitcnt lgkmcnt(4)
    v_mfma_f32_16x16x32_bf16 v[64:67], v[80:83], a[48:51], v[64:67]
    ds_read_b128 v[100:103], v12 offset:13312
    s_add_u32 m0, s30, 32768
    s_add_u32 s33, s32, 327680
    s_cmp_lt_u32 s24, 4
    s_cselect_b32 s33, s33, 1073741824
    buffer_load_dwordx4 v4, s[20:23], s33 offen sc1 lds
    v_mfma_f32_16x16x32_bf16 v[68:71], v[80:83], a[52:55], v[68:71]
    v_rcp_f32 v104, v104
    v_rcp_f32 v105, v105
    s_waitcnt lgkmcnt(4)
    v_mfma_f32_16x16x32_bf16 v[72:75], v[84:87], a[48:51], v[72:75]
    ds_read_b128 v[80:83], v12 offset:14336
    v_rcp_f32 v106, v106
    v_mfma_f32_16x16x32_bf16 v[76:79], v[84:87], a[52:55], v[76:79]
    v_rcp_f32 v107, v107
    s_waitcnt lgkmcnt(4)
    v_mfma_f32_16x16x32_bf16 v[64:67], v[88:91], a[56:59], v[64:67]
    ds_read_b128 v[84:87], v12 offset:15360
    v_mul_f32 v48, v48, v104
    v_mfma_f32_16x16x32_bf16 v[68:71], v[88:91], a[60:63], v[68:71]
    v_mul_f32 v49, v49, v105
    s_waitcnt lgkmcnt(4)
    v_mfma_f32_16x16x32_bf16 v[72:75], v[92:95], a[56:59], v[72:75]
    ds_read_b128 v[88:91], v12 offset:16384
    v_mul_f32 v50, v50, v106
    v_mfma_f32_16x16x32_bf16 v[76:79], v[92:95], a[60:63], v[76:79]
    v_mul_f32 v51, v51, v107
    s_waitcnt lgkmcnt(4)
    v_mfma_f32_16x16x32_bf16 v[64:67], v[96:99], a[64:67], v[64:67]
    ds_read_b128 v[92:95], v12 offset:17408
    v_cvt_pk_bf16_f32 v108, v48, v49
    v_mfma_f32_16x16x32_bf16 v[68:71], v[96:99], a[68:71], v[68:71]
    v_cvt_pk_bf16_f32 v109, v50, v51
    s_waitcnt lgkmcnt(4)
    v_mfma_f32_16x16x32_bf16 v[72:75], v[100:103], a[64:67], v[72:75]
    ds_read_b128 v[96:99], v12 offset:18432
    v_mul_f32 v104, v52, v15
    v_mfma_f32_16x16x32_bf16 v[76:79], v[100:103], a[68:71], v[76:79]
    v_mul_f32 v105, v53, v15
    s_waitcnt lgkmcnt(4)
    v_mfma_f32_16x16x32_bf16 v[64:67], v[80:83], a[72:75], v[64:67]
    ds_read_b128 v[100:103], v12 offset:19456
    v_mul_f32 v106, v54, v15
    v_mfma_f32_16x16x32_bf16 v[68:71], v[80:83], a[76:79], v[68:71]
    v_mul_f32 v107, v55, v15
    s_waitcnt lgkmcnt(4)
    v_mfma_f32_16x16x32_bf16 v[72:75], v[84:87], a[72:75], v[72:75]
    ds_read_b128 v[80:83], v12 offset:20480
    v_exp_f32 v104, v104
    v_mfma_f32_16x16x32_bf16 v[76:79], v[84:87], a[76:79], v[76:79]
    v_exp_f32 v105, v105
    s_waitcnt lgkmcnt(4)
    v_mfma_f32_16x16x32_bf16 v[64:67], v[88:91], a[80:83], v[64:67]
    ds_read_b128 v[84:87], v12 offset:21504
    v_exp_f32 v106, v106
    v_mfma_f32_16x16x32_bf16 v[68:71], v[88:91], a[84:87], v[68:71]
    v_exp_f32 v107, v107
    s_waitcnt lgkmcnt(4)
    v_mfma_f32_16x16x32_bf16 v[72:75], v[92:95], a[80:83], v[72:75]
    ds_read_b128 v[88:91], v12 offset:22528
    v_mul_f32 v52, v52, v60
    v_mfma_f32_16x16x32_bf16 v[76:79], v[92:95], a[84:87], v[76:79]
    v_mul_f32 v53, v53, v61
    s_waitcnt lgkmcnt(4)
    v_mfma_f32_16x16x32_bf16 v[64:67], v[96:99], a[88:91], v[64:67]
    ds_read_b128 v[92:95], v12 offset:23552
    v_mul_f32 v54, v54, v62
    v_mfma_f32_16x16x32_bf16 v[68:71], v[96:99], a[92:95], v[68:71]
    v_mul_f32 v55, v55, v63
    s_waitcnt lgkmcnt(4)
    v_mfma_f32_16x16x32_bf16 v[72:75], v[100:103], a[88:91], v[72:75]
    ds_read_b128 v[96:99], v12 offset:24576
    v_fma_f32 v104, v104, v3, v3
    v_mfma_f32_16x16x32_bf16 v[76:79], v[100:103], a[92:95], v[76:79]
    v_fma_f32 v105, v105, v3, v3
    s_waitcnt lgkmcnt(4)
    v_mfma_f32_16x16x32_bf16 v[64:67], v[80:83], a[96:99], v[64:67]
    ds_read_b128 v[100:103], v12 offset:25600
    v_fma_f32 v106, v106, v3, v3
    v_mfma_f32_16x16x32_bf16 v[68:71], v[80:83], a[100:103], v[68:71]
    v_fma_f32 v107, v107, v3, v3
    s_waitcnt lgkmcnt(4)
    v_mfma_f32_16x16x32_bf16 v[72:75], v[84:87], a[96:99], v[72:75]
    ds_read_b128 v[80:83], v12 offset:26624
    v_rcp_f32 v104, v104
    v_mfma_f32_16x16x32_bf16 v[76:79], v[84:87], a[100:103], v[76:79]
    v_rcp_f32 v105, v105
    s_waitcnt lgkmcnt(4)
    v_mfma_f32_16x16x32_bf16 v[64:67], v[88:91], a[104:107], v[64:67]
    ds_read_b128 v[84:87], v12 offset:27648
    v_rcp_f32 v106, v106
    v_mfma_f32_16x16x32_bf16 v[68:71], v[88:91], a[108:111], v[68:71]
    v_rcp_f32 v107, v107
    s_waitcnt lgkmcnt(4)
    v_mfma_f32_16x16x32_bf16 v[72:75], v[92:95], a[104:107], v[72:75]
    ds_read_b128 v[88:91], v12 offset:28672
    v_mul_f32 v52, v52, v104
    v_mfma_f32_16x16x32_bf16 v[76:79], v[92:95], a[108:111], v[76:79]
    v_mul_f32 v53, v53, v105
    s_waitcnt lgkmcnt(4)
    v_mfma_f32_16x16x32_bf16 v[64:67], v[96:99], a[112:115], v[64:67]
    ds_read_b128 v[92:95], v12 offset:29696
    v_mul_f32 v54, v54, v106
    v_mfma_f32_16x16x32_bf16 v[68:71], v[96:99], a[116:119], v[68:71]
    v_mul_f32 v55, v55, v107
    s_waitcnt lgkmcnt(4)
    v_mfma_f32_16x16x32_bf16 v[72:75], v[100:103], a[112:115], v[72:75]
    ds_read_b128 v[96:99], v12 offset:30720
    v_cvt_pk_bf16_f32 v8, v52, v53
    v_mfma_f32_16x16x32_bf16 v[76:79], v[100:103], a[116:119], v[76:79]
    v_cvt_pk_bf16_f32 v9, v54, v55
    s_waitcnt lgkmcnt(4)
    v_mfma_f32_16x16x32_bf16 v[64:67], v[80:83], a[120:123], v[64:67]
    ds_read_b128 v[100:103], v12 offset:31744
    v_mfma_f32_16x16x32_bf16 v[68:71], v[80:83], a[124:127], v[68:71]
    s_waitcnt lgkmcnt(4)
    v_mfma_f32_16x16x32_bf16 v[72:75], v[84:87], a[120:123], v[72:75]
    s_cmp_lg_u32 s24, 0
    s_cbranch_scc1 Lsequ_67
    s_waitcnt vmcnt(3)
    v_readfirstlane_b32 s50, v6
    s_mov_b32 s51, 0
    s_nop 0
    s_cmp_ge_u32 s50, 32
    s_cbranch_scc1 Lsequ_67
Lsequ_66:
    s_sleep 4
    buffer_load_dword v6, v7, s[20:23], s44 offen offset:0 sc1
    s_waitcnt vmcnt(0)
    v_readfirstlane_b32 s50, v6
    s_add_u32 s51, s51, 1
    s_cmp_ge_u32 s51, 200000
    s_cbranch_scc1 Lsequ_67
    s_cmp_lt_u32 s50, 32
    s_cbranch_scc1 Lsequ_66
Lsequ_67:
    s_waitcnt vmcnt(0)
    s_barrier
    v_mov_b32 v5, 1
    buffer_atomic_add v5, v7, s[20:23], s41 offen offset:256 sc1
    ds_read_b128 v[80:83], v4 offset:0
    v_mfma_f32_16x16x32_bf16 v[76:79], v[84:87], a[124:127], v[76:79]
    s_waitcnt lgkmcnt(4)
    v_mfma_f32_16x16x32_bf16 v[64:67], v[88:91], v[112:115], v[64:67]
    ds_read_b128 v[84:87], v4 offset:1024
    s_mul_i32 s48, s24, 3072
    v_bfe_u32 v12, v1, 3, 1
    v_mfma_f32_16x16x32_bf16 v[68:71], v[88:91], v[116:119], v[68:71]
    v_mul_u32_u24 v12, 4480, v12
    v_add_u32 v12, v13, v12
    s_waitcnt lgkmcnt(4)
    v_mfma_f32_16x16x32_bf16 v[72:75], v[92:95], v[112:115], v[72:75]
    ds_read_b128 v[88:91], v4 offset:2048
    v_mfma_f32_16x16x32_bf16 v[76:79], v[92:95], v[116:119], v[76:79]
    buffer_load_dwordx4 v[32:35], v4, s[20:23], s60 offen offset:0 sc1
    s_waitcnt lgkmcnt(4)
    v_mfma_f32_16x16x32_bf16 v[64:67], v[96:99], v[120:123], v[64:67]
    ds_read_b128 v[92:95], v4 offset:3072
    v_mfma_f32_16x16x32_bf16 v[68:71], v[96:99], v[124:127], v[68:71]
    s_waitcnt lgkmcnt(4)
    v_mfma_f32_16x16x32_bf16 v[72:75], v[100:103], v[120:123], v[72:75]
    ds_read_b128 v[96:99], v4 offset:4096
    v_mfma_f32_16x16x32_bf16 v[76:79], v[100:103], v[124:127], v[76:79]
    buffer_load_dwordx4 v[36:39], v4, s[20:23], s60 offen offset:1024 sc1
    s_waitcnt lgkmcnt(4)
    v_mfma_f32_16x16x32_bf16 v[16:19], v[80:83], a[0:3], 0
    ds_read_b128 v[100:103], v4 offset:5120
    v_mfma_f32_16x16x32_bf16 v[20:23], v[80:83], a[4:7], 0
    s_waitcnt lgkmcnt(4)
    v_mfma_f32_16x16x32_bf16 v[24:27], v[84:87], a[0:3], 0
    ds_read_b128 v[80:83], v4 offset:6144
    v_mfma_f32_16x16x32_bf16 v[28:31], v[84:87], a[4:7], 0
    buffer_load_dwordx4 v[40:43], v4, s[20:23], s60 offen offset:2048 sc1
    s_waitcnt lgkmcnt(4)
    v_mfma_f32_16x16x32_bf16 v[16:19], v[88:91], a[8:11], v[16:19]
    ds_read_b128 v[84:87], v4 offset:7168
    v_mfma_f32_16x16x32_bf16 v[20:23], v[88:91], a[12:15], v[20:23]
    s_waitcnt lgkmcnt(4)
    v_mfma_f32_16x16x32_bf16 v[24:27], v[92:95], a[8:11], v[24:27]
    ds_read_b128 v[88:91], v4 offset:8192
    v_mul_f32 v104, v64, v14
    v_mfma_f32_16x16x32_bf16 v[28:31], v[92:95], a[12:15], v[28:31]
    v_mul_f32 v105, v65, v14
    s_waitcnt lgkmcnt(4)
    v_mfma_f32_16x16x32_bf16 v[16:19], v[96:99], a[16:19], v[16:19]
    ds_read_b128 v[92:95], v4 offset:9216
    buffer_load_dwordx4 v[44:47], v4, s[20:23], s60 offen offset:3072 sc1
    s_add_u32 s60, s60, 65536
    v_mfma_f32_16x16x32_bf16 v[20:23], v[96:99], a[20:23], v[20:23]
    v_mul_f32 v106, v66, v14
    v_mul_f32 v107, v67, v14
    s_waitcnt lgkmcnt(4)
    v_mfma_f32_16x16x32_bf16 v[24:27], v[100:103], a[16:19], v[24:27]
    ds_read_b128 v[96:99], v4 offset:10240
    v_exp_f32 v104, v104
    v_mfma_f32_16x16x32_bf16 v[28:31], v[100:103], a[20:23], v[28:31]
    v_exp_f32 v105, v105
    s_waitcnt lgkmcnt(4)
    v_mfma_f32_16x16x32_bf16 v[16:19], v[80:83], a[24:27], v[16:19]
    ds_read_b128 v[100:103], v4 offset:11264
    s_add_u32 m0, s48, 49152
    s_add_u32 s33, s54, 73728
    buffer_load_dwordx4 v13, s[20:23], s33 offen offset:0 sc1 lds
    v_mfma_f32_16x16x32_bf16 v[20:23], v[80:83], a[28:31], v[20:23]
    v_exp_f32 v106, v106
    v_exp_f32 v107, v107
    s_waitcnt lgkmcnt(4)
    v_mfma_f32_16x16x32_bf16 v[24:27], v[84:87], a[24:27], v[24:27]
    ds_read_b128 v[80:83], v4 offset:12288
    v_mul_f32 v64, v64, v72
    v_mfma_f32_16x16x32_bf16 v[28:31], v[84:87], a[28:31], v[28:31]
    v_mul_f32 v65, v65, v73
    s_waitcnt lgkmcnt(4)
    v_mfma_f32_16x16x32_bf16 v[16:19], v[88:91], a[32:35], v[16:19]
    ds_read_b128 v[84:87], v4 offset:13312
    v_mul_f32 v66, v66, v74
    v_mfma_f32_16x16x32_bf16 v[20:23], v[88:91], a[36:39], v[20:23]
    v_mul_f32 v67, v67, v75
    s_waitcnt lgkmcnt(4)
    v_mfma_f32_16x16x32_bf16 v[24:27], v[92:95], a[32:35], v[24:27]
    ds_read_b128 v[88:91], v4 offset:14336
    s_add_u32 m0, s48, 49920
    s_add_u32 s33, s54, 73728
    buffer_load_dwordx4 v13, s[20:23], s33 offen offset:256 sc1 lds
    v_mfma_f32_16x16x32_bf16 v[28:31], v[92:95], a[36:39], v[28:31]
    v_fma_f32 v104, v104, v2, v2
    v_fma_f32 v105, v105, v2, v2
    s_waitcnt lgkmcnt(4)
    v_mfma_f32_16x16x32_bf16 v[16:19], v[96:99], a[40:43], v[16:19]
    ds_read_b128 v[92:95], v4 offset:15360
    v_fma_f32 v106, v106, v2, v2
    v_mfma_f32_16x16x32_bf16 v[20:23], v[96:99], a[44:47], v[20:23]
    v_fma_f32 v107, v107, v2, v2
    s_waitcnt lgkmcnt(4)
    v_mfma_f32_16x16x32_bf16 v[24:27], v[100:103], a[40:43], v[24:27]
    ds_read_b128 v[96:99], v4 offset:16384
    s_add_u32 m0, s48, 50688
    s_add_u32 s33, s54, 73728
    buffer_load_dwordx4 v13, s[20:23], s33 offen offset:512 sc1 lds
    v_mfma_f32_16x16x32_bf16 v[28:31], v[100:103], a[44:47], v[28:31]
    v_rcp_f32 v104, v104
    v_rcp_f32 v105, v105
    s_waitcnt lgkmcnt(4)
    v_mfma_f32_16x16x32_bf16 v[16:19], v[80:83], a[48:51], v[16:19]
    ds_read_b128 v[100:103], v4 offset:17408
    v_rcp_f32 v106, v106
    v_mfma_f32_16x16x32_bf16 v[20:23], v[80:83], a[52:55], v[20:23]
    v_rcp_f32 v107, v107
    s_waitcnt lgkmcnt(4)
    v_mfma_f32_16x16x32_bf16 v[24:27], v[84:87], a[48:51], v[24:27]
    ds_read_b128 v[80:83], v4 offset:18432
    v_mul_f32 v64, v64, v104
    v_mfma_f32_16x16x32_bf16 v[28:31], v[84:87], a[52:55], v[28:31]
    v_mul_f32 v65, v65, v105
    s_waitcnt lgkmcnt(4)
    v_mfma_f32_16x16x32_bf16 v[16:19], v[88:91], a[56:59], v[16:19]
    ds_read_b128 v[84:87], v4 offset:19456
    buffer_load_dwordx4 v[48:51], v4, s[20:23], s61 offen offset:0 sc1
    v_mfma_f32_16x16x32_bf16 v[20:23], v[88:91], a[60:63], v[20:23]
    v_mul_f32 v66, v66, v106
    v_mul_f32 v67, v67, v107
    s_waitcnt lgkmcnt(4)
    v_mfma_f32_16x16x32_bf16 v[24:27], v[92:95], a[56:59], v[24:27]
    ds_read_b128 v[88:91], v4 offset:20480
    v_cvt_pk_bf16_f32 v110, v64, v65
    v_mfma_f32_16x16x32_bf16 v[28:31], v[92:95], a[60:63], v[28:31]
    v_cvt_pk_bf16_f32 v111, v66, v67
    s_waitcnt lgkmcnt(4)
    v_mfma_f32_16x16x32_bf16 v[16:19], v[96:99], a[64:67], v[16:19]
    ds_read_b128 v[92:95], v4 offset:21504
    buffer_load_dwordx4 v[52:55], v4, s[20:23], s61 offen offset:1024 sc1
    v_mfma_f32_16x16x32_bf16 v[20:23], v[96:99], a[68:71], v[20:23]
    s_add_u32 s33, s36, 393216
    buffer_store_dwordx4 v[108:111], v4, s[20:23], s33 offen offset:0 sc1
    v_mul_f32 v104, v68, v15
    s_waitcnt lgkmcnt(4)
    v_mfma_f32_16x16x32_bf16 v[24:27], v[100:103], a[64:67], v[24:27]
    ds_read_b128 v[96:99], v4 offset:22528
    v_mul_f32 v105, v69, v15
    v_mfma_f32_16x16x32_bf16 v[28:31], v[100:103], a[68:71], v[28:31]
    v_mul_f32 v106, v70, v15
    s_waitcnt lgkmcnt(4)
    v_mfma_f32_16x16x32_bf16 v[16:19], v[80:83], a[72:75], v[16:19]
    ds_read_b128 v[100:103], v4 offset:23552
    v_mul_f32 v107, v71, v15
    v_mfma_f32_16x16x32_bf16 v[20:23], v[80:83], a[76:79], v[20:23]
    v_exp_f32 v104, v104
    s_waitcnt lgkmcnt(4)
    v_mfma_f32_16x16x32_bf16 v[24:27], v[84:87], a[72:75], v[24:27]
    s_barrier
    buffer_load_dword v6, v7, s[20:23], s44 offen offset:768 sc1
    ds_read_b128 v[80:83], v4 offset:24576
    v_exp_f32 v105, v105
    v_mfma_f32_16x16x32_bf16 v[28:31], v[84:87], a[76:79], v[28:31]
    v_exp_f32 v106, v106
    s_waitcnt lgkmcnt(4)
    v_mfma_f32_16x16x32_bf16 v[16:19], v[88:91], a[80:83], v[16:19]
    ds_read_b128 v[84:87], v4 offset:25600
    buffer_load_dwordx4 v[56:59], v4, s[20:23], s61 offen offset:2048 sc1
    v_mfma_f32_16x16x32_bf16 v[20:23], v[88:91], a[84:87], v[20:23]
    v_exp_f32 v107, v107
    v_mul_f32 v68, v68, v76
    s_waitcnt lgkmcnt(4)
    v_mfma_f32_16x16x32_bf16 v[24:27], v[92:95], a[80:83], v[24:27]
    ds_read_b128 v[88:91], v4 offset:26624
    v_mul_f32 v69, v69, v77
    v_mfma_f32_16x16x32_bf16 v[28:31], v[92:95], a[84:87], v[28:31]
    v_mul_f32 v70, v70, v78
    s_waitcnt lgkmcnt(4)
    v_mfma_f32_16x16x32_bf16 v[16:19], v[96:99], a[88:91], v[16:19]
    ds_read_b128 v[92:95], v4 offset:27648
    buffer_load_dwordx4 v[60:63], v4, s[20:23], s61 offen offset:3072 sc1
    s_add_u32 s61, s61, 65536
    v_mfma_f32_16x16x32_bf16 v[20:23], v[96:99], a[92:95], v[20:23]
    v_mul_f32 v71, v71, v79
    v_fma_f32 v104, v104, v3, v3
    s_waitcnt lgkmcnt(4)
    v_mfma_f32_16x16x32_bf16 v[24:27], v[100:103], a[88:91], v[24:27]
    ds_read_b128 v[96:99], v4 offset:28672
    v_fma_f32 v105, v105, v3, v3
    v_mfma_f32_16x16x32_bf16 v[28:31], v[100:103], a[92:95], v[28:31]
    v_fma_f32 v106, v106, v3, v3
    s_waitcnt lgkmcnt(4)
    v_mfma_f32_16x16x32_bf16 v[16:19], v[80:83], a[96:99], v[16:19]
    ds_read_b128 v[100:103], v4 offset:29696
    v_fma_f32 v107, v107, v3, v3
    v_mfma_f32_16x16x32_bf16 v[20:23], v[80:83], a[100:103], v[20:23]
    v_rcp_f32 v104, v104
    s_waitcnt lgkmcnt(4)
    v_mfma_f32_16x16x32_bf16 v[24:27], v[84:87], a[96:99], v[24:27]
    ds_read_b128 v[80:83], v4 offset:30720
    s_add_u32 m0, s48, 72960
    s_add_u32 s33, s54, 73728
    buffer_load_dwordx4 v13, s[20:23], s33 offen offset:768 sc1 lds
    v_mfma_f32_16x16x32_bf16 v[28:31], v[84:87], a[100:103], v[28:31]
    v_rcp_f32 v105, v105
    v_rcp_f32 v106, v106
    s_waitcnt lgkmcnt(4)
    v_mfma_f32_16x16x32_bf16 v[16:19], v[88:91], a[104:107], v[16:19]
    ds_read_b128 v[84:87], v4 offset:31744
    v_rcp_f32 v107, v107
    v_mfma_f32_16x16x32_bf16 v[20:23], v[88:91], a[108:111], v[20:23]
    v_mul_f32 v68, v68, v104
    s_waitcnt lgkmcnt(4)
    v_mfma_f32_16x16x32_bf16 v[24:27], v[92:95], a[104:107], v[24:27]
    ds_read_b128 v[88:91], v4 offset:32768
    s_add_u32 m0, s48, 73728
    s_add_u32 s33, s54, 0
    buffer_load_dwordx4 v12, s[20:23], s33 offen offset:1024 sc1 lds
    v_mfma_f32_16x16x32_bf16 v[28:31], v[92:95], a[108:111], v[28:31]
    v_mul_f32 v69, v69, v105
    v_mul_f32 v70, v70, v106
    s_waitcnt lgkmcnt(4)
    v_mfma_f32_16x16x32_bf16 v[16:19], v[96:99], a[112:115], v[16:19]
    ds_read_b128 v[92:95], v4 offset:33792
    v_mul_f32 v71, v71, v107
    v_mfma_f32_16x16x32_bf16 v[20:23], v[96:99], a[116:119], v[20:23]
    v_cvt_pk_bf16_f32 v10, v68, v69
    s_waitcnt lgkmcnt(4)
    v_mfma_f32_16x16x32_bf16 v[24:27], v[100:103], a[112:115], v[24:27]
    ds_read_b128 v[96:99], v4 offset:34816
    v_cvt_pk_bf16_f32 v11, v70, v71
    v_mfma_f32_16x16x32_bf16 v[28:31], v[100:103], a[116:119], v[28:31]
    s_add_u32 s33, s36, 393216
    buffer_store_dwordx4 v[8:11], v4, s[20:23], s33 offen offset:1024 sc1
    s_waitcnt lgkmcnt(4)
    v_mfma_f32_16x16x32_bf16 v[16:19], v[80:83], a[120:123], v[16:19]
    ds_read_b128 v[100:103], v4 offset:35840
    v_mfma_f32_16x16x32_bf16 v[20:23], v[80:83], a[124:127], v[20:23]
    s_add_u32 m0, s48, 74752
    s_add_u32 s33, s54, 73728
    buffer_load_dwordx4 v12, s[20:23], s33 offen offset:1024 sc1 lds
    s_waitcnt lgkmcnt(4)
    v_mfma_f32_16x16x32_bf16 v[24:27], v[84:87], a[120:123], v[24:27]
    v_mfma_f32_16x16x32_bf16 v[28:31], v[84:87], a[124:127], v[28:31]
    s_waitcnt lgkmcnt(3)
    v_mfma_f32_16x16x32_bf16 v[16:19], v[88:91], v[112:115], v[16:19]
    v_mfma_f32_16x16x32_bf16 v[20:23], v[88:91], v[116:119], v[20:23]
    s_waitcnt lgkmcnt(2)
    v_mfma_f32_16x16x32_bf16 v[24:27], v[92:95], v[112:115], v[24:27]
    v_mfma_f32_16x16x32_bf16 v[28:31], v[92:95], v[116:119], v[28:31]
    s_waitcnt lgkmcnt(1)
    v_mfma_f32_16x16x32_bf16 v[16:19], v[96:99], v[120:123], v[16:19]
    v_mfma_f32_16x16x32_bf16 v[20:23], v[96:99], v[124:127], v[20:23]
    s_waitcnt lgkmcnt(0)
    v_mfma_f32_16x16x32_bf16 v[24:27], v[100:103], v[120:123], v[24:27]
    v_mfma_f32_16x16x32_bf16 v[28:31], v[100:103], v[124:127], v[28:31]
    v_bfe_u32 v12, v1, 3, 1
    v_mul_u32_u24 v12, 4480, v12
    v_add_u32 v12, v13, v12
    v_add_u32 v104, s49, v4
    s_waitcnt vmcnt(16)
    ds_read_b128 v[64:67], v104 offset:0
    ds_read_b128 v[68:71], v104 offset:1024
    ds_read_b128 v[72:75], v104 offset:2048
    ds_read_b128 v[76:79], v104 offset:3072
    ds_read_b128 v[80:83], v104 offset:4096
    ds_read_b128 v[84:87], v104 offset:5120
    ds_read_b128 v[88:91], v104 offset:6144
    ds_read_b128 v[92:95], v104 offset:7168
    s_add_u32 s54, s54, 73728
    v_mul_f32 v104, v16, v14
    v_mul_f32 v105, v17, v14
    v_mul_f32 v106, v18, v14
    v_mul_f32 v107, v19, v14
    v_exp_f32 v104, v104
    v_exp_f32 v105, v105
    v_exp_f32 v106, v106
    v_exp_f32 v107, v107
    s_add_u32 s55, s55, 73728
    v_mul_f32 v16, v16, v24
    v_mul_f32 v17, v17, v25
    v_mul_f32 v18, v18, v26
    v_mul_f32 v19, v19, v27
    v_fma_f32 v104, v104, v2, v2
    v_fma_f32 v105, v105, v2, v2
    v_fma_f32 v106, v106, v2, v2
    v_fma_f32 v107, v107, v2, v2
    buffer_load_dwordx4 v[96:99], v4, s[20:23], s60 offen offset:0 sc1
    v_rcp_f32 v104, v104
    v_rcp_f32 v105, v105
    v_rcp_f32 v106, v106
    v_rcp_f32 v107, v107
    v_mul_f32 v16, v16, v104
    v_mul_f32 v17, v17, v105
    v_mul_f32 v18, v18, v106
    v_mul_f32 v19, v19, v107
    buffer_load_dwordx4 v[100:103], v4, s[20:23], s60 offen offset:1024 sc1
    v_cvt_pk_bf16_f32 v108, v16, v17
    v_cvt_pk_bf16_f32 v109, v18, v19
    v_mul_f32 v104, v20, v15
    v_mul_f32 v105, v21, v15
    v_mul_f32 v106, v22, v15
    v_mul_f32 v107, v23, v15
    v_exp_f32 v104, v104
    v_exp_f32 v105, v105
    buffer_load_dwordx4 v[112:115], v4, s[20:23], s60 offen offset:2048 sc1
    v_exp_f32 v106, v106
    v_exp_f32 v107, v107
    v_mul_f32 v20, v20, v28
    v_mul_f32 v21, v21, v29
    v_mul_f32 v22, v22, v30
    v_mul_f32 v23, v23, v31
    v_fma_f32 v104, v104, v3, v3
    v_fma_f32 v105, v105, v3, v3
    buffer_load_dwordx4 v[116:119], v4, s[20:23], s60 offen offset:3072 sc1
    s_add_u32 s60, s60, 65536
    v_fma_f32 v106, v106, v3, v3
    v_fma_f32 v107, v107, v3, v3
    v_rcp_f32 v104, v104
    v_rcp_f32 v105, v105
    v_rcp_f32 v106, v106
    v_rcp_f32 v107, v107
    v_mul_f32 v20, v20, v104
    v_mul_f32 v21, v21, v105
    s_add_u32 s54, s54, 73728
    v_mul_f32 v22, v22, v106
    v_mul_f32 v23, v23, v107
    v_cvt_pk_bf16_f32 v110, v20, v21
    v_cvt_pk_bf16_f32 v111, v22, v23
    v_bfe_u32 v8, v1, 4, 1
    v_lshrrev_b32 v9, 5, v1
    v_lshlrev_b32 v8, 10, v8
    v_lshl_add_u32 v8, v9, 8, v8
    v_and_b32 v9, 15, v1
    v_lshl_add_u32 v8, v9, 4, v8
    v_permlane16_swap_b32 v108, v110
    v_permlane16_swap_b32 v109, v111
    buffer_store_dwordx4 v[108:111], v8, s[20:23], s39 offen sc1
    v_accvgpr_write_b32 a0, 0
    v_accvgpr_write_b32 a1, 0
    v_accvgpr_write_b32 a2, 0
    v_accvgpr_write_b32 a3, 0
    v_accvgpr_write_b32 a4, 0
    v_accvgpr_write_b32 a5, 0
    v_accvgpr_write_b32 a6, 0
    v_accvgpr_write_b32 a7, 0
    v_accvgpr_write_b32 a8, 0
    v_accvgpr_write_b32 a9, 0
    v_accvgpr_write_b32 a10, 0
    v_accvgpr_write_b32 a11, 0
    v_accvgpr_write_b32 a12, 0
    v_accvgpr_write_b32 a13, 0
    v_accvgpr_write_b32 a14, 0
    v_accvgpr_write_b32 a15, 0
    v_accvgpr_write_b32 a16, 0
    v_accvgpr_write_b32 a17, 0
    v_accvgpr_write_b32 a18, 0
    v_accvgpr_write_b32 a19, 0
    v_accvgpr_write_b32 a20, 0
    v_accvgpr_write_b32 a21, 0
    v_accvgpr_write_b32 a22, 0
    v_accvgpr_write_b32 a23, 0
    v_accvgpr_write_b32 a24, 0
    v_accvgpr_write_b32 a25, 0
    v_accvgpr_write_b32 a26, 0
    v_accvgpr_write_b32 a27, 0
    v_accvgpr_write_b32 a28, 0
    v_accvgpr_write_b32 a29, 0
    v_accvgpr_write_b32 a30, 0
    v_accvgpr_write_b32 a31, 0
    v_accvgpr_write_b32 a32, 0
    v_accvgpr_write_b32 a33, 0
    v_accvgpr_write_b32 a34, 0
    v_accvgpr_write_b32 a35, 0
    v_accvgpr_write_b32 a36, 0
    v_accvgpr_write_b32 a37, 0
    v_accvgpr_write_b32 a38, 0
    v_accvgpr_write_b32 a39, 0
    v_accvgpr_write_b32 a40, 0
    v_accvgpr_write_b32 a41, 0
    v_accvgpr_write_b32 a42, 0
    v_accvgpr_write_b32 a43, 0
    v_accvgpr_write_b32 a44, 0
    v_accvgpr_write_b32 a45, 0
    v_accvgpr_write_b32 a46, 0
    v_accvgpr_write_b32 a47, 0
    v_accvgpr_write_b32 a48, 0
    v_accvgpr_write_b32 a49, 0
    v_accvgpr_write_b32 a50, 0
    v_accvgpr_write_b32 a51, 0
    v_accvgpr_write_b32 a52, 0
    v_accvgpr_write_b32 a53, 0
    v_accvgpr_write_b32 a54, 0
    v_accvgpr_write_b32 a55, 0
    v_accvgpr_write_b32 a56, 0
    v_accvgpr_write_b32 a57, 0
    v_accvgpr_write_b32 a58, 0
    v_accvgpr_write_b32 a59, 0
    v_accvgpr_write_b32 a60, 0
    v_accvgpr_write_b32 a61, 0
    v_accvgpr_write_b32 a62, 0
    v_accvgpr_write_b32 a63, 0
    v_accvgpr_write_b32 a64, 0
    v_accvgpr_write_b32 a65, 0
    v_accvgpr_write_b32 a66, 0
    v_accvgpr_write_b32 a67, 0
    v_accvgpr_write_b32 a68, 0
    v_accvgpr_write_b32 a69, 0
    v_accvgpr_write_b32 a70, 0
    v_accvgpr_write_b32 a71, 0
    v_accvgpr_write_b32 a72, 0
    v_accvgpr_write_b32 a73, 0
    v_accvgpr_write_b32 a74, 0
    v_accvgpr_write_b32 a75, 0
    v_accvgpr_write_b32 a76, 0
    v_accvgpr_write_b32 a77, 0
    v_accvgpr_write_b32 a78, 0
    v_accvgpr_write_b32 a79, 0
    v_accvgpr_write_b32 a80, 0
    v_accvgpr_write_b32 a81, 0
    v_accvgpr_write_b32 a82, 0
    v_accvgpr_write_b32 a83, 0
    v_accvgpr_write_b32 a84, 0
    v_accvgpr_write_b32 a85, 0
    v_accvgpr_write_b32 a86, 0
    v_accvgpr_write_b32 a87, 0
    v_accvgpr_write_b32 a88, 0
    v_accvgpr_write_b32 a89, 0
    v_accvgpr_write_b32 a90, 0
    v_accvgpr_write_b32 a91, 0
    v_accvgpr_write_b32 a92, 0
    v_accvgpr_write_b32 a93, 0
    v_accvgpr_write_b32 a94, 0
    v_accvgpr_write_b32 a95, 0
    s_add_u32 s48, s48, 49152
    v_add_u32 v104, s48, v4
    s_waitcnt vmcnt(4)
    ds_read_b128 a[104:107], v104 offset:25600
    ds_read_b128 a[108:111], v104 offset:26624
    ds_read_b128 v[120:123], v104 offset:0
    ds_read_b128 v[124:127], v104 offset:1024
    ds_read_b128 a[96:99], v104 offset:2048
    ds_read_b128 a[100:103], v104 offset:24576
    s_waitcnt lgkmcnt(0)
    s_waitcnt vmcnt(18)
    v_mfma_f32_16x16x32_bf16 a[0:3], v[64:67], v[32:35], a[0:3]
    buffer_load_dwordx4 v[16:19], v13, s[20:23], s55 offen offset:0 sc1
    v_mfma_f32_16x16x32_bf16 a[16:19], v[68:71], v[32:35], a[16:19]
    v_mfma_f32_16x16x32_bf16 a[32:35], v[72:75], v[32:35], a[32:35]
    buffer_load_dwordx4 v[20:23], v13, s[20:23], s55 offen offset:256 sc1
    v_mfma_f32_16x16x32_bf16 a[48:51], v[76:79], v[32:35], a[48:51]
    s_waitcnt vmcnt(19)
    v_mfma_f32_16x16x32_bf16 a[4:7], v[64:67], v[36:39], a[4:7]
    v_mfma_f32_16x16x32_bf16 a[20:23], v[68:71], v[36:39], a[20:23]
    buffer_load_dwordx4 v[24:27], v13, s[20:23], s55 offen offset:512 sc1
    v_mfma_f32_16x16x32_bf16 a[36:39], v[72:75], v[36:39], a[36:39]
    v_mfma_f32_16x16x32_bf16 a[52:55], v[76:79], v[36:39], a[52:55]
    buffer_load_dwordx4 v[28:31], v13, s[20:23], s55 offen offset:768 sc1
    s_waitcnt vmcnt(20)
    v_mfma_f32_16x16x32_bf16 a[8:11], v[64:67], v[40:43], a[8:11]
    v_mfma_f32_16x16x32_bf16 a[24:27], v[68:71], v[40:43], a[24:27]
    v_mfma_f32_16x16x32_bf16 a[40:43], v[72:75], v[40:43], a[40:43]
    buffer_load_dwordx4 a[112:115], v4, s[20:23], s61 offen offset:0 sc1
    v_mfma_f32_16x16x32_bf16 a[56:59], v[76:79], v[40:43], a[56:59]
    s_waitcnt vmcnt(20)
    v_mfma_f32_16x16x32_bf16 a[12:15], v[64:67], v[44:47], a[12:15]
    buffer_load_dwordx4 a[116:119], v4, s[20:23], s61 offen offset:1024 sc1
    v_mfma_f32_16x16x32_bf16 a[28:31], v[68:71], v[44:47], a[28:31]
    v_mfma_f32_16x16x32_bf16 a[44:47], v[72:75], v[44:47], a[44:47]
    v_mfma_f32_16x16x32_bf16 a[60:63], v[76:79], v[44:47], a[60:63]
    buffer_load_dwordx4 a[120:123], v4, s[20:23], s61 offen offset:2048 sc1
    s_waitcnt vmcnt(63)
    v_mfma_f32_16x16x32_bf16 a[64:67], a[104:107], v[32:35], a[64:67]
    v_mfma_f32_16x16x32_bf16 a[68:71], a[104:107], v[36:39], a[68:71]
    buffer_load_dwordx4 a[124:127], v4, s[20:23], s61 offen offset:3072 sc1
    s_add_u32 s61, s61, 65536
    v_mfma_f32_16x16x32_bf16 a[72:75], a[104:107], v[40:43], a[72:75]
    v_mfma_f32_16x16x32_bf16 a[76:79], a[104:107], v[44:47], a[76:79]
    s_add_u32 s55, s55, 73728
    s_cmp_lg_u32 s24, 0
    s_cbranch_scc1 Lsequ_69
    s_waitcnt vmcnt(17)
    v_readfirstlane_b32 s50, v6
    s_mov_b32 s51, 0
    s_nop 0
    s_cmp_ge_u32 s50, 32
    s_cbranch_scc1 Lsequ_69
Lsequ_68:
    s_sleep 4
    buffer_load_dword v6, v7, s[20:23], s44 offen offset:768 sc1
    s_waitcnt vmcnt(0)
    v_readfirstlane_b32 s50, v6
    s_add_u32 s51, s51, 1
    s_cmp_ge_u32 s51, 200000
    s_cbranch_scc1 Lsequ_69
    s_cmp_lt_u32 s50, 32
    s_cbranch_scc1 Lsequ_68
Lsequ_69:
    s_barrier
    s_waitcnt vmcnt(19)
    v_mfma_f32_16x16x32_bf16 a[0:3], v[80:83], v[48:51], a[0:3]
    buffer_load_dwordx4 v[64:67], v13, s[20:23], s54 offen offset:0 sc1
    v_mfma_f32_16x16x32_bf16 a[16:19], v[84:87], v[48:51], a[16:19]
    v_mfma_f32_16x16x32_bf16 a[32:35], v[88:91], v[48:51], a[32:35]
    buffer_load_dwordx4 v[68:71], v13, s[20:23], s54 offen offset:256 sc1
    v_mfma_f32_16x16x32_bf16 a[48:51], v[92:95], v[48:51], a[48:51]
    s_waitcnt vmcnt(20)
    v_mfma_f32_16x16x32_bf16 a[4:7], v[80:83], v[52:55], a[4:7]
    v_mfma_f32_16x16x32_bf16 a[20:23], v[84:87], v[52:55], a[20:23]
    buffer_load_dwordx4 v[72:75], v13, s[20:23], s54 offen offset:512 sc1
    v_mfma_f32_16x16x32_bf16 a[36:39], v[88:91], v[52:55], a[36:39]
    v_mfma_f32_16x16x32_bf16 a[52:55], v[92:95], v[52:55], a[52:55]
    buffer_load_dwordx4 v[76:79], v13, s[20:23], s54 offen offset:768 sc1
    s_waitcnt vmcnt(20)
    v_mfma_f32_16x16x32_bf16 a[8:11], v[80:83], v[56:59], a[8:11]
    v_mfma_f32_16x16x32_bf16 a[24:27], v[84:87], v[56:59], a[24:27]
    v_mfma_f32_16x16x32_bf16 a[40:43], v[88:91], v[56:59], a[40:43]
    buffer_load_dwordx4 v[32:35], v4, s[20:23], s60 offen offset:0 sc1
    v_mfma_f32_16x16x32_bf16 a[56:59], v[92:95], v[56:59], a[56:59]
    s_waitcnt vmcnt(20)
    v_mfma_f32_16x16x32_bf16 a[12:15], v[80:83], v[60:63], a[12:15]
    buffer_load_dwordx4 v[36:39], v4, s[20:23], s60 offen offset:1024 sc1
    v_mfma_f32_16x16x32_bf16 a[28:31], v[84:87], v[60:63], a[28:31]
    v_mfma_f32_16x16x32_bf16 a[44:47], v[88:91], v[60:63], a[44:47]
    v_mfma_f32_16x16x32_bf16 a[60:63], v[92:95], v[60:63], a[60:63]
    buffer_load_dwordx4 v[40:43], v4, s[20:23], s60 offen offset:2048 sc1
    v_mfma_f32_16x16x32_bf16 a[80:83], a[104:107], v[48:51], a[80:83]
    v_mfma_f32_16x16x32_bf16 a[84:87], a[104:107], v[52:55], a[84:87]
    buffer_load_dwordx4 v[44:47], v4, s[20:23], s60 offen offset:3072 sc1
    s_add_u32 s60, s60, 65536
    v_mfma_f32_16x16x32_bf16 a[88:91], a[104:107], v[56:59], a[88:91]
    v_mfma_f32_16x16x32_bf16 a[92:95], a[104:107], v[60:63], a[92:95]
    buffer_load_dwordx4 a[104:107], v12, s[20:23], s54 offen offset:1024 sc1
    s_add_u32 s54, s54, 73728
    buffer_load_dword v6, v7, s[20:23], s44 offen offset:256 sc1
    s_waitcnt vmcnt(21)
    v_mfma_f32_16x16x32_bf16 a[0:3], v[120:123], v[96:99], a[0:3]
    buffer_load_dwordx4 v[80:83], v13, s[20:23], s55 offen offset:0 sc1
    v_mfma_f32_16x16x32_bf16 a[16:19], v[124:127], v[96:99], a[16:19]
    v_mfma_f32_16x16x32_bf16 a[32:35], a[96:99], v[96:99], a[32:35]
    buffer_load_dwordx4 v[84:87], v13, s[20:23], s55 offen offset:256 sc1
    v_mfma_f32_16x16x32_bf16 a[48:51], a[100:103], v[96:99], a[48:51]
    s_waitcnt vmcnt(22)
    v_mfma_f32_16x16x32_bf16 a[4:7], v[120:123], v[100:103], a[4:7]
    v_mfma_f32_16x16x32_bf16 a[20:23], v[124:127], v[100:103], a[20:23]
    buffer_load_dwordx4 v[88:91], v13, s[20:23], s55 offen offset:512 sc1
    v_mfma_f32_16x16x32_bf16 a[36:39], a[96:99], v[100:103], a[36:39]
    v_mfma_f32_16x16x32_bf16 a[52:55], a[100:103], v[100:103], a[52:55]
    buffer_load_dwordx4 v[92:95], v13, s[20:23], s55 offen offset:768 sc1
    s_waitcnt vmcnt(23)
    v_mfma_f32_16x16x32_bf16 a[8:11], v[120:123], v[112:115], a[8:11]
    v_mfma_f32_16x16x32_bf16 a[24:27], v[124:127], v[112:115], a[24:27]
    v_mfma_f32_16x16x32_bf16 a[40:43], a[96:99], v[112:115], a[40:43]
    buffer_load_dwordx4 v[48:51], v4, s[20:23], s61 offen offset:0 sc1
    v_mfma_f32_16x16x32_bf16 a[56:59], a[100:103], v[112:115], a[56:59]
    s_waitcnt vmcnt(23)
    v_mfma_f32_16x16x32_bf16 a[12:15], v[120:123], v[116:119], a[12:15]
    buffer_load_dwordx4 v[52:55], v4, s[20:23], s61 offen offset:1024 sc1
    v_mfma_f32_16x16x32_bf16 a[28:31], v[124:127], v[116:119], a[28:31]
    v_mfma_f32_16x16x32_bf16 a[44:47], a[96:99], v[116:119], a[44:47]
    v_mfma_f32_16x16x32_bf16 a[60:63], a[100:103], v[116:119], a[60:63]
    buffer_load_dwordx4 v[56:59], v4, s[20:23], s61 offen offset:2048 sc1
    s_waitcnt vmcnt(63)
    v_mfma_f32_16x16x32_bf16 a[64:67], a[108:111], v[96:99], a[64:67]
    v_mfma_f32_16x16x32_bf16 a[68:71], a[108:111], v[100:103], a[68:71]
    buffer_load_dwordx4 v[60:63], v4, s[20:23], s61 offen offset:3072 sc1
    s_add_u32 s61, s61, 65536
    v_mfma_f32_16x16x32_bf16 a[72:75], a[108:111], v[112:115], a[72:75]
    v_mfma_f32_16x16x32_bf16 a[76:79], a[108:111], v[116:119], a[76:79]
    s_add_u32 s55, s55, 73728
    s_waitcnt vmcnt(21)
    v_mfma_f32_16x16x32_bf16 a[0:3], v[16:19], a[112:115], a[0:3]
    buffer_load_dwordx4 v[120:123], v13, s[20:23], s54 offen offset:0 sc1
    v_mfma_f32_16x16x32_bf16 a[16:19], v[20:23], a[112:115], a[16:19]
    v_mfma_f32_16x16x32_bf16 a[32:35], v[24:27], a[112:115], a[32:35]
    buffer_load_dwordx4 v[124:127], v13, s[20:23], s54 offen offset:256 sc1
    v_mfma_f32_16x16x32_bf16 a[48:51], v[28:31], a[112:115], a[48:51]
    s_waitcnt vmcnt(22)
    v_mfma_f32_16x16x32_bf16 a[4:7], v[16:19], a[116:119], a[4:7]
    v_mfma_f32_16x16x32_bf16 a[20:23], v[20:23], a[116:119], a[20:23]
    buffer_load_dwordx4 a[96:99], v13, s[20:23], s54 offen offset:512 sc1
    v_mfma_f32_16x16x32_bf16 a[36:39], v[24:27], a[116:119], a[36:39]
    v_mfma_f32_16x16x32_bf16 a[52:55], v[28:31], a[116:119], a[52:55]
    buffer_load_dwordx4 a[100:103], v13, s[20:23], s54 offen offset:768 sc1
    s_waitcnt vmcnt(23)
    v_mfma_f32_16x16x32_bf16 a[8:11], v[16:19], a[120:123], a[8:11]
    v_mfma_f32_16x16x32_bf16 a[24:27], v[20:23], a[120:123], a[24:27]
    v_mfma_f32_16x16x32_bf16 a[40:43], v[24:27], a[120:123], a[40:43]
    buffer_load_dwordx4 v[96:99], v4, s[20:23], s60 offen offset:0 sc1
    v_mfma_f32_16x16x32_bf16 a[56:59], v[28:31], a[120:123], a[56:59]
    s_waitcnt vmcnt(23)
    v_mfma_f32_16x16x32_bf16 a[12:15], v[16:19], a[124:127], a[12:15]
    buffer_load_dwordx4 v[100:103], v4, s[20:23], s60 offen offset:1024 sc1
    v_mfma_f32_16x16x32_bf16 a[28:31], v[20:23], a[124:127], a[28:31]
    v_mfma_f32_16x16x32_bf16 a[44:47], v[24:27], a[124:127], a[44:47]
    v_mfma_f32_16x16x32_bf16 a[60:63], v[28:31], a[124:127], a[60:63]
    buffer_load_dwordx4 v[112:115], v4, s[20:23], s60 offen offset:2048 sc1
    v_mfma_f32_16x16x32_bf16 a[80:83], a[108:111], a[112:115], a[80:83]
    v_mfma_f32_16x16x32_bf16 a[84:87], a[108:111], a[116:119], a[84:87]
    buffer_load_dwordx4 v[116:119], v4, s[20:23], s60 offen offset:3072 sc1
    s_add_u32 s60, s60, 65536
    v_mfma_f32_16x16x32_bf16 a[88:91], a[108:111], a[120:123], a[88:91]
    v_mfma_f32_16x16x32_bf16 a[92:95], a[108:111], a[124:127], a[92:95]
    buffer_load_dwordx4 a[108:111], v12, s[20:23], s54 offen offset:1024 sc1
    s_add_u32 s54, s54, 73728
    s_lshr_b32 s53, s24, 2
    s_cmp_lg_u32 s53, 0
    s_cbranch_scc1 Lsequ_70
    s_waitcnt vmcnt(0)
Lsequ_70:
    s_waitcnt vmcnt(22)
    v_mfma_f32_16x16x32_bf16 a[0:3], v[64:67], v[32:35], a[0:3]
    buffer_load_dwordx4 v[16:19], v13, s[20:23], s55 offen offset:0 sc1
    v_mfma_f32_16x16x32_bf16 a[16:19], v[68:71], v[32:35], a[16:19]
    v_mfma_f32_16x16x32_bf16 a[32:35], v[72:75], v[32:35], a[32:35]
    buffer_load_dwordx4 v[20:23], v13, s[20:23], s55 offen offset:256 sc1
    v_mfma_f32_16x16x32_bf16 a[48:51], v[76:79], v[32:35], a[48:51]
    s_waitcnt vmcnt(23)
    v_mfma_f32_16x16x32_bf16 a[4:7], v[64:67], v[36:39], a[4:7]
    v_mfma_f32_16x16x32_bf16 a[20:23], v[68:71], v[36:39], a[20:23]
    buffer_load_dwordx4 v[24:27], v13, s[20:23], s55 offen offset:512 sc1
    v_mfma_f32_16x16x32_bf16 a[36:39], v[72:75], v[36:39], a[36:39]
    v_mfma_f32_16x16x32_bf16 a[52:55], v[76:79], v[36:39], a[52:55]
    buffer_load_dwordx4 v[28:31], v13, s[20:23], s55 offen offset:768 sc1
    s_waitcnt vmcnt(24)
    v_mfma_f32_16x16x32_bf16 a[8:11], v[64:67], v[40:43], a[8:11]
    v_mfma_f32_16x16x32_bf16 a[24:27], v[68:71], v[40:43], a[24:27]
    v_mfma_f32_16x16x32_bf16 a[40:43], v[72:75], v[40:43], a[40:43]
    buffer_load_dwordx4 a[112:115], v4, s[20:23], s61 offen offset:0 sc1
    v_mfma_f32_16x16x32_bf16 a[56:59], v[76:79], v[40:43], a[56:59]
    s_waitcnt vmcnt(24)
    v_mfma_f32_16x16x32_bf16 a[12:15], v[64:67], v[44:47], a[12:15]
    buffer_load_dwordx4 a[116:119], v4, s[20:23], s61 offen offset:1024 sc1
    v_mfma_f32_16x16x32_bf16 a[28:31], v[68:71], v[44:47], a[28:31]
    v_mfma_f32_16x16x32_bf16 a[44:47], v[72:75], v[44:47], a[44:47]
    v_mfma_f32_16x16x32_bf16 a[60:63], v[76:79], v[44:47], a[60:63]
    buffer_load_dwordx4 a[120:123], v4, s[20:23], s61 offen offset:2048 sc1
    s_waitcnt vmcnt(25)
    v_mfma_f32_16x16x32_bf16 a[64:67], a[104:107], v[32:35], a[64:67]
    v_mfma_f32_16x16x32_bf16 a[68:71], a[104:107], v[36:39], a[68:71]
    buffer_load_dwordx4 a[124:127], v4, s[20:23], s61 offen offset:3072 sc1
    s_add_u32 s61, s61, 65536
    v_mfma_f32_16x16x32_bf16 a[72:75], a[104:107], v[40:43], a[72:75]
    v_mfma_f32_16x16x32_bf16 a[76:79], a[104:107], v[44:47], a[76:79]
    s_add_u32 s55, s55, 73728
    s_cmp_lg_u32 s24, 0
    s_cbranch_scc1 Lsequ_72
    s_waitcnt vmcnt(25)
    v_readfirstlane_b32 s50, v6
    s_mov_b32 s51, 0
    s_nop 0
    s_cmp_ge_u32 s50, 32
    s_cbranch_scc1 Lsequ_72
Lsequ_71:
    s_sleep 4
    buffer_load_dword v6, v7, s[20:23], s44 offen offset:256 sc1
    s_waitcnt vmcnt(0)
    v_readfirstlane_b32 s50, v6
    s_add_u32 s51, s51, 1
    s_cmp_ge_u32 s51, 200000
    s_cbranch_scc1 Lsequ_72
    s_cmp_lt_u32 s50, 32
    s_cbranch_scc1 Lsequ_71
Lsequ_72:
    s_barrier
    s_lshr_b32 s53, s24, 2
    s_cmp_lg_u32 s53, 1
    s_cbranch_scc1 Lsequ_73
    s_waitcnt vmcnt(0)
Lsequ_73:
    s_waitcnt vmcnt(20)
    v_mfma_f32_16x16x32_bf16 a[0:3], v[80:83], v[48:51], a[0:3]
    buffer_load_dwordx4 v[64:67], v13, s[20:23], s54 offen offset:0 sc1
    v_mfma_f32_16x16x32_bf16 a[16:19], v[84:87], v[48:51], a[16:19]
    v_mfma_f32_16x16x32_bf16 a[32:35], v[88:91], v[48:51], a[32:35]
    buffer_load_dwordx4 v[68:71], v13, s[20:23], s54 offen offset:256 sc1
    v_mfma_f32_16x16x32_bf16 a[48:51], v[92:95], v[48:51], a[48:51]
    s_waitcnt vmcnt(21)
    v_mfma_f32_16x16x32_bf16 a[4:7], v[80:83], v[52:55], a[4:7]
    v_mfma_f32_16x16x32_bf16 a[20:23], v[84:87], v[52:55], a[20:23]
    buffer_load_dwordx4 v[72:75], v13, s[20:23], s54 offen offset:512 sc1
    v_mfma_f32_16x16x32_bf16 a[36:39], v[88:91], v[52:55], a[36:39]
    v_mfma_f32_16x16x32_bf16 a[52:55], v[92:95], v[52:55], a[52:55]
    buffer_load_dwordx4 v[76:79], v13, s[20:23], s54 offen offset:768 sc1
    s_waitcnt vmcnt(22)
    v_mfma_f32_16x16x32_bf16 a[8:11], v[80:83], v[56:59], a[8:11]
    v_mfma_f32_16x16x32_bf16 a[24:27], v[84:87], v[56:59], a[24:27]
    v_mfma_f32_16x16x32_bf16 a[40:43], v[88:91], v[56:59], a[40:43]
    buffer_load_dwordx4 v[32:35], v4, s[20:23], s60 offen offset:0 sc1
    v_mfma_f32_16x16x32_bf16 a[56:59], v[92:95], v[56:59], a[56:59]
    s_waitcnt vmcnt(22)
    v_mfma_f32_16x16x32_bf16 a[12:15], v[80:83], v[60:63], a[12:15]
    buffer_load_dwordx4 v[36:39], v4, s[20:23], s60 offen offset:1024 sc1
    v_mfma_f32_16x16x32_bf16 a[28:31], v[84:87], v[60:63], a[28:31]
    v_mfma_f32_16x16x32_bf16 a[44:47], v[88:91], v[60:63], a[44:47]
    v_mfma_f32_16x16x32_bf16 a[60:63], v[92:95], v[60:63], a[60:63]
    buffer_load_dwordx4 v[40:43], v4, s[20:23], s60 offen offset:2048 sc1
    v_mfma_f32_16x16x32_bf16 a[80:83], a[104:107], v[48:51], a[80:83]
    v_mfma_f32_16x16x32_bf16 a[84:87], a[104:107], v[52:55], a[84:87]
    buffer_load_dwordx4 v[44:47], v4, s[20:23], s60 offen offset:3072 sc1
    s_add_u32 s60, s60, 65536
    v_mfma_f32_16x16x32_bf16 a[88:91], a[104:107], v[56:59], a[88:91]
    v_mfma_f32_16x16x32_bf16 a[92:95], a[104:107], v[60:63], a[92:95]
    buffer_load_dwordx4 a[104:107], v12, s[20:23], s54 offen offset:1024 sc1
    s_add_u32 s54, s54, 73728
    s_barrier
    v_mov_b32 v5, 1
    buffer_atomic_add v5, v7, s[20:23], s41 offen offset:512 sc1
    s_waitcnt vmcnt(21)
    v_mfma_f32_16x16x32_bf16 a[0:3], v[120:123], v[96:99], a[0:3]
    buffer_load_dwordx4 v[80:83], v13, s[20:23], s55 offen offset:0 sc1
    v_mfma_f32_16x16x32_bf16 a[16:19], v[124:127], v[96:99], a[16:19]
    v_mfma_f32_16x16x32_bf16 a[32:35], a[96:99], v[96:99], a[32:35]
    buffer_load_dwordx4 v[84:87], v13, s[20:23], s55 offen offset:256 sc1
    v_mfma_f32_16x16x32_bf16 a[48:51], a[100:103], v[96:99], a[48:51]
    s_waitcnt vmcnt(22)
    v_mfma_f32_16x16x32_bf16 a[4:7], v[120:123], v[100:103], a[4:7]
    v_mfma_f32_16x16x32_bf16 a[20:23], v[124:127], v[100:103], a[20:23]
    buffer_load_dwordx4 v[88:91], v13, s[20:23], s55 offen offset:512 sc1
    v_mfma_f32_16x16x32_bf16 a[36:39], a[96:99], v[100:103], a[36:39]
    v_mfma_f32_16x16x32_bf16 a[52:55], a[100:103], v[100:103], a[52:55]
    buffer_load_dwordx4 v[92:95], v13, s[20:23], s55 offen offset:768 sc1
    s_waitcnt vmcnt(23)
    v_mfma_f32_16x16x32_bf16 a[8:11], v[120:123], v[112:115], a[8:11]
    v_mfma_f32_16x16x32_bf16 a[24:27], v[124:127], v[112:115], a[24:27]
    v_mfma_f32_16x16x32_bf16 a[40:43], a[96:99], v[112:115], a[40:43]
    buffer_load_dwordx4 v[48:51], v4, s[20:23], s61 offen offset:0 sc1
    v_mfma_f32_16x16x32_bf16 a[56:59], a[100:103], v[112:115], a[56:59]
    s_waitcnt vmcnt(23)
    v_mfma_f32_16x16x32_bf16 a[12:15], v[120:123], v[116:119], a[12:15]
    buffer_load_dwordx4 v[52:55], v4, s[20:23], s61 offen offset:1024 sc1
    v_mfma_f32_16x16x32_bf16 a[28:31], v[124:127], v[116:119], a[28:31]
    v_mfma_f32_16x16x32_bf16 a[44:47], a[96:99], v[116:119], a[44:47]
    v_mfma_f32_16x16x32_bf16 a[60:63], a[100:103], v[116:119], a[60:63]
    buffer_load_dwordx4 v[56:59], v4, s[20:23], s61 offen offset:2048 sc1
    s_waitcnt vmcnt(24)
    v_mfma_f32_16x16x32_bf16 a[64:67], a[108:111], v[96:99], a[64:67]
    v_mfma_f32_16x16x32_bf16 a[68:71], a[108:111], v[100:103], a[68:71]
    buffer_load_dwordx4 v[60:63], v4, s[20:23], s61 offen offset:3072 sc1
    s_add_u32 s61, s61, 65536
    v_mfma_f32_16x16x32_bf16 a[72:75], a[108:111], v[112:115], a[72:75]
    v_mfma_f32_16x16x32_bf16 a[76:79], a[108:111], v[116:119], a[76:79]
    s_add_u32 s55, s55, 73728
    s_waitcnt vmcnt(20)
    v_mfma_f32_16x16x32_bf16 a[0:3], v[16:19], a[112:115], a[0:3]
    buffer_load_dwordx4 v[120:123], v13, s[20:23], s54 offen offset:0 sc1
    v_mfma_f32_16x16x32_bf16 a[16:19], v[20:23], a[112:115], a[16:19]
    v_mfma_f32_16x16x32_bf16 a[32:35], v[24:27], a[112:115], a[32:35]
    buffer_load_dwordx4 v[124:127], v13, s[20:23], s54 offen offset:256 sc1
    v_mfma_f32_16x16x32_bf16 a[48:51], v[28:31], a[112:115], a[48:51]
    s_waitcnt vmcnt(21)
    v_mfma_f32_16x16x32_bf16 a[4:7], v[16:19], a[116:119], a[4:7]
    v_mfma_f32_16x16x32_bf16 a[20:23], v[20:23], a[116:119], a[20:23]
    buffer_load_dwordx4 a[96:99], v13, s[20:23], s54 offen offset:512 sc1
    v_mfma_f32_16x16x32_bf16 a[36:39], v[24:27], a[116:119], a[36:39]
    v_mfma_f32_16x16x32_bf16 a[52:55], v[28:31], a[116:119], a[52:55]
    buffer_load_dwordx4 a[100:103], v13, s[20:23], s54 offen offset:768 sc1
    s_waitcnt vmcnt(22)
    v_mfma_f32_16x16x32_bf16 a[8:11], v[16:19], a[120:123], a[8:11]
    v_mfma_f32_16x16x32_bf16 a[24:27], v[20:23], a[120:123], a[24:27]
    v_mfma_f32_16x16x32_bf16 a[40:43], v[24:27], a[120:123], a[40:43]
    buffer_load_dwordx4 v[96:99], v4, s[20:23], s60 offen offset:0 sc1
    v_mfma_f32_16x16x32_bf16 a[56:59], v[28:31], a[120:123], a[56:59]
    s_waitcnt vmcnt(22)
    v_mfma_f32_16x16x32_bf16 a[12:15], v[16:19], a[124:127], a[12:15]
    buffer_load_dwordx4 v[100:103], v4, s[20:23], s60 offen offset:1024 sc1
    v_mfma_f32_16x16x32_bf16 a[28:31], v[20:23], a[124:127], a[28:31]
    v_mfma_f32_16x16x32_bf16 a[44:47], v[24:27], a[124:127], a[44:47]
    v_mfma_f32_16x16x32_bf16 a[60:63], v[28:31], a[124:127], a[60:63]
    buffer_load_dwordx4 v[112:115], v4, s[20:23], s60 offen offset:2048 sc1
    v_mfma_f32_16x16x32_bf16 a[80:83], a[108:111], a[112:115], a[80:83]
    v_mfma_f32_16x16x32_bf16 a[84:87], a[108:111], a[116:119], a[84:87]
    buffer_load_dwordx4 v[116:119], v4, s[20:23], s60 offen offset:3072 sc1
    s_add_u32 s60, s60, 65536
    v_mfma_f32_16x16x32_bf16 a[88:91], a[108:111], a[120:123], a[88:91]
    v_mfma_f32_16x16x32_bf16 a[92:95], a[108:111], a[124:127], a[92:95]
    buffer_load_dwordx4 a[108:111], v12, s[20:23], s54 offen offset:1024 sc1
    s_add_u32 s54, s54, 73728
    buffer_load_dword v6, v7, s[20:23], s44 offen offset:512 sc1
    s_waitcnt vmcnt(22)
    v_mfma_f32_16x16x32_bf16 a[0:3], v[64:67], v[32:35], a[0:3]
    buffer_load_dwordx4 v[16:19], v13, s[20:23], s55 offen offset:0 sc1
    v_mfma_f32_16x16x32_bf16 a[16:19], v[68:71], v[32:35], a[16:19]
    v_mfma_f32_16x16x32_bf16 a[32:35], v[72:75], v[32:35], a[32:35]
    buffer_load_dwordx4 v[20:23], v13, s[20:23], s55 offen offset:256 sc1
    v_mfma_f32_16x16x32_bf16 a[48:51], v[76:79], v[32:35], a[48:51]
    s_waitcnt vmcnt(23)
    v_mfma_f32_16x16x32_bf16 a[4:7], v[64:67], v[36:39], a[4:7]
    v_mfma_f32_16x16x32_bf16 a[20:23], v[68:71], v[36:39], a[20:23]
    buffer_load_dwordx4 v[24:27], v13, s[20:23], s55 offen offset:512 sc1
    v_mfma_f32_16x16x32_bf16 a[36:39], v[72:75], v[36:39], a[36:39]
    v_mfma_f32_16x16x32_bf16 a[52:55], v[76:79], v[36:39], a[52:55]
    buffer_load_dwordx4 v[28:31], v13, s[20:23], s55 offen offset:768 sc1
    s_waitcnt vmcnt(24)
    v_mfma_f32_16x16x32_bf16 a[8:11], v[64:67], v[40:43], a[8:11]
    v_mfma_f32_16x16x32_bf16 a[24:27], v[68:71], v[40:43], a[24:27]
    v_mfma_f32_16x16x32_bf16 a[40:43], v[72:75], v[40:43], a[40:43]
    buffer_load_dwordx4 a[112:115], v4, s[20:23], s61 offen offset:0 sc1
    v_mfma_f32_16x16x32_bf16 a[56:59], v[76:79], v[40:43], a[56:59]
    s_waitcnt vmcnt(24)
    v_mfma_f32_16x16x32_bf16 a[12:15], v[64:67], v[44:47], a[12:15]
    buffer_load_dwordx4 a[116:119], v4, s[20:23], s61 offen offset:1024 sc1
    v_mfma_f32_16x16x32_bf16 a[28:31], v[68:71], v[44:47], a[28:31]
    v_mfma_f32_16x16x32_bf16 a[44:47], v[72:75], v[44:47], a[44:47]
    v_mfma_f32_16x16x32_bf16 a[60:63], v[76:79], v[44:47], a[60:63]
    buffer_load_dwordx4 a[120:123], v4, s[20:23], s61 offen offset:2048 sc1
    s_waitcnt vmcnt(25)
    v_mfma_f32_16x16x32_bf16 a[64:67], a[104:107], v[32:35], a[64:67]
    v_mfma_f32_16x16x32_bf16 a[68:71], a[104:107], v[36:39], a[68:71]
    buffer_load_dwordx4 a[124:127], v4, s[20:23], s61 offen offset:3072 sc1
    s_add_u32 s61, s61, 65536
    v_mfma_f32_16x16x32_bf16 a[72:75], a[104:107], v[40:43], a[72:75]
    v_mfma_f32_16x16x32_bf16 a[76:79], a[104:107], v[44:47], a[76:79]
    s_add_u32 s55, s55, 73728
    s_cmp_lg_u32 s24, 0
    s_cbranch_scc1 Lsequ_75
    s_waitcnt vmcnt(8)
    v_readfirstlane_b32 s50, v6
    s_mov_b32 s51, 0
    s_nop 0
    s_cmp_ge_u32 s50, 32
    s_cbranch_scc1 Lsequ_75
Lsequ_74:
    s_sleep 4
    buffer_load_dword v6, v7, s[20:23], s44 offen offset:512 sc1
    s_waitcnt vmcnt(0)
    v_readfirstlane_b32 s50, v6
    s_add_u32 s51, s51, 1
    s_cmp_ge_u32 s51, 200000
    s_cbranch_scc1 Lsequ_75
    s_cmp_lt_u32 s50, 32
    s_cbranch_scc1 Lsequ_74
Lsequ_75:
    s_barrier
    s_waitcnt vmcnt(21)
    v_mfma_f32_16x16x32_bf16 a[0:3], v[80:83], v[48:51], a[0:3]
    buffer_load_dwordx4 v[64:67], v13, s[20:23], s54 offen offset:0 sc1
    v_mfma_f32_16x16x32_bf16 a[16:19], v[84:87], v[48:51], a[16:19]
    v_mfma_f32_16x16x32_bf16 a[32:35], v[88:91], v[48:51], a[32:35]
    buffer_load_dwordx4 v[68:71], v13, s[20:23], s54 offen offset:256 sc1
    v_mfma_f32_16x16x32_bf16 a[48:51], v[92:95], v[48:51], a[48:51]
    s_waitcnt vmcnt(22)
    v_mfma_f32_16x16x32_bf16 a[4:7], v[80:83], v[52:55], a[4:7]
    v_mfma_f32_16x16x32_bf16 a[20:23], v[84:87], v[52:55], a[20:23]
    buffer_load_dwordx4 v[72:75], v13, s[20:23], s54 offen offset:512 sc1
    v_mfma_f32_16x16x32_bf16 a[36:39], v[88:91], v[52:55], a[36:39]
    v_mfma_f32_16x16x32_bf16 a[52:55], v[92:95], v[52:55], a[52:55]
    buffer_load_dwordx4 v[76:79], v13, s[20:23], s54 offen offset:768 sc1
    s_waitcnt vmcnt(23)
    v_mfma_f32_16x16x32_bf16 a[8:11], v[80:83], v[56:59], a[8:11]
    v_mfma_f32_16x16x32_bf16 a[24:27], v[84:87], v[56:59], a[24:27]
    v_mfma_f32_16x16x32_bf16 a[40:43], v[88:91], v[56:59], a[40:43]
    buffer_load_dwordx4 v[32:35], v4, s[20:23], s60 offen offset:0 sc1
    v_mfma_f32_16x16x32_bf16 a[56:59], v[92:95], v[56:59], a[56:59]
    s_waitcnt vmcnt(23)
    v_mfma_f32_16x16x32_bf16 a[12:15], v[80:83], v[60:63], a[12:15]
    buffer_load_dwordx4 v[36:39], v4, s[20:23], s60 offen offset:1024 sc1
    v_mfma_f32_16x16x32_bf16 a[28:31], v[84:87], v[60:63], a[28:31]
    v_mfma_f32_16x16x32_bf16 a[44:47], v[88:91], v[60:63], a[44:47]
    v_mfma_f32_16x16x32_bf16 a[60:63], v[92:95], v[60:63], a[60:63]
    buffer_load_dwordx4 v[40:43], v4, s[20:23], s60 offen offset:2048 sc1
    v_mfma_f32_16x16x32_bf16 a[80:83], a[104:107], v[48:51], a[80:83]
    v_mfma_f32_16x16x32_bf16 a[84:87], a[104:107], v[52:55], a[84:87]
    buffer_load_dwordx4 v[44:47], v4, s[20:23], s60 offen offset:3072 sc1
    s_add_u32 s60, s60, 65536
    v_mfma_f32_16x16x32_bf16 a[88:91], a[104:107], v[56:59], a[88:91]
    v_mfma_f32_16x16x32_bf16 a[92:95], a[104:107], v[60:63], a[92:95]
    buffer_load_dwordx4 a[104:107], v12, s[20:23], s54 offen offset:1024 sc1
    s_add_u32 s54, s54, 73728
    s_waitcnt vmcnt(22)
    v_mfma_f32_16x16x32_bf16 a[0:3], v[120:123], v[96:99], a[0:3]
    buffer_load_dwordx4 v[80:83], v13, s[20:23], s55 offen offset:0 sc1
    v_mfma_f32_16x16x32_bf16 a[16:19], v[124:127], v[96:99], a[16:19]
    v_mfma_f32_16x16x32_bf16 a[32:35], a[96:99], v[96:99], a[32:35]
    buffer_load_dwordx4 v[84:87], v13, s[20:23], s55 offen offset:256 sc1
    v_mfma_f32_16x16x32_bf16 a[48:51], a[100:103], v[96:99], a[48:51]
    s_waitcnt vmcnt(23)
    v_mfma_f32_16x16x32_bf16 a[4:7], v[120:123], v[100:103], a[4:7]
    v_mfma_f32_16x16x32_bf16 a[20:23], v[124:127], v[100:103], a[20:23]
    buffer_load_dwordx4 v[88:91], v13, s[20:23], s55 offen offset:512 sc1
    v_mfma_f32_16x16x32_bf16 a[36:39], a[96:99], v[100:103], a[36:39]
    v_mfma_f32_16x16x32_bf16 a[52:55], a[100:103], v[100:103], a[52:55]
    buffer_load_dwordx4 v[92:95], v13, s[20:23], s55 offen offset:768 sc1
    s_waitcnt vmcnt(24)
    v_mfma_f32_16x16x32_bf16 a[8:11], v[120:123], v[112:115], a[8:11]
    v_mfma_f32_16x16x32_bf16 a[24:27], v[124:127], v[112:115], a[24:27]
    v_mfma_f32_16x16x32_bf16 a[40:43], a[96:99], v[112:115], a[40:43]
    buffer_load_dwordx4 v[48:51], v4, s[20:23], s61 offen offset:0 sc1
    v_mfma_f32_16x16x32_bf16 a[56:59], a[100:103], v[112:115], a[56:59]
    s_waitcnt vmcnt(24)
    v_mfma_f32_16x16x32_bf16 a[12:15], v[120:123], v[116:119], a[12:15]
    buffer_load_dwordx4 v[52:55], v4, s[20:23], s61 offen offset:1024 sc1
    v_mfma_f32_16x16x32_bf16 a[28:31], v[124:127], v[116:119], a[28:31]
    v_mfma_f32_16x16x32_bf16 a[44:47], a[96:99], v[116:119], a[44:47]
    v_mfma_f32_16x16x32_bf16 a[60:63], a[100:103], v[116:119], a[60:63]
    buffer_load_dwordx4 v[56:59], v4, s[20:23], s61 offen offset:2048 sc1
    s_waitcnt vmcnt(25)
    v_mfma_f32_16x16x32_bf16 a[64:67], a[108:111], v[96:99], a[64:67]
    v_mfma_f32_16x16x32_bf16 a[68:71], a[108:111], v[100:103], a[68:71]
    buffer_load_dwordx4 v[60:63], v4, s[20:23], s61 offen offset:3072 sc1
    s_add_u32 s61, s61, 65536
    v_mfma_f32_16x16x32_bf16 a[72:75], a[108:111], v[112:115], a[72:75]
    v_mfma_f32_16x16x32_bf16 a[76:79], a[108:111], v[116:119], a[76:79]
    s_add_u32 s55, s55, 73728
    s_waitcnt vmcnt(20)
    v_mfma_f32_16x16x32_bf16 a[0:3], v[16:19], a[112:115], a[0:3]
    buffer_load_dwordx4 v[120:123], v13, s[20:23], s54 offen offset:0 sc1
    v_mfma_f32_16x16x32_bf16 a[16:19], v[20:23], a[112:115], a[16:19]
    v_mfma_f32_16x16x32_bf16 a[32:35], v[24:27], a[112:115], a[32:35]
    buffer_load_dwordx4 v[124:127], v13, s[20:23], s54 offen offset:256 sc1
    v_mfma_f32_16x16x32_bf16 a[48:51], v[28:31], a[112:115], a[48:51]
    s_waitcnt vmcnt(21)
    v_mfma_f32_16x16x32_bf16 a[4:7], v[16:19], a[116:119], a[4:7]
    v_mfma_f32_16x16x32_bf16 a[20:23], v[20:23], a[116:119], a[20:23]
    buffer_load_dwordx4 a[96:99], v13, s[20:23], s54 offen offset:512 sc1
    v_mfma_f32_16x16x32_bf16 a[36:39], v[24:27], a[116:119], a[36:39]
    v_mfma_f32_16x16x32_bf16 a[52:55], v[28:31], a[116:119], a[52:55]
    buffer_load_dwordx4 a[100:103], v13, s[20:23], s54 offen offset:768 sc1
    s_waitcnt vmcnt(22)
    v_mfma_f32_16x16x32_bf16 a[8:11], v[16:19], a[120:123], a[8:11]
    v_mfma_f32_16x16x32_bf16 a[24:27], v[20:23], a[120:123], a[24:27]
    v_mfma_f32_16x16x32_bf16 a[40:43], v[24:27], a[120:123], a[40:43]
    buffer_load_dwordx4 v[96:99], v4, s[20:23], s60 offen offset:0 sc1
    v_mfma_f32_16x16x32_bf16 a[56:59], v[28:31], a[120:123], a[56:59]
    s_waitcnt vmcnt(22)
    v_mfma_f32_16x16x32_bf16 a[12:15], v[16:19], a[124:127], a[12:15]
    buffer_load_dwordx4 v[100:103], v4, s[20:23], s60 offen offset:1024 sc1
    v_mfma_f32_16x16x32_bf16 a[28:31], v[20:23], a[124:127], a[28:31]
    v_mfma_f32_16x16x32_bf16 a[44:47], v[24:27], a[124:127], a[44:47]
    v_mfma_f32_16x16x32_bf16 a[60:63], v[28:31], a[124:127], a[60:63]
    buffer_load_dwordx4 v[112:115], v4, s[20:23], s60 offen offset:2048 sc1
    v_mfma_f32_16x16x32_bf16 a[80:83], a[108:111], a[112:115], a[80:83]
    v_mfma_f32_16x16x32_bf16 a[84:87], a[108:111], a[116:119], a[84:87]
    buffer_load_dwordx4 v[116:119], v4, s[20:23], s60 offen offset:3072 sc1
    s_add_u32 s60, s60, 65536
    v_mfma_f32_16x16x32_bf16 a[88:91], a[108:111], a[120:123], a[88:91]
    v_mfma_f32_16x16x32_bf16 a[92:95], a[108:111], a[124:127], a[92:95]
    buffer_load_dwordx4 a[108:111], v12, s[20:23], s54 offen offset:1024 sc1
    s_add_u32 s54, s54, 73728
    s_waitcnt vmcnt(21)
    v_mfma_f32_16x16x32_bf16 a[0:3], v[64:67], v[32:35], a[0:3]
    buffer_load_dwordx4 v[16:19], v13, s[20:23], s55 offen offset:0 sc1
    v_mfma_f32_16x16x32_bf16 a[16:19], v[68:71], v[32:35], a[16:19]
    v_mfma_f32_16x16x32_bf16 a[32:35], v[72:75], v[32:35], a[32:35]
    buffer_load_dwordx4 v[20:23], v13, s[20:23], s55 offen offset:256 sc1
    v_mfma_f32_16x16x32_bf16 a[48:51], v[76:79], v[32:35], a[48:51]
    s_waitcnt vmcnt(22)
    v_mfma_f32_16x16x32_bf16 a[4:7], v[64:67], v[36:39], a[4:7]
    v_mfma_f32_16x16x32_bf16 a[20:23], v[68:71], v[36:39], a[20:23]
    buffer_load_dwordx4 v[24:27], v13, s[20:23], s55 offen offset:512 sc1
    v_mfma_f32_16x16x32_bf16 a[36:39], v[72:75], v[36:39], a[36:39]
    v_mfma_f32_16x16x32_bf16 a[52:55], v[76:79], v[36:39], a[52:55]
    buffer_load_dwordx4 v[28:31], v13, s[20:23], s55 offen offset:768 sc1
    s_waitcnt vmcnt(23)
    v_mfma_f32_16x16x32_bf16 a[8:11], v[64:67], v[40:43], a[8:11]
    v_mfma_f32_16x16x32_bf16 a[24:27], v[68:71], v[40:43], a[24:27]
    v_mfma_f32_16x16x32_bf16 a[40:43], v[72:75], v[40:43], a[40:43]
    buffer_load_dwordx4 a[112:115], v4, s[20:23], s61 offen offset:0 sc1
    v_mfma_f32_16x16x32_bf16 a[56:59], v[76:79], v[40:43], a[56:59]
    s_waitcnt vmcnt(23)
    v_mfma_f32_16x16x32_bf16 a[12:15], v[64:67], v[44:47], a[12:15]
    buffer_load_dwordx4 a[116:119], v4, s[20:23], s61 offen offset:1024 sc1
    v_mfma_f32_16x16x32_bf16 a[28:31], v[68:71], v[44:47], a[28:31]
    v_mfma_f32_16x16x32_bf16 a[44:47], v[72:75], v[44:47], a[44:47]
    v_mfma_f32_16x16x32_bf16 a[60:63], v[76:79], v[44:47], a[60:63]
    buffer_load_dwordx4 a[120:123], v4, s[20:23], s61 offen offset:2048 sc1
    s_waitcnt vmcnt(24)
    v_mfma_f32_16x16x32_bf16 a[64:67], a[104:107], v[32:35], a[64:67]
    v_mfma_f32_16x16x32_bf16 a[68:71], a[104:107], v[36:39], a[68:71]
    buffer_load_dwordx4 a[124:127], v4, s[20:23], s61 offen offset:3072 sc1
    s_add_u32 s61, s61, 65536
    v_mfma_f32_16x16x32_bf16 a[72:75], a[104:107], v[40:43], a[72:75]
    v_mfma_f32_16x16x32_bf16 a[76:79], a[104:107], v[44:47], a[76:79]
    s_add_u32 s55, s55, 73728
    s_waitcnt vmcnt(20)
    v_mfma_f32_16x16x32_bf16 a[0:3], v[80:83], v[48:51], a[0:3]
    buffer_load_dwordx4 v[64:67], v13, s[20:23], s54 offen offset:0 sc1
    v_mfma_f32_16x16x32_bf16 a[16:19], v[84:87], v[48:51], a[16:19]
    v_mfma_f32_16x16x32_bf16 a[32:35], v[88:91], v[48:51], a[32:35]
    buffer_load_dwordx4 v[68:71], v13, s[20:23], s54 offen offset:256 sc1
    v_mfma_f32_16x16x32_bf16 a[48:51], v[92:95], v[48:51], a[48:51]
    s_waitcnt vmcnt(21)
    v_mfma_f32_16x16x32_bf16 a[4:7], v[80:83], v[52:55], a[4:7]
    v_mfma_f32_16x16x32_bf16 a[20:23], v[84:87], v[52:55], a[20:23]
    buffer_load_dwordx4 v[72:75], v13, s[20:23], s54 offen offset:512 sc1
    v_mfma_f32_16x16x32_bf16 a[36:39], v[88:91], v[52:55], a[36:39]
    v_mfma_f32_16x16x32_bf16 a[52:55], v[92:95], v[52:55], a[52:55]
    buffer_load_dwordx4 v[76:79], v13, s[20:23], s54 offen offset:768 sc1
    s_waitcnt vmcnt(22)
    v_mfma_f32_16x16x32_bf16 a[8:11], v[80:83], v[56:59], a[8:11]
    v_mfma_f32_16x16x32_bf16 a[24:27], v[84:87], v[56:59], a[24:27]
    v_mfma_f32_16x16x32_bf16 a[40:43], v[88:91], v[56:59], a[40:43]
    buffer_load_dwordx4 v[32:35], v4, s[20:23], s60 offen offset:0 sc1
    v_mfma_f32_16x16x32_bf16 a[56:59], v[92:95], v[56:59], a[56:59]
    s_waitcnt vmcnt(22)
    v_mfma_f32_16x16x32_bf16 a[12:15], v[80:83], v[60:63], a[12:15]
    buffer_load_dwordx4 v[36:39], v4, s[20:23], s60 offen offset:1024 sc1
    v_mfma_f32_16x16x32_bf16 a[28:31], v[84:87], v[60:63], a[28:31]
    v_mfma_f32_16x16x32_bf16 a[44:47], v[88:91], v[60:63], a[44:47]
    v_mfma_f32_16x16x32_bf16 a[60:63], v[92:95], v[60:63], a[60:63]
    buffer_load_dwordx4 v[40:43], v4, s[20:23], s60 offen offset:2048 sc1
    v_mfma_f32_16x16x32_bf16 a[80:83], a[104:107], v[48:51], a[80:83]
    v_mfma_f32_16x16x32_bf16 a[84:87], a[104:107], v[52:55], a[84:87]
    buffer_load_dwordx4 v[44:47], v4, s[20:23], s60 offen offset:3072 sc1
    s_add_u32 s60, s60, 65536
    v_mfma_f32_16x16x32_bf16 a[88:91], a[104:107], v[56:59], a[88:91]
    v_mfma_f32_16x16x32_bf16 a[92:95], a[104:107], v[60:63], a[92:95]
    buffer_load_dwordx4 a[104:107], v12, s[20:23], s54 offen offset:1024 sc1
    s_add_u32 s54, s54, 73728
    s_waitcnt vmcnt(21)
    v_mfma_f32_16x16x32_bf16 a[0:3], v[120:123], v[96:99], a[0:3]
    buffer_load_dwordx4 v[80:83], v13, s[20:23], s55 offen offset:0 sc1
    v_mfma_f32_16x16x32_bf16 a[16:19], v[124:127], v[96:99], a[16:19]
    v_mfma_f32_16x16x32_bf16 a[32:35], a[96:99], v[96:99], a[32:35]
    buffer_load_dwordx4 v[84:87], v13, s[20:23], s55 offen offset:256 sc1
    v_mfma_f32_16x16x32_bf16 a[48:51], a[100:103], v[96:99], a[48:51]
    s_waitcnt vmcnt(22)
    v_mfma_f32_16x16x32_bf16 a[4:7], v[120:123], v[100:103], a[4:7]
    v_mfma_f32_16x16x32_bf16 a[20:23], v[124:127], v[100:103], a[20:23]
    buffer_load_dwordx4 v[88:91], v13, s[20:23], s55 offen offset:512 sc1
    v_mfma_f32_16x16x32_bf16 a[36:39], a[96:99], v[100:103], a[36:39]
    v_mfma_f32_16x16x32_bf16 a[52:55], a[100:103], v[100:103], a[52:55]
    buffer_load_dwordx4 v[92:95], v13, s[20:23], s55 offen offset:768 sc1
    s_waitcnt vmcnt(23)
    v_mfma_f32_16x16x32_bf16 a[8:11], v[120:123], v[112:115], a[8:11]
    v_mfma_f32_16x16x32_bf16 a[24:27], v[124:127], v[112:115], a[24:27]
    v_mfma_f32_16x16x32_bf16 a[40:43], a[96:99], v[112:115], a[40:43]
    buffer_load_dwordx4 v[48:51], v4, s[20:23], s61 offen offset:0 sc1
    v_mfma_f32_16x16x32_bf16 a[56:59], a[100:103], v[112:115], a[56:59]
    s_waitcnt vmcnt(23)
    v_mfma_f32_16x16x32_bf16 a[12:15], v[120:123], v[116:119], a[12:15]
    buffer_load_dwordx4 v[52:55], v4, s[20:23], s61 offen offset:1024 sc1
    v_mfma_f32_16x16x32_bf16 a[28:31], v[124:127], v[116:119], a[28:31]
    v_mfma_f32_16x16x32_bf16 a[44:47], a[96:99], v[116:119], a[44:47]
    v_mfma_f32_16x16x32_bf16 a[60:63], a[100:103], v[116:119], a[60:63]
    buffer_load_dwordx4 v[56:59], v4, s[20:23], s61 offen offset:2048 sc1
    s_waitcnt vmcnt(24)
    v_mfma_f32_16x16x32_bf16 a[64:67], a[108:111], v[96:99], a[64:67]
    v_mfma_f32_16x16x32_bf16 a[68:71], a[108:111], v[100:103], a[68:71]
    buffer_load_dwordx4 v[60:63], v4, s[20:23], s61 offen offset:3072 sc1
    s_add_u32 s61, s61, 65536
    v_mfma_f32_16x16x32_bf16 a[72:75], a[108:111], v[112:115], a[72:75]
    v_mfma_f32_16x16x32_bf16 a[76:79], a[108:111], v[116:119], a[76:79]
    s_add_u32 s55, s55, 73728
    s_mov_b32 s34, 7282
    v_mul_lo_u32 v8, v0, s34
    v_lshrrev_b32 v8, 16, v8
    v_mul_u32_u24 v9, 9, v8
    v_sub_u32 v9, v0, v9
    v_add_u32 v11, 512, v0
    v_mul_lo_u32 v10, v11, s34
    v_lshrrev_b32 v10, 16, v10
    v_mul_u32_u24 v14, 9, v10
    v_sub_u32 v11, v11, v14
    s_mul_i32 s35, s43, 9
    s_mul_i32 s36, s42, 73728
    s_add_u32 s36, s36, 10563584
    s_lshl_b32 s37, s42, 8
    s_add_u32 s37, s37, 12922880
    s_mul_i32 s38, s42, 73728
    s_mul_i32 s39, s43, 144
    s_add_u32 s38, s38, s39
    v_min_u32 v8, 63, v8
    v_lshrrev_b32 v14, 5, v8
    v_mul_u32_u24 v14, 36864, v14
    v_add_u32 v15, s35, v9
    v_lshl_add_u32 v14, v15, 9, v14
    v_and_b32 v15, 31, v8
    v_lshl_add_u32 v14, v15, 4, v14
    v_lshlrev_b32 v15, 2, v8
    buffer_load_dwordx4 v[104:107], v14, s[20:23], s36 offen sc1
    buffer_load_dword v2, v15, s[20:23], s37 offen sc1
    v_min_u32 v10, 63, v10
    v_lshrrev_b32 v14, 5, v10
    v_mul_u32_u24 v14, 36864, v14
    v_add_u32 v15, s35, v11
    v_lshl_add_u32 v14, v15, 9, v14
    v_and_b32 v15, 31, v10
    v_lshl_add_u32 v14, v15, 4, v14
    v_lshlrev_b32 v15, 2, v10
    buffer_load_dwordx4 v[108:111], v14, s[20:23], s36 offen sc1
    buffer_load_dword v3, v15, s[20:23], s37 offen sc1
    s_waitcnt vmcnt(24)
    v_mfma_f32_16x16x32_bf16 a[0:3], v[16:19], a[112:115], a[0:3]
    v_mfma_f32_16x16x32_bf16 a[16:19], v[20:23], a[112:115], a[16:19]
    v_mfma_f32_16x16x32_bf16 a[32:35], v[24:27], a[112:115], a[32:35]
    v_mfma_f32_16x16x32_bf16 a[48:51], v[28:31], a[112:115], a[48:51]
    s_waitcnt vmcnt(23)
    v_mfma_f32_16x16x32_bf16 a[4:7], v[16:19], a[116:119], a[4:7]
    v_mfma_f32_16x16x32_bf16 a[20:23], v[20:23], a[116:119], a[20:23]
    v_mfma_f32_16x16x32_bf16 a[36:39], v[24:27], a[116:119], a[36:39]
    v_mfma_f32_16x16x32_bf16 a[52:55], v[28:31], a[116:119], a[52:55]
    s_waitcnt vmcnt(22)
    v_mfma_f32_16x16x32_bf16 a[8:11], v[16:19], a[120:123], a[8:11]
    v_mfma_f32_16x16x32_bf16 a[24:27], v[20:23], a[120:123], a[24:27]
    v_mfma_f32_16x16x32_bf16 a[40:43], v[24:27], a[120:123], a[40:43]
    v_mfma_f32_16x16x32_bf16 a[56:59], v[28:31], a[120:123], a[56:59]
    s_waitcnt vmcnt(21)
    v_mfma_f32_16x16x32_bf16 a[12:15], v[16:19], a[124:127], a[12:15]
    v_mfma_f32_16x16x32_bf16 a[28:31], v[20:23], a[124:127], a[28:31]
    v_mfma_f32_16x16x32_bf16 a[44:47], v[24:27], a[124:127], a[44:47]
    v_mfma_f32_16x16x32_bf16 a[60:63], v[28:31], a[124:127], a[60:63]
    v_mfma_f32_16x16x32_bf16 a[80:83], a[108:111], a[112:115], a[80:83]
    v_mfma_f32_16x16x32_bf16 a[84:87], a[108:111], a[116:119], a[84:87]
    v_mfma_f32_16x16x32_bf16 a[88:91], a[108:111], a[120:123], a[88:91]
    v_mfma_f32_16x16x32_bf16 a[92:95], a[108:111], a[124:127], a[92:95]
    s_waitcnt vmcnt(16)
    v_mfma_f32_16x16x32_bf16 a[0:3], v[64:67], v[32:35], a[0:3]
    v_mfma_f32_16x16x32_bf16 a[16:19], v[68:71], v[32:35], a[16:19]
    v_mfma_f32_16x16x32_bf16 a[32:35], v[72:75], v[32:35], a[32:35]
    v_mfma_f32_16x16x32_bf16 a[48:51], v[76:79], v[32:35], a[48:51]
    s_waitcnt vmcnt(15)
    v_mfma_f32_16x16x32_bf16 a[4:7], v[64:67], v[36:39], a[4:7]
    v_mfma_f32_16x16x32_bf16 a[20:23], v[68:71], v[36:39], a[20:23]
    v_mfma_f32_16x16x32_bf16 a[36:39], v[72:75], v[36:39], a[36:39]
    v_mfma_f32_16x16x32_bf16 a[52:55], v[76:79], v[36:39], a[52:55]
    s_waitcnt vmcnt(14)
    v_mfma_f32_16x16x32_bf16 a[8:11], v[64:67], v[40:43], a[8:11]
    v_mfma_f32_16x16x32_bf16 a[24:27], v[68:71], v[40:43], a[24:27]
    v_mfma_f32_16x16x32_bf16 a[40:43], v[72:75], v[40:43], a[40:43]
    v_mfma_f32_16x16x32_bf16 a[56:59], v[76:79], v[40:43], a[56:59]
    s_waitcnt vmcnt(13)
    v_mfma_f32_16x16x32_bf16 a[12:15], v[64:67], v[44:47], a[12:15]
    v_mfma_f32_16x16x32_bf16 a[28:31], v[68:71], v[44:47], a[28:31]
    v_mfma_f32_16x16x32_bf16 a[44:47], v[72:75], v[44:47], a[44:47]
    v_mfma_f32_16x16x32_bf16 a[60:63], v[76:79], v[44:47], a[60:63]
    s_waitcnt vmcnt(12)
    v_mfma_f32_16x16x32_bf16 a[64:67], a[104:107], v[32:35], a[64:67]
    v_mfma_f32_16x16x32_bf16 a[68:71], a[104:107], v[36:39], a[68:71]
    v_mfma_f32_16x16x32_bf16 a[72:75], a[104:107], v[40:43], a[72:75]
    v_mfma_f32_16x16x32_bf16 a[76:79], a[104:107], v[44:47], a[76:79]
    s_waitcnt vmcnt(7)
    v_mfma_f32_16x16x32_bf16 a[0:3], v[80:83], v[48:51], a[0:3]
    v_mfma_f32_16x16x32_bf16 a[16:19], v[84:87], v[48:51], a[16:19]
    v_mfma_f32_16x16x32_bf16 a[32:35], v[88:91], v[48:51], a[32:35]
    v_mfma_f32_16x16x32_bf16 a[48:51], v[92:95], v[48:51], a[48:51]
    s_waitcnt vmcnt(6)
    v_mfma_f32_16x16x32_bf16 a[4:7], v[80:83], v[52:55], a[4:7]
    v_mfma_f32_16x16x32_bf16 a[20:23], v[84:87], v[52:55], a[20:23]
    v_mfma_f32_16x16x32_bf16 a[36:39], v[88:91], v[52:55], a[36:39]
    v_mfma_f32_16x16x32_bf16 a[52:55], v[92:95], v[52:55], a[52:55]
    s_waitcnt vmcnt(5)
    v_mfma_f32_16x16x32_bf16 a[8:11], v[80:83], v[56:59], a[8:11]
    v_mfma_f32_16x16x32_bf16 a[24:27], v[84:87], v[56:59], a[24:27]
    v_mfma_f32_16x16x32_bf16 a[40:43], v[88:91], v[56:59], a[40:43]
    v_mfma_f32_16x16x32_bf16 a[56:59], v[92:95], v[56:59], a[56:59]
    s_waitcnt vmcnt(4)
    v_mfma_f32_16x16x32_bf16 a[12:15], v[80:83], v[60:63], a[12:15]
    v_mfma_f32_16x16x32_bf16 a[28:31], v[84:87], v[60:63], a[28:31]
    v_mfma_f32_16x16x32_bf16 a[44:47], v[88:91], v[60:63], a[44:47]
    v_mfma_f32_16x16x32_bf16 a[60:63], v[92:95], v[60:63], a[60:63]
    v_mfma_f32_16x16x32_bf16 a[80:83], a[104:107], v[48:51], a[80:83]
    v_mfma_f32_16x16x32_bf16 a[84:87], a[104:107], v[52:55], a[84:87]
    v_mfma_f32_16x16x32_bf16 a[88:91], a[104:107], v[56:59], a[88:91]
    v_mfma_f32_16x16x32_bf16 a[92:95], a[104:107], v[60:63], a[92:95]
    s_mul_i32 s40, s24, 19456
    v_and_b32 v14, 15, v1
    v_mul_u32_u24 v14, 304, v14
    v_lshrrev_b32 v15, 4, v1
    v_lshl_add_u32 v14, v15, 4, v14
    v_add_u32 v14, s40, v14
    ds_write_b128 v14, a[0:3] offset:0
    ds_write_b128 v14, a[16:19] offset:64
    ds_write_b128 v14, a[32:35] offset:128
    ds_write_b128 v14, a[48:51] offset:192
    ds_write_b128 v14, a[4:7] offset:4864
    ds_write_b128 v14, a[20:23] offset:4928
    ds_write_b128 v14, a[36:39] offset:4992
    ds_write_b128 v14, a[52:55] offset:5056
    ds_write_b128 v14, a[8:11] offset:9728
    ds_write_b128 v14, a[24:27] offset:9792
    ds_write_b128 v14, a[40:43] offset:9856
    ds_write_b128 v14, a[56:59] offset:9920
    ds_write_b128 v14, a[12:15] offset:14592
    ds_write_b128 v14, a[28:31] offset:14656
    ds_write_b128 v14, a[44:47] offset:14720
    ds_write_b128 v14, a[60:63] offset:14784
    v_accvgpr_read_b32 v16, a64
    v_accvgpr_read_b32 v32, a80
    v_accvgpr_read_b32 v17, a65
    v_accvgpr_read_b32 v33, a81
    v_accvgpr_read_b32 v18, a66
    v_accvgpr_read_b32 v34, a82
    v_accvgpr_read_b32 v19, a67
    v_accvgpr_read_b32 v35, a83
    v_accvgpr_read_b32 v20, a68
    v_accvgpr_read_b32 v36, a84
    v_accvgpr_read_b32 v21, a69
    v_accvgpr_read_b32 v37, a85
    v_accvgpr_read_b32 v22, a70
    v_accvgpr_read_b32 v38, a86
    v_accvgpr_read_b32 v23, a71
    v_accvgpr_read_b32 v39, a87
    v_accvgpr_read_b32 v24, a72
    v_accvgpr_read_b32 v40, a88
    v_accvgpr_read_b32 v25, a73
    v_accvgpr_read_b32 v41, a89
    v_accvgpr_read_b32 v26, a74
    v_accvgpr_read_b32 v42, a90
    v_accvgpr_read_b32 v27, a75
    v_accvgpr_read_b32 v43, a91
    v_accvgpr_read_b32 v28, a76
    v_accvgpr_read_b32 v44, a92
    v_accvgpr_read_b32 v29, a77
    v_accvgpr_read_b32 v45, a93
    v_accvgpr_read_b32 v30, a78
    v_accvgpr_read_b32 v46, a94
    v_accvgpr_read_b32 v31, a79
    v_accvgpr_read_b32 v47, a95
    v_mov_b32 v48, v32
    v_mov_b32 v49, v33
    v_mov_b32 v50, v34
    v_mov_b32 v51, v35
    v_mov_b32 v52, v36
    v_mov_b32 v53, v37
    v_mov_b32 v54, v38
    v_mov_b32 v55, v39
    v_mov_b32 v56, v40
    v_mov_b32 v57, v41
    v_mov_b32 v58, v42
    v_mov_b32 v59, v43
    v_mov_b32 v60, v44
    v_mov_b32 v61, v45
    v_mov_b32 v62, v46
    v_mov_b32 v63, v47
    v_permlane32_swap_b32 v32, v48
    v_permlane32_swap_b32 v33, v49
    v_permlane32_swap_b32 v34, v50
    v_permlane32_swap_b32 v35, v51
    v_permlane32_swap_b32 v36, v52
    v_permlane32_swap_b32 v37, v53
    v_permlane32_swap_b32 v38, v54
    v_permlane32_swap_b32 v39, v55
    v_permlane32_swap_b32 v40, v56
    v_permlane32_swap_b32 v41, v57
    v_permlane32_swap_b32 v42, v58
    v_permlane32_swap_b32 v43, v59
    v_permlane32_swap_b32 v44, v60
    v_permlane32_swap_b32 v45, v61
    v_permlane32_swap_b32 v46, v62
    v_permlane32_swap_b32 v47, v63
    v_add_f32 v16, v16, v48
    v_add_f32 v17, v17, v49
    v_add_f32 v18, v18, v50
    v_add_f32 v19, v19, v51
    v_add_f32 v20, v20, v52
    v_add_f32 v21, v21, v53
    v_add_f32 v22, v22, v54
    v_add_f32 v23, v23, v55
    v_add_f32 v24, v24, v56
    v_add_f32 v25, v25, v57
    v_add_f32 v26, v26, v58
    v_add_f32 v27, v27, v59
    v_add_f32 v28, v28, v60
    v_add_f32 v29, v29, v61
    v_add_f32 v30, v30, v62
    v_add_f32 v31, v31, v63
    s_mov_b32 exec_hi, 0
    ds_write_b128 v14, v[16:19] offset:256
    ds_write_b128 v14, v[20:23] offset:5120
    ds_write_b128 v14, v[24:27] offset:9984
    ds_write_b128 v14, v[28:31] offset:14848
    s_mov_b64 exec, -1
    s_mov_b32 s46, 0xffff0000
    s_waitcnt lgkmcnt(0)
    s_barrier
    s_waitcnt vmcnt(0)
    v_mul_u32_u24 v14, 304, v8
    v_lshl_add_u32 v14, v9, 5, v14
    v_add_u32 v15, 77824, v14
    ds_read_b128 v[16:19], v14 offset:0
    ds_read_b128 v[20:23], v14 offset:16
    ds_read_b128 v[24:27], v14 offset:19456
    ds_read_b128 v[28:31], v14 offset:19472
    ds_read_b128 v[32:35], v14 offset:38912
    ds_read_b128 v[36:39], v14 offset:38928
    ds_read_b128 v[40:43], v14 offset:58368
    ds_read_b128 v[44:47], v14 offset:58384
    ds_read_b128 v[48:51], v15 offset:0
    ds_read_b128 v[52:55], v15 offset:16
    ds_read_b128 v[56:59], v15 offset:19456
    ds_read_b128 v[60:63], v15 offset:19472
    ds_read_b128 v[64:67], v15 offset:38912
    ds_read_b128 v[68:71], v15 offset:38928
    ds_read_b128 v[72:75], v15 offset:58368
    ds_read_b128 v[76:79], v15 offset:58384
    v_mul_u32_u24 v14, 1152, v8
    v_lshl_add_u32 v14, v9, 4, v14
    v_lshlrev_b32 v80, 16, v104
    v_and_b32 v81, s46, v104
    v_lshlrev_b32 v82, 16, v105
    v_and_b32 v83, s46, v105
    v_lshlrev_b32 v84, 16, v106
    v_and_b32 v85, s46, v106
    v_lshlrev_b32 v86, 16, v107
    v_and_b32 v87, s46, v107
    v_add_f32 v80, v80, v2
    v_add_f32 v81, v81, v2
    v_add_f32 v82, v82, v2
    v_add_f32 v83, v83, v2
    v_add_f32 v84, v84, v2
    v_add_f32 v85, v85, v2
    v_add_f32 v86, v86, v2
    v_add_f32 v87, v87, v2
    s_waitcnt lgkmcnt(12)
    v_add_f32 v16, v16, v24
    v_add_f32 v17, v17, v25
    v_add_f32 v18, v18, v26
    v_add_f32 v19, v19, v27
    v_add_f32 v20, v20, v28
    v_add_f32 v21, v21, v29
    v_add_f32 v22, v22, v30
    v_add_f32 v23, v23, v31
    s_waitcnt lgkmcnt(8)
    v_add_f32 v32, v32, v40
    v_add_f32 v33, v33, v41
    v_add_f32 v34, v34, v42
    v_add_f32 v35, v35, v43
    v_add_f32 v36, v36, v44
    v_add_f32 v37, v37, v45
    v_add_f32 v38, v38, v46
    v_add_f32 v39, v39, v47
    s_waitcnt lgkmcnt(4)
    v_add_f32 v48, v48, v56
    v_add_f32 v49, v49, v57
    v_add_f32 v50, v50, v58
    v_add_f32 v51, v51, v59
    v_add_f32 v52, v52, v60
    v_add_f32 v53, v53, v61
    v_add_f32 v54, v54, v62
    v_add_f32 v55, v55, v63
    s_waitcnt lgkmcnt(0)
    v_add_f32 v64, v64, v72
    v_add_f32 v65, v65, v73
    v_add_f32 v66, v66, v74
    v_add_f32 v67, v67, v75
    v_add_f32 v68, v68, v76
    v_add_f32 v69, v69, v77
    v_add_f32 v70, v70, v78
    v_add_f32 v71, v71, v79
    v_add_f32 v16, v16, v32
    v_add_f32 v48, v48, v64
    v_add_f32 v17, v17, v33
    v_add_f32 v49, v49, v65
    v_add_f32 v18, v18, v34
    v_add_f32 v50, v50, v66
    v_add_f32 v19, v19, v35
    v_add_f32 v51, v51, v67
    v_add_f32 v20, v20, v36
    v_add_f32 v52, v52, v68
    v_add_f32 v21, v21, v37
    v_add_f32 v53, v53, v69
    v_add_f32 v22, v22, v38
    v_add_f32 v54, v54, v70
    v_add_f32 v23, v23, v39
    v_add_f32 v55, v55, v71
    v_add_f32 v16, v16, v48
    v_add_f32 v17, v17, v49
    v_add_f32 v18, v18, v50
    v_add_f32 v19, v19, v51
    v_add_f32 v20, v20, v52
    v_add_f32 v21, v21, v53
    v_add_f32 v22, v22, v54
    v_add_f32 v23, v23, v55
    v_add_f32 v16, v16, v80
    v_add_f32 v17, v17, v81
    v_add_f32 v18, v18, v82
    v_add_f32 v19, v19, v83
    v_add_f32 v20, v20, v84
    v_add_f32 v21, v21, v85
    v_add_f32 v22, v22, v86
    v_add_f32 v23, v23, v87
    v_cvt_pk_bf16_f32 v88, v16, v17
    v_cvt_pk_bf16_f32 v89, v18, v19
    v_cvt_pk_bf16_f32 v90, v20, v21
    v_cvt_pk_bf16_f32 v91, v22, v23
    buffer_store_dwordx4 v[88:91], v14, s[12:15], s38 offen
    s_cmp_lg_u32 s24, 0
    s_cbranch_scc1 Lsequ_76
    v_mul_u32_u24 v14, 304, v10
    v_lshl_add_u32 v14, v11, 5, v14
    v_add_u32 v15, 77824, v14
    ds_read_b128 v[16:19], v14 offset:0
    ds_read_b128 v[20:23], v14 offset:16
    ds_read_b128 v[24:27], v14 offset:19456
    ds_read_b128 v[28:31], v14 offset:19472
    ds_read_b128 v[32:35], v14 offset:38912
    ds_read_b128 v[36:39], v14 offset:38928
    ds_read_b128 v[40:43], v14 offset:58368
    ds_read_b128 v[44:47], v14 offset:58384
    ds_read_b128 v[48:51], v15 offset:0
    ds_read_b128 v[52:55], v15 offset:16
    ds_read_b128 v[56:59], v15 offset:19456
    ds_read_b128 v[60:63], v15 offset:19472
    ds_read_b128 v[64:67], v15 offset:38912
    ds_read_b128 v[68:71], v15 offset:38928
    ds_read_b128 v[72:75], v15 offset:58368
    ds_read_b128 v[76:79], v15 offset:58384
    v_mul_u32_u24 v14, 1152, v10
    v_lshl_add_u32 v14, v11, 4, v14
    v_lshlrev_b32 v80, 16, v108
    v_and_b32 v81, s46, v108
    v_lshlrev_b32 v82, 16, v109
    v_and_b32 v83, s46, v109
    v_lshlrev_b32 v84, 16, v110
    v_and_b32 v85, s46, v110
    v_lshlrev_b32 v86, 16, v111
    v_and_b32 v87, s46, v111
    v_add_f32 v80, v80, v3
    v_add_f32 v81, v81, v3
    v_add_f32 v82, v82, v3
    v_add_f32 v83, v83, v3
    v_add_f32 v84, v84, v3
    v_add_f32 v85, v85, v3
    v_add_f32 v86, v86, v3
    v_add_f32 v87, v87, v3
    s_waitcnt lgkmcnt(12)
    v_add_f32 v16, v16, v24
    v_add_f32 v17, v17, v25
    v_add_f32 v18, v18, v26
    v_add_f32 v19, v19, v27
    v_add_f32 v20, v20, v28
    v_add_f32 v21, v21, v29
    v_add_f32 v22, v22, v30
    v_add_f32 v23, v23, v31
    s_waitcnt lgkmcnt(8)
    v_add_f32 v32, v32, v40
    v_add_f32 v33, v33, v41
    v_add_f32 v34, v34, v42
    v_add_f32 v35, v35, v43
    v_add_f32 v36, v36, v44
    v_add_f32 v37, v37, v45
    v_add_f32 v38, v38, v46
    v_add_f32 v39, v39, v47
    s_waitcnt lgkmcnt(4)
    v_add_f32 v48, v48, v56
    v_add_f32 v49, v49, v57
    v_add_f32 v50, v50, v58
    v_add_f32 v51, v51, v59
    v_add_f32 v52, v52, v60
    v_add_f32 v53, v53, v61
    v_add_f32 v54, v54, v62
    v_add_f32 v55, v55, v63
    s_waitcnt lgkmcnt(0)
    v_add_f32 v64, v64, v72
    v_add_f32 v65, v65, v73
    v_add_f32 v66, v66, v74
    v_add_f32 v67, v67, v75
    v_add_f32 v68, v68, v76
    v_add_f32 v69, v69, v77
    v_add_f32 v70, v70, v78
    v_add_f32 v71, v71, v79
    v_add_f32 v16, v16, v32
    v_add_f32 v48, v48, v64
    v_add_f32 v17, v17, v33
    v_add_f32 v49, v49, v65
    v_add_f32 v18, v18, v34
    v_add_f32 v50, v50, v66
    v_add_f32 v19, v19, v35
    v_add_f32 v51, v51, v67
    v_add_f32 v20, v20, v36
    v_add_f32 v52, v52, v68
    v_add_f32 v21, v21, v37
    v_add_f32 v53, v53, v69
    v_add_f32 v22, v22, v38
    v_add_f32 v54, v54, v70
    v_add_f32 v23, v23, v39
    v_add_f32 v55, v55, v71
    v_add_f32 v16, v16, v48
    v_add_f32 v17, v17, v49
    v_add_f32 v18, v18, v50
    v_add_f32 v19, v19, v51
    v_add_f32 v20, v20, v52
    v_add_f32 v21, v21, v53
    v_add_f32 v22, v22, v54
    v_add_f32 v23, v23, v55
    v_add_f32 v16, v16, v80
    v_add_f32 v17, v17, v81
    v_add_f32 v18, v18, v82
    v_add_f32 v19, v19, v83
    v_add_f32 v20, v20, v84
    v_add_f32 v21, v21, v85
    v_add_f32 v22, v22, v86
    v_add_f32 v23, v23, v87
    v_cvt_pk_bf16_f32 v88, v16, v17
    v_cvt_pk_bf16_f32 v89, v18, v19
    v_cvt_pk_bf16_f32 v90, v20, v21
    v_cvt_pk_bf16_f32 v91, v22, v23
    buffer_store_dwordx4 v[88:91], v14, s[12:15], s38 offen
Lsequ_76:
Lsequ_1:
    s_endpgm
ALL_CODE_END:
.section .rodata,"a"
.p2align 6
.amdhsa_kernel sequential_preLN__softmax_full_mha__swiglu_ffn__prompt_kernel
  .amdhsa_next_free_vgpr 256
  .amdhsa_next_free_sgpr 100
  .amdhsa_accum_offset 128
  .amdhsa_group_segment_fixed_size 0
  .amdhsa_kernarg_size 80
  .amdhsa_user_sgpr_count 2
  .amdhsa_user_sgpr_kernarg_segment_ptr 1
  .amdhsa_system_sgpr_workgroup_id_x 1
.end_amdhsa_kernel
```
